```python
import torch

def _softmax(x, axis=-1):
    return torch.softmax(x, dim=axis)
def _gelu(x):
    return torch.nn.functional.gelu(x, approximate="tanh")
def _silu(x):
    return torch.nn.functional.silu(x)
def _sigmoid(x):
    return torch.sigmoid(x)
def _layernorm(x, axis=-1, eps=1e-5):
    m = x.mean(dim=axis, keepdim=True)
    v = x.var(dim=axis, keepdim=True, unbiased=False)
    return (x - m) / torch.sqrt(v + eps)
def _scatter_add(tgt, idx, src, axis=0):
    return tgt.clone().index_add_(axis, idx, src)
def _segment_sum(src, seg, n):
    out = torch.zeros((n,) + src.shape[1:], dtype=src.dtype)
    return out.index_add_(0, seg, src)
def _pad(x, pw):
    flat = tuple(v for pair in reversed(pw) for v in pair)
    return torch.nn.functional.pad(x, flat)

kernel_name = 'concat_heads__gqa_block_cached__mha_block_cached__near_ridge'

def setup_inputs():

    _w = (lambda a: (lambda t: t.to(torch.bfloat16) if t.is_floating_point() else t)(torch.as_tensor(a)))
    def _A_setup():
        B, Sq, D = 16, 48, 512
        Hq, Hkv, Sk, Dh = 32, 8, 512, 128
        assert Hq % Hkv == 0, (Hq, Hkv)
        return {
            "x": _w((lambda *s: torch.randn(*s, dtype=torch.bfloat16) * 0.8)(B, Sq, D)),
            "k_cache": _w((lambda *s: torch.randn(*s, dtype=torch.bfloat16) * 0.8)(B, Hkv, Sk, Dh)),
            "v_cache": _w((lambda *s: torch.randn(*s, dtype=torch.bfloat16) * 0.05)(B, Hkv, Sk, Dh)),
            "wq": _w((lambda *s: torch.randn(*s, dtype=torch.bfloat16) * 0.8)(D, Hq * Dh) * (D ** -0.5)),
            "wo": _w((lambda *s: torch.randn(*s, dtype=torch.bfloat16) * 0.05)(Hq * Dh, D) * ((Hq * Dh) ** -0.5)),
        }
    _A_in = _A_setup()

    def _B_setup():
        B, Sq, D = 16, 48, 512
        H, Sk, Dh = 32, 512, 128
        return {
            "x": _w((lambda *s: torch.randn(*s, dtype=torch.bfloat16) * 0.8)(B, Sq, D)),
            "k_cache": _w((lambda *s: torch.randn(*s, dtype=torch.bfloat16) * 0.8)(B, H, Sk, Dh)),
            "v_cache": _w((lambda *s: torch.randn(*s, dtype=torch.bfloat16) * 0.05)(B, H, Sk, Dh)),
            "wq": _w((lambda *s: torch.randn(*s, dtype=torch.bfloat16) * 0.8)(D, H * Dh) * (D ** -0.5)),
            "wo": _w((lambda *s: torch.randn(*s, dtype=torch.bfloat16) * 0.05)(H * Dh, D) * ((H * Dh) ** -0.5)),
        }
    _B_in = _B_setup()

    return {
        "A_x": _A_in["x"],
        "A_k_cache": _A_in["k_cache"],
        "A_v_cache": _A_in["v_cache"],
        "A_wq": _A_in["wq"],
        "A_wo": _A_in["wo"],
        "B_x": _B_in["x"],
        "B_k_cache": _B_in["k_cache"],
        "B_v_cache": _B_in["v_cache"],
        "B_wq": _B_in["wq"],
        "B_wo": _B_in["wo"],
    }

def reference(A_x, A_k_cache, A_v_cache, A_wq, A_wo, B_x, B_k_cache, B_v_cache, B_wq, B_wo):
    def _A_ref(x, k_cache, v_cache, wq, wo):
        B, Sq, D = x.shape
        Hq, Dh = 32, 128
        Hkv = k_cache.shape[1]
        rep = Hq // Hkv
        q = (lambda x, *d: x.permute(*d))((x @ wq).reshape(B, Sq, Hq, Dh), 0, 2, 1, 3)
        k = (lambda x, n, axis: torch.repeat_interleave(x, n, dim=axis))(k_cache, rep, axis=1)
        v = (lambda x, n, axis: torch.repeat_interleave(x, n, dim=axis))(v_cache, rep, axis=1)
        scores = torch.einsum("bhqd,bhkd->bhqk", q, k) * (Dh ** -0.5)
        p = _softmax(scores, axis=-1)
        o = torch.einsum("bhqk,bhkd->bhqd", p, v)
        return (lambda x, *d: x.permute(*d))(o, 0, 2, 1, 3).reshape(B, Sq, Hq * Dh) @ wo

    def _B_ref(x, k_cache, v_cache, wq, wo):
        B, Sq, D = x.shape
        H, Dh = 32, 128
        q = (lambda x, *d: x.permute(*d))((x @ wq).reshape(B, Sq, H, Dh), 0, 2, 1, 3)
        scores = torch.einsum("bhqd,bhkd->bhqk", q, k_cache) * (Dh ** -0.5)
        p = _softmax(scores, axis=-1)
        o = torch.einsum("bhqk,bhkd->bhqd", p, v_cache)
        return (lambda x, *d: x.permute(*d))(o, 0, 2, 1, 3).reshape(B, Sq, H * Dh) @ wo

    a = _A_ref(A_x, A_k_cache, A_v_cache, A_wq, A_wo)
    b = _B_ref(B_x, B_k_cache, B_v_cache, B_wq, B_wo)
    return torch.concatenate([a, b], axis=-1)
```

```asm
; @launch grid=(256,1,1) block=(512,1,1) lds=163840
.amdgcn_target "amdgcn-amd-amdhsa--gfx950"
.text
.globl concat_heads__gqa_block_cached__mha_block_cached__near_ridge_kernel
.p2align 8
.type concat_heads__gqa_block_cached__mha_block_cached__near_ridge_kernel,@function
concat_heads__gqa_block_cached__mha_block_cached__near_ridge_kernel:
.Lcode_begin:
    s_cmp_ge_u32 s2, 256
    s_cbranch_scc1 .Lend
    s_load_dwordx16 s[40:55], s[0:1], 0
    s_load_dwordx8 s[56:63], s[0:1], 64
    s_load_dwordx2 s[64:65], s[0:1], 96
    v_lshrrev_b32 v1, 6, v0
    s_nop 0
    v_readfirstlane_b32 s4, v1
    s_and_b32 s5, s2, 7
    s_bfe_u32 s7, s2, 0x10003
    s_lshr_b32 s6, s2, 4
    s_lshl_b32 s6, s6, 0
    s_and_b32 s94, s4, 3
    s_mov_b32 s82, 2097152
    v_and_b32 v32, 63, v0
    v_lshlrev_b32 v2, 4, v32
    s_lshl_b32 s11, s94, 13
    v_lshlrev_b32 v33, 7, v32
    v_add_u32 v33, s11, v33
    s_getpc_b64 s[96:97]
.Lpf_pc:
    s_sub_u32 s96, s96, .Lpf_pc-.Lcode_begin
    s_subb_u32 s97, s97, 0
    v_min_u32 v33, .Lcode_end-.Lcode_begin-4, v33
    s_mul_i32 s3, s6, 49152
    s_mul_i32 s11, s4, 6144
    s_add_u32 s3, s3, s11
    s_add_u32 s3, s3, 2048
    v_add_u32 v34, s3, v2
    s_cmp_eq_u32 s7, 0
    s_cbranch_scc1 .Lno_xw
    s_waitcnt lgkmcnt(0)
    global_load_dwordx4 v[120:123], v34, s[50:51] offset:-2048
    global_load_dwordx4 v[124:127], v34, s[50:51] offset:-1024
    global_load_dwordx4 v[128:131], v34, s[50:51] offset:0
    global_load_dwordx4 v[132:135], v34, s[50:51] offset:1024
    global_load_dwordx4 v[136:139], v34, s[50:51] offset:2048
    global_load_dwordx4 v[140:143], v34, s[50:51] offset:3072
.Lno_xw:
    s_cmp_lt_u32 s4, 4
    s_cbranch_scc1 .Lconsumer
    s_setprio 2
    s_lshl_b32 s75, s94, 12
    s_lshl_b32 s8, s94, 8
    s_add_u32 s8, s8, 137216
    v_mov_b32 v34, .Ltab-.Lcode_begin
    s_waitcnt lgkmcnt(0)
    s_cmp_eq_u32 s7, 0
    s_cbranch_scc1 .Lld_a
    v_lshrrev_b32 v12, 4, v32
    s_and_b32 s3, s94, 1
    s_lshl_b32 s3, s3, 7
    v_lshrrev_b32 v7, 5, v32
    v_and_b32 v4, 0x1ff, v2
    v_lshlrev_b32 v5, 5, v7
    v_xor_b32 v4, v4, v5
    v_lshl_add_u32 v4, v7, 13, v4
    v_xor_b32 v28, s3, v4
    v_xor_b32 v29, 64, v28
    v_and_b32 v4, 7, v32
    v_xor_b32 v4, v4, v12
    v_lshlrev_b32 v4, 4, v4
    v_lshrrev_b32 v7, 3, v32
    v_lshl_add_u32 v36, v7, 10, v4
    v_xor_b32 v37, 64, v36
    s_lshr_b32 s92, s6, 1
    s_and_b32 s39, s6, 1
    s_lshl_b32 s39, s39, 18
    s_mov_b32 s12, s50
    s_mov_b32 s13, s51
    s_mov_b32 s14, 0xc0000
    s_mov_b32 s15, 0x20000
    s_mov_b32 s24, s56
    s_mov_b32 s25, s57
    s_mov_b32 s26, 0x400000
    s_mov_b32 s27, 0x20000
    s_mul_i32 s67, s94, 3072
    s_and_b32 s3, s94, 2
    s_lshl_b32 s3, s3, 10
    s_add_u32 s67, s67, s3
    s_mul_i32 s3, s94, 24576
    s_bitcmp0_b32 s94, 0
    s_cbranch_scc1 .Lxs_1
    v_swap_b32 v36, v37
.Lxs_1:
    s_and_b32 s68, s6, 14
    s_mul_i32 s68, s68, 49152
    s_add_u32 s68, s68, s3
    s_lshl_b32 s72, s5, 10
    s_lshl_b32 s3, s94, 16
    s_add_u32 s72, s72, s3
    s_lshr_b32 s3, s39, 9
    s_add_u32 s72, s72, s3
    s_lshl_b32 s10, s92, 19
    s_lshl_b32 s92, s92, 7
    s_add_u32 s66, s10, s72
    s_add_u32 s10, s10, 0x80000
    s_and_b32 s10, s10, 0x3fffff
    s_mov_b32 m0, s75
    s_nop 0
    buffer_load_dwordx4 v28, s[24:27], s66 offen offset:0 lds
    s_add_u32 s66, s66, 15360
    buffer_load_dwordx4 v29, s[24:27], s66 offen offset:1024 lds
    s_add_u32 s66, s66, 15360
    buffer_load_dwordx4 v28, s[24:27], s66 offen offset:2048 lds
    s_add_u32 s66, s66, 15360
    buffer_load_dwordx4 v29, s[24:27], s66 offen offset:3072 lds
    s_add_u32 m0, s75, 16384
    s_add_u32 s66, s66, 216064
    buffer_load_dwordx4 v28, s[24:27], s66 offen offset:0 lds
    s_add_u32 s66, s66, 15360
    buffer_load_dwordx4 v29, s[24:27], s66 offen offset:1024 lds
    s_add_u32 s66, s66, 15360
    buffer_load_dwordx4 v28, s[24:27], s66 offen offset:2048 lds
    s_add_u32 s66, s66, 15360
    buffer_load_dwordx4 v29, s[24:27], s66 offen offset:3072 lds
    s_add_u32 s75, s75, 32768
    s_and_b32 s75, s75, 0x1ffff
    s_add_u32 s66, s92, 0
    s_and_b32 s66, s66, 1023
    s_add_u32 s66, s66, s68
    s_add_u32 m0, s67, 131072
    s_nop 0
    buffer_load_dwordx4 v36, s[12:15], s66 offen offset:0 lds
    s_add_u32 s66, s66, 7168
    buffer_load_dwordx4 v37, s[12:15], s66 offen offset:1024 lds
    s_add_u32 s66, s66, 7168
    buffer_load_dwordx4 v36, s[12:15], s66 offen offset:2048 lds
    s_barrier
    s_mov_b32 m0, s8
    v_add_u32 v34, 4, v34
    global_load_lds_dword v34, s[96:97]
    s_add_u32 s66, s92, 128
    s_and_b32 s66, s66, 1023
    s_add_u32 s66, s66, s68
    s_add_u32 m0, s67, 147456
    s_nop 0
    buffer_load_dwordx4 v36, s[12:15], s66 offen offset:0 lds
    s_add_u32 s66, s66, 7168
    buffer_load_dwordx4 v37, s[12:15], s66 offen offset:1024 lds
    s_add_u32 s66, s66, 7168
    buffer_load_dwordx4 v36, s[12:15], s66 offen offset:2048 lds
    s_add_u32 s66, s10, s72
    s_add_u32 s10, s10, 0x80000
    s_and_b32 s10, s10, 0x3fffff
    s_mov_b32 m0, s75
    s_nop 0
    buffer_load_dwordx4 v28, s[24:27], s66 offen offset:0 lds
    s_add_u32 s66, s66, 15360
    buffer_load_dwordx4 v29, s[24:27], s66 offen offset:1024 lds
    s_add_u32 s66, s66, 15360
    buffer_load_dwordx4 v28, s[24:27], s66 offen offset:2048 lds
    s_add_u32 s66, s66, 15360
    buffer_load_dwordx4 v29, s[24:27], s66 offen offset:3072 lds
    s_add_u32 m0, s75, 16384
    s_add_u32 s66, s66, 216064
    buffer_load_dwordx4 v28, s[24:27], s66 offen offset:0 lds
    s_add_u32 s66, s66, 15360
    buffer_load_dwordx4 v29, s[24:27], s66 offen offset:1024 lds
    s_add_u32 s66, s66, 15360
    buffer_load_dwordx4 v28, s[24:27], s66 offen offset:2048 lds
    s_add_u32 s66, s66, 15360
    buffer_load_dwordx4 v29, s[24:27], s66 offen offset:3072 lds
    s_add_u32 s75, s75, 32768
    s_and_b32 s75, s75, 0x1ffff
    s_mov_b32 m0, s8
    v_add_u32 v34, 4, v34
    global_load_lds_dword v34, s[96:97]
    s_add_u32 s66, s10, s72
    s_add_u32 s10, s10, 0x80000
    s_and_b32 s10, s10, 0x3fffff
    s_mov_b32 m0, s75
    s_nop 0
    buffer_load_dwordx4 v28, s[24:27], s66 offen offset:0 lds
    s_add_u32 s66, s66, 15360
    buffer_load_dwordx4 v29, s[24:27], s66 offen offset:1024 lds
    s_add_u32 s66, s66, 15360
    buffer_load_dwordx4 v28, s[24:27], s66 offen offset:2048 lds
    s_add_u32 s66, s66, 15360
    buffer_load_dwordx4 v29, s[24:27], s66 offen offset:3072 lds
    s_add_u32 m0, s75, 16384
    s_add_u32 s66, s66, 216064
    buffer_load_dwordx4 v28, s[24:27], s66 offen offset:0 lds
    s_add_u32 s66, s66, 15360
    buffer_load_dwordx4 v29, s[24:27], s66 offen offset:1024 lds
    s_add_u32 s66, s66, 15360
    buffer_load_dwordx4 v28, s[24:27], s66 offen offset:2048 lds
    s_add_u32 s66, s66, 15360
    buffer_load_dwordx4 v29, s[24:27], s66 offen offset:3072 lds
    s_add_u32 s75, s75, 32768
    s_and_b32 s75, s75, 0x1ffff
    s_barrier
    s_add_u32 s66, s92, 256
    s_and_b32 s66, s66, 1023
    s_add_u32 s66, s66, s68
    s_add_u32 m0, s67, 131072
    s_nop 0
    buffer_load_dwordx4 v36, s[12:15], s66 offen offset:0 lds
    s_add_u32 s66, s66, 7168
    buffer_load_dwordx4 v37, s[12:15], s66 offen offset:1024 lds
    s_add_u32 s66, s66, 7168
    buffer_load_dwordx4 v36, s[12:15], s66 offen offset:2048 lds
    s_mov_b32 m0, s8
    v_add_u32 v34, 4, v34
    global_load_lds_dword v34, s[96:97]
    s_add_u32 s66, s10, s72
    s_add_u32 s10, s10, 0x80000
    s_and_b32 s10, s10, 0x3fffff
    s_mov_b32 m0, s75
    s_nop 0
    buffer_load_dwordx4 v28, s[24:27], s66 offen offset:0 lds
    s_add_u32 s66, s66, 15360
    buffer_load_dwordx4 v29, s[24:27], s66 offen offset:1024 lds
    s_add_u32 s66, s66, 15360
    buffer_load_dwordx4 v28, s[24:27], s66 offen offset:2048 lds
    s_add_u32 s66, s66, 15360
    buffer_load_dwordx4 v29, s[24:27], s66 offen offset:3072 lds
    s_add_u32 m0, s75, 16384
    s_add_u32 s66, s66, 216064
    buffer_load_dwordx4 v28, s[24:27], s66 offen offset:0 lds
    s_add_u32 s66, s66, 15360
    buffer_load_dwordx4 v29, s[24:27], s66 offen offset:1024 lds
    s_add_u32 s66, s66, 15360
    buffer_load_dwordx4 v28, s[24:27], s66 offen offset:2048 lds
    s_add_u32 s66, s66, 15360
    buffer_load_dwordx4 v29, s[24:27], s66 offen offset:3072 lds
    s_add_u32 s75, s75, 32768
    s_and_b32 s75, s75, 0x1ffff
    s_barrier
    s_add_u32 s66, s92, 384
    s_and_b32 s66, s66, 1023
    s_add_u32 s66, s66, s68
    s_add_u32 m0, s67, 147456
    s_nop 0
    buffer_load_dwordx4 v36, s[12:15], s66 offen offset:0 lds
    s_add_u32 s66, s66, 7168
    buffer_load_dwordx4 v37, s[12:15], s66 offen offset:1024 lds
    s_add_u32 s66, s66, 7168
    buffer_load_dwordx4 v36, s[12:15], s66 offen offset:2048 lds
    s_mov_b32 m0, s8
    v_add_u32 v34, 4, v34
    global_load_lds_dword v34, s[96:97]
    s_add_u32 s66, s10, s72
    s_add_u32 s10, s10, 0x80000
    s_and_b32 s10, s10, 0x3fffff
    s_mov_b32 m0, s75
    s_nop 0
    buffer_load_dwordx4 v28, s[24:27], s66 offen offset:0 lds
    s_add_u32 s66, s66, 15360
    buffer_load_dwordx4 v29, s[24:27], s66 offen offset:1024 lds
    s_add_u32 s66, s66, 15360
    buffer_load_dwordx4 v28, s[24:27], s66 offen offset:2048 lds
    s_add_u32 s66, s66, 15360
    buffer_load_dwordx4 v29, s[24:27], s66 offen offset:3072 lds
    s_add_u32 m0, s75, 16384
    s_add_u32 s66, s66, 216064
    buffer_load_dwordx4 v28, s[24:27], s66 offen offset:0 lds
    s_add_u32 s66, s66, 15360
    buffer_load_dwordx4 v29, s[24:27], s66 offen offset:1024 lds
    s_add_u32 s66, s66, 15360
    buffer_load_dwordx4 v28, s[24:27], s66 offen offset:2048 lds
    s_add_u32 s66, s66, 15360
    buffer_load_dwordx4 v29, s[24:27], s66 offen offset:3072 lds
    s_add_u32 s75, s75, 32768
    s_and_b32 s75, s75, 0x1ffff
    s_barrier
    s_add_u32 s66, s92, 512
    s_and_b32 s66, s66, 1023
    s_add_u32 s66, s66, s68
    s_add_u32 m0, s67, 131072
    s_nop 0
    buffer_load_dwordx4 v36, s[12:15], s66 offen offset:0 lds
    s_add_u32 s66, s66, 7168
    buffer_load_dwordx4 v37, s[12:15], s66 offen offset:1024 lds
    s_add_u32 s66, s66, 7168
    buffer_load_dwordx4 v36, s[12:15], s66 offen offset:2048 lds
    s_mov_b32 m0, s8
    v_add_u32 v34, 4, v34
    global_load_lds_dword v34, s[96:97]
    s_add_u32 s66, s10, s72
    s_add_u32 s10, s10, 0x80000
    s_and_b32 s10, s10, 0x3fffff
    s_mov_b32 m0, s75
    s_nop 0
    buffer_load_dwordx4 v28, s[24:27], s66 offen offset:0 lds
    s_add_u32 s66, s66, 15360
    buffer_load_dwordx4 v29, s[24:27], s66 offen offset:1024 lds
    s_add_u32 s66, s66, 15360
    buffer_load_dwordx4 v28, s[24:27], s66 offen offset:2048 lds
    s_add_u32 s66, s66, 15360
    buffer_load_dwordx4 v29, s[24:27], s66 offen offset:3072 lds
    s_add_u32 m0, s75, 16384
    s_add_u32 s66, s66, 216064
    buffer_load_dwordx4 v28, s[24:27], s66 offen offset:0 lds
    s_add_u32 s66, s66, 15360
    buffer_load_dwordx4 v29, s[24:27], s66 offen offset:1024 lds
    s_add_u32 s66, s66, 15360
    buffer_load_dwordx4 v28, s[24:27], s66 offen offset:2048 lds
    s_add_u32 s66, s66, 15360
    buffer_load_dwordx4 v29, s[24:27], s66 offen offset:3072 lds
    s_add_u32 s75, s75, 32768
    s_and_b32 s75, s75, 0x1ffff
    v_and_b32 v3, 15, v32
    v_lshrrev_b32 v5, 1, v3
    v_and_b32 v6, 1, v32
    v_lshlrev_b32 v6, 4, v6
    s_and_b32 s3, s94, 1
    s_lshl_b32 s3, s3, 7
    v_xor_b32 v4, v3, v12
    v_lshlrev_b32 v4, 4, v4
    v_lshl_add_u32 v4, v12, 8, v4
    v_xor_b32 v16, 0, v4
    v_xor_b32 v17, 64, v4
    v_xor_b32 v18, 128, v4
    v_xor_b32 v19, 192, v4
    v_xor_b32 v4, v5, v12
    v_lshl_add_u32 v4, v4, 5, v6
    v_lshl_add_u32 v20, v12, 8, v4
    v_xor_b32 v21, 0x80, v20
    v_xor_b32 v4, s3, v2
    v_xor_b32 v24, 0, v4
    v_xor_b32 v25, 32, v4
    v_xor_b32 v26, 64, v4
    v_xor_b32 v27, 96, v4
    s_mul_i32 s93, s6, 1
    s_mul_i32 s3, s5, 3
    s_add_u32 s93, s93, s3
    s_lshl_b32 s93, s93, 14
    s_mov_b32 s16, s52
    s_mov_b32 s17, s53
    s_mov_b32 s18, 0x4000000
    s_mov_b32 s19, 0x20000
    s_mov_b32 s20, s54
    s_mov_b32 s21, s55
    s_mov_b32 s22, 0x4000000
    s_mov_b32 s23, 0x20000
    s_mov_b32 s28, s58
    s_mov_b32 s29, s59
    s_mov_b32 s30, 0x400000
    s_mov_b32 s31, 0x20000
    s_lshl_b32 s3, s94, 12
    s_lshl_b32 s69, s6, 3
    s_add_u32 s69, s69, s5
    s_and_b32 s69, s6, 14
    s_lshl_b32 s69, s69, 5
    s_and_b32 s74, s6, s7
    s_lshl_b32 s73, s5, s7
    s_add_u32 s73, s73, s74
    s_lshl_b32 s73, s73, 1
    s_add_u32 s69, s69, s73
    s_lshl_b32 s69, s69, 17
    s_add_u32 s69, s69, s3
    s_lshl_b32 s73, s73, 17
    s_add_u32 s73, s73, s3
    s_barrier
    s_add_u32 s66, s92, 640
    s_and_b32 s66, s66, 1023
    s_add_u32 s66, s66, s68
    s_add_u32 m0, s67, 147456
    s_nop 0
    buffer_load_dwordx4 v36, s[12:15], s66 offen offset:0 lds
    s_add_u32 s66, s66, 7168
    buffer_load_dwordx4 v37, s[12:15], s66 offen offset:1024 lds
    s_add_u32 s66, s66, 7168
    buffer_load_dwordx4 v36, s[12:15], s66 offen offset:2048 lds
    s_mov_b32 m0, s8
    v_add_u32 v34, 4, v34
    global_load_lds_dword v34, s[96:97]
    s_add_u32 s66, s10, s72
    s_add_u32 s10, s10, 0x80000
    s_and_b32 s10, s10, 0x3fffff
    s_mov_b32 m0, s75
    s_nop 0
    buffer_load_dwordx4 v28, s[24:27], s66 offen offset:0 lds
    s_add_u32 s66, s66, 15360
    buffer_load_dwordx4 v29, s[24:27], s66 offen offset:1024 lds
    s_add_u32 s66, s66, 15360
    buffer_load_dwordx4 v28, s[24:27], s66 offen offset:2048 lds
    s_add_u32 s66, s66, 15360
    buffer_load_dwordx4 v29, s[24:27], s66 offen offset:3072 lds
    s_add_u32 m0, s75, 16384
    s_add_u32 s66, s66, 216064
    buffer_load_dwordx4 v28, s[24:27], s66 offen offset:0 lds
    s_add_u32 s66, s66, 15360
    buffer_load_dwordx4 v29, s[24:27], s66 offen offset:1024 lds
    s_add_u32 s66, s66, 15360
    buffer_load_dwordx4 v28, s[24:27], s66 offen offset:2048 lds
    s_add_u32 s66, s66, 15360
    buffer_load_dwordx4 v29, s[24:27], s66 offen offset:3072 lds
    s_add_u32 s75, s75, 32768
    s_and_b32 s75, s75, 0x1ffff
    s_barrier
    s_add_u32 s66, s92, 768
    s_and_b32 s66, s66, 1023
    s_add_u32 s66, s66, s68
    s_add_u32 m0, s67, 131072
    s_nop 0
    buffer_load_dwordx4 v36, s[12:15], s66 offen offset:0 lds
    s_add_u32 s66, s66, 7168
    buffer_load_dwordx4 v37, s[12:15], s66 offen offset:1024 lds
    s_add_u32 s66, s66, 7168
    buffer_load_dwordx4 v36, s[12:15], s66 offen offset:2048 lds
    s_mov_b32 m0, s8
    v_add_u32 v34, 4, v34
    global_load_lds_dword v34, s[96:97]
    s_add_u32 s66, s10, s72
    s_add_u32 s10, s10, 0x80000
    s_and_b32 s10, s10, 0x3fffff
    s_mov_b32 m0, s75
    s_nop 0
    buffer_load_dwordx4 v28, s[24:27], s66 offen offset:0 lds
    s_add_u32 s66, s66, 15360
    buffer_load_dwordx4 v29, s[24:27], s66 offen offset:1024 lds
    s_add_u32 s66, s66, 15360
    buffer_load_dwordx4 v28, s[24:27], s66 offen offset:2048 lds
    s_add_u32 s66, s66, 15360
    buffer_load_dwordx4 v29, s[24:27], s66 offen offset:3072 lds
    s_add_u32 m0, s75, 16384
    s_add_u32 s66, s66, 216064
    buffer_load_dwordx4 v28, s[24:27], s66 offen offset:0 lds
    s_add_u32 s66, s66, 15360
    buffer_load_dwordx4 v29, s[24:27], s66 offen offset:1024 lds
    s_add_u32 s66, s66, 15360
    buffer_load_dwordx4 v28, s[24:27], s66 offen offset:2048 lds
    s_add_u32 s66, s66, 15360
    buffer_load_dwordx4 v29, s[24:27], s66 offen offset:3072 lds
    s_add_u32 s75, s75, 32768
    s_and_b32 s75, s75, 0x1ffff
    s_barrier
    s_add_u32 s66, s92, 896
    s_and_b32 s66, s66, 1023
    s_add_u32 s66, s66, s68
    s_add_u32 m0, s67, 147456
    s_nop 0
    buffer_load_dwordx4 v36, s[12:15], s66 offen offset:0 lds
    s_add_u32 s66, s66, 7168
    buffer_load_dwordx4 v37, s[12:15], s66 offen offset:1024 lds
    s_add_u32 s66, s66, 7168
    buffer_load_dwordx4 v36, s[12:15], s66 offen offset:2048 lds
    s_mov_b32 m0, s8
    v_add_u32 v34, 4, v34
    global_load_lds_dword v34, s[96:97]
    s_and_b32 s66, s93, 0x1ffff
    s_add_u32 s66, s66, s69
    s_add_u32 s38, s93, 32768
    s_and_b32 s38, s38, 0x1ffff
    s_add_u32 s38, s38, s69
    s_add_u32 s38, s38, 0x20000
    s_mov_b32 m0, s75
    s_nop 0
    buffer_load_dwordx4 v16, s[16:19], s66 offen offset:0 nt lds
    buffer_load_dwordx4 v17, s[16:19], s66 offen offset:1024 nt lds
    buffer_load_dwordx4 v18, s[16:19], s66 offen offset:2048 nt lds
    buffer_load_dwordx4 v19, s[16:19], s66 offen offset:3072 nt lds
    s_add_u32 m0, s75, 16384
    s_mov_b32 s66, s38
    buffer_load_dwordx4 v16, s[16:19], s66 offen offset:0 nt lds
    buffer_load_dwordx4 v17, s[16:19], s66 offen offset:1024 nt lds
    buffer_load_dwordx4 v18, s[16:19], s66 offen offset:2048 nt lds
    buffer_load_dwordx4 v19, s[16:19], s66 offen offset:3072 nt lds
    s_mov_b32 m0, s8
    v_add_u32 v34, 4, v34
    global_load_lds_dword v34, s[96:97]
    s_add_u32 s75, s75, 32768
    s_and_b32 s75, s75, 0x1ffff
    s_add_u32 s66, s93, 65536
    s_and_b32 s66, s66, 0x1ffff
    s_add_u32 s66, s66, s69
    s_add_u32 s66, s66, 0x400000
    s_add_u32 s38, s93, 98304
    s_and_b32 s38, s38, 0x1ffff
    s_add_u32 s38, s38, s69
    s_add_u32 s38, s38, 0x420000
    s_mov_b32 m0, s75
    s_nop 0
    buffer_load_dwordx4 v16, s[16:19], s66 offen offset:0 nt lds
    buffer_load_dwordx4 v17, s[16:19], s66 offen offset:1024 nt lds
    buffer_load_dwordx4 v18, s[16:19], s66 offen offset:2048 nt lds
    buffer_load_dwordx4 v19, s[16:19], s66 offen offset:3072 nt lds
    s_add_u32 m0, s75, 16384
    s_mov_b32 s66, s38
    buffer_load_dwordx4 v16, s[16:19], s66 offen offset:0 nt lds
    buffer_load_dwordx4 v17, s[16:19], s66 offen offset:1024 nt lds
    buffer_load_dwordx4 v18, s[16:19], s66 offen offset:2048 nt lds
    buffer_load_dwordx4 v19, s[16:19], s66 offen offset:3072 nt lds
    s_mov_b32 m0, s8
    v_add_u32 v34, 4, v34
    global_load_lds_dword v34, s[96:97]
    s_add_u32 s75, s75, 32768
    s_and_b32 s75, s75, 0x1ffff
    s_and_b32 s66, s93, 0x1ffff
    s_add_u32 s66, s66, s69
    s_add_u32 s38, s93, 32768
    s_and_b32 s38, s38, 0x1ffff
    s_add_u32 s38, s38, s69
    s_add_u32 s38, s38, 0x20000
    s_barrier
    s_mov_b32 m0, s75
    s_nop 0
    buffer_load_dwordx4 v20, s[20:23], s66 offen offset:0 nt lds
    buffer_load_dwordx4 v21, s[20:23], s66 offen offset:1024 nt lds
    buffer_load_dwordx4 v20, s[20:23], s66 offen offset:2048 nt lds
    buffer_load_dwordx4 v21, s[20:23], s66 offen offset:3072 nt lds
    s_add_u32 m0, s75, 16384
    s_mov_b32 s66, s38
    buffer_load_dwordx4 v20, s[20:23], s66 offen offset:0 nt lds
    buffer_load_dwordx4 v21, s[20:23], s66 offen offset:1024 nt lds
    buffer_load_dwordx4 v20, s[20:23], s66 offen offset:2048 nt lds
    buffer_load_dwordx4 v21, s[20:23], s66 offen offset:3072 nt lds
    s_mov_b32 m0, s8
    v_add_u32 v34, 4, v34
    global_load_lds_dword v34, s[96:97]
    s_add_u32 s75, s75, 32768
    s_and_b32 s75, s75, 0x1ffff
    s_add_u32 s66, s93, 65536
    s_and_b32 s66, s66, 0x1ffff
    s_add_u32 s66, s66, s69
    s_add_u32 s66, s66, 0x400000
    s_add_u32 s38, s93, 98304
    s_and_b32 s38, s38, 0x1ffff
    s_add_u32 s38, s38, s69
    s_add_u32 s38, s38, 0x420000
    s_barrier
    s_mov_b32 m0, s75
    s_nop 0
    buffer_load_dwordx4 v20, s[20:23], s66 offen offset:0 nt lds
    buffer_load_dwordx4 v21, s[20:23], s66 offen offset:1024 nt lds
    buffer_load_dwordx4 v20, s[20:23], s66 offen offset:2048 nt lds
    buffer_load_dwordx4 v21, s[20:23], s66 offen offset:3072 nt lds
    s_add_u32 m0, s75, 16384
    s_mov_b32 s66, s38
    buffer_load_dwordx4 v20, s[20:23], s66 offen offset:0 nt lds
    buffer_load_dwordx4 v21, s[20:23], s66 offen offset:1024 nt lds
    buffer_load_dwordx4 v20, s[20:23], s66 offen offset:2048 nt lds
    buffer_load_dwordx4 v21, s[20:23], s66 offen offset:3072 nt lds
    s_mov_b32 m0, s8
    v_add_u32 v34, 4, v34
    global_load_lds_dword v34, s[96:97]
    s_add_u32 s75, s75, 32768
    s_and_b32 s75, s75, 0x1ffff
    s_add_u32 s93, s93, 16384
    s_cmp_lg_u32 s94, 0
    s_cbranch_scc1 .Lcl_2
    v_mov_b32 v41, 0
    s_lshl_b32 s3, s7, 4
    s_lshr_b32 s11, s6, s7
    s_add_u32 s3, s3, s11
    s_lshl_b32 s3, s3, 11
    s_add_u32 s3, s3, 0x1200000
    s_and_b32 s74, s6, s7
    s_lshl_b32 s11, s5, s7
    s_add_u32 s11, s11, s74
    s_lshl_b32 s11, s11, 2
    s_add_u32 s3, s3, s11
    v_lshl_add_u32 v40, v2, 3, s3
    s_mov_b64 exec, 0x1
    global_store_dword v40, v41, s[64:65] sc1
    s_mov_b64 exec, -1
.Lcl_2:
    s_and_b32 s66, s93, 0x1ffff
    s_add_u32 s66, s66, s69
    s_add_u32 s38, s93, 32768
    s_and_b32 s38, s38, 0x1ffff
    s_add_u32 s38, s38, s69
    s_add_u32 s38, s38, 0x20000
    s_barrier
    s_mov_b32 m0, s75
    s_nop 0
    buffer_load_dwordx4 v16, s[16:19], s66 offen offset:0 nt lds
    buffer_load_dwordx4 v17, s[16:19], s66 offen offset:1024 nt lds
    buffer_load_dwordx4 v18, s[16:19], s66 offen offset:2048 nt lds
    buffer_load_dwordx4 v19, s[16:19], s66 offen offset:3072 nt lds
    s_add_u32 m0, s75, 16384
    s_mov_b32 s66, s38
    buffer_load_dwordx4 v16, s[16:19], s66 offen offset:0 nt lds
    buffer_load_dwordx4 v17, s[16:19], s66 offen offset:1024 nt lds
    buffer_load_dwordx4 v18, s[16:19], s66 offen offset:2048 nt lds
    buffer_load_dwordx4 v19, s[16:19], s66 offen offset:3072 nt lds
    s_mov_b32 m0, s8
    v_add_u32 v34, 4, v34
    global_load_lds_dword v34, s[96:97]
    s_add_u32 s75, s75, 32768
    s_and_b32 s75, s75, 0x1ffff
    s_add_u32 s66, s93, 65536
    s_and_b32 s66, s66, 0x1ffff
    s_add_u32 s66, s66, s69
    s_add_u32 s66, s66, 0x400000
    s_add_u32 s38, s93, 98304
    s_and_b32 s38, s38, 0x1ffff
    s_add_u32 s38, s38, s69
    s_add_u32 s38, s38, 0x420000
    s_mov_b32 m0, s75
    s_nop 0
    buffer_load_dwordx4 v16, s[16:19], s66 offen offset:0 nt lds
    buffer_load_dwordx4 v17, s[16:19], s66 offen offset:1024 nt lds
    buffer_load_dwordx4 v18, s[16:19], s66 offen offset:2048 nt lds
    buffer_load_dwordx4 v19, s[16:19], s66 offen offset:3072 nt lds
    s_add_u32 m0, s75, 16384
    s_mov_b32 s66, s38
    buffer_load_dwordx4 v16, s[16:19], s66 offen offset:0 nt lds
    buffer_load_dwordx4 v17, s[16:19], s66 offen offset:1024 nt lds
    buffer_load_dwordx4 v18, s[16:19], s66 offen offset:2048 nt lds
    buffer_load_dwordx4 v19, s[16:19], s66 offen offset:3072 nt lds
    s_mov_b32 m0, s8
    v_add_u32 v34, 4, v34
    global_load_lds_dword v34, s[96:97]
    s_add_u32 s75, s75, 32768
    s_and_b32 s75, s75, 0x1ffff
    s_and_b32 s66, s93, 0x1ffff
    s_add_u32 s66, s66, s69
    s_add_u32 s38, s93, 32768
    s_and_b32 s38, s38, 0x1ffff
    s_add_u32 s38, s38, s69
    s_add_u32 s38, s38, 0x20000
    s_barrier
    s_mov_b32 m0, s75
    s_nop 0
    buffer_load_dwordx4 v20, s[20:23], s66 offen offset:0 nt lds
    buffer_load_dwordx4 v21, s[20:23], s66 offen offset:1024 nt lds
    buffer_load_dwordx4 v20, s[20:23], s66 offen offset:2048 nt lds
    buffer_load_dwordx4 v21, s[20:23], s66 offen offset:3072 nt lds
    s_add_u32 m0, s75, 16384
    s_mov_b32 s66, s38
    buffer_load_dwordx4 v20, s[20:23], s66 offen offset:0 nt lds
    buffer_load_dwordx4 v21, s[20:23], s66 offen offset:1024 nt lds
    buffer_load_dwordx4 v20, s[20:23], s66 offen offset:2048 nt lds
    buffer_load_dwordx4 v21, s[20:23], s66 offen offset:3072 nt lds
    s_mov_b32 m0, s8
    v_add_u32 v34, 4, v34
    global_load_lds_dword v34, s[96:97]
    s_add_u32 s75, s75, 32768
    s_and_b32 s75, s75, 0x1ffff
    s_add_u32 s66, s93, 65536
    s_and_b32 s66, s66, 0x1ffff
    s_add_u32 s66, s66, s69
    s_add_u32 s66, s66, 0x400000
    s_add_u32 s38, s93, 98304
    s_and_b32 s38, s38, 0x1ffff
    s_add_u32 s38, s38, s69
    s_add_u32 s38, s38, 0x420000
    s_mov_b32 m0, s75
    s_nop 0
    buffer_load_dwordx4 v20, s[20:23], s66 offen offset:0 nt lds
    buffer_load_dwordx4 v21, s[20:23], s66 offen offset:1024 nt lds
    buffer_load_dwordx4 v20, s[20:23], s66 offen offset:2048 nt lds
    buffer_load_dwordx4 v21, s[20:23], s66 offen offset:3072 nt lds
    s_add_u32 m0, s75, 16384
    s_mov_b32 s66, s38
    buffer_load_dwordx4 v20, s[20:23], s66 offen offset:0 nt lds
    buffer_load_dwordx4 v21, s[20:23], s66 offen offset:1024 nt lds
    buffer_load_dwordx4 v20, s[20:23], s66 offen offset:2048 nt lds
    buffer_load_dwordx4 v21, s[20:23], s66 offen offset:3072 nt lds
    s_mov_b32 m0, s8
    v_add_u32 v34, 4, v34
    global_load_lds_dword v34, s[96:97]
    s_add_u32 s75, s75, 32768
    s_and_b32 s75, s75, 0x1ffff
    s_add_u32 s93, s93, 16384
    s_cmp_lg_u32 s94, 0
    s_cbranch_scc1 .Lcc_3
    v_mov_b32 v42, 0
    v_mov_b32 v43, 1
    s_waitcnt vmcnt(30)
    s_mov_b64 exec, 1
    global_atomic_add v42, v43, s[62:63] sc1
    s_mov_b64 exec, -1
.Lcc_3:
    s_mov_b32 s9, 6
.Lld_4:
    s_and_b32 s66, s93, 0x1ffff
    s_add_u32 s66, s66, s69
    s_add_u32 s38, s93, 32768
    s_and_b32 s38, s38, 0x1ffff
    s_add_u32 s38, s38, s69
    s_add_u32 s38, s38, 0x20000
    s_barrier
    s_mov_b32 m0, s75
    s_nop 0
    buffer_load_dwordx4 v16, s[16:19], s66 offen offset:0 nt lds
    buffer_load_dwordx4 v17, s[16:19], s66 offen offset:1024 nt lds
    buffer_load_dwordx4 v18, s[16:19], s66 offen offset:2048 nt lds
    buffer_load_dwordx4 v19, s[16:19], s66 offen offset:3072 nt lds
    s_add_u32 m0, s75, 16384
    s_mov_b32 s66, s38
    buffer_load_dwordx4 v16, s[16:19], s66 offen offset:0 nt lds
    buffer_load_dwordx4 v17, s[16:19], s66 offen offset:1024 nt lds
    buffer_load_dwordx4 v18, s[16:19], s66 offen offset:2048 nt lds
    buffer_load_dwordx4 v19, s[16:19], s66 offen offset:3072 nt lds
    s_mov_b32 m0, s8
    v_add_u32 v34, 4, v34
    global_load_lds_dword v34, s[96:97]
    s_add_u32 s75, s75, 32768
    s_and_b32 s75, s75, 0x1ffff
    s_add_u32 s66, s93, 65536
    s_and_b32 s66, s66, 0x1ffff
    s_add_u32 s66, s66, s69
    s_add_u32 s66, s66, 0x400000
    s_add_u32 s38, s93, 98304
    s_and_b32 s38, s38, 0x1ffff
    s_add_u32 s38, s38, s69
    s_add_u32 s38, s38, 0x420000
    s_mov_b32 m0, s75
    s_nop 0
    buffer_load_dwordx4 v16, s[16:19], s66 offen offset:0 nt lds
    buffer_load_dwordx4 v17, s[16:19], s66 offen offset:1024 nt lds
    buffer_load_dwordx4 v18, s[16:19], s66 offen offset:2048 nt lds
    buffer_load_dwordx4 v19, s[16:19], s66 offen offset:3072 nt lds
    s_add_u32 m0, s75, 16384
    s_mov_b32 s66, s38
    buffer_load_dwordx4 v16, s[16:19], s66 offen offset:0 nt lds
    buffer_load_dwordx4 v17, s[16:19], s66 offen offset:1024 nt lds
    buffer_load_dwordx4 v18, s[16:19], s66 offen offset:2048 nt lds
    buffer_load_dwordx4 v19, s[16:19], s66 offen offset:3072 nt lds
    s_mov_b32 m0, s8
    v_add_u32 v34, 4, v34
    global_load_lds_dword v34, s[96:97]
    s_add_u32 s75, s75, 32768
    s_and_b32 s75, s75, 0x1ffff
    s_and_b32 s66, s93, 0x1ffff
    s_add_u32 s66, s66, s69
    s_add_u32 s38, s93, 32768
    s_and_b32 s38, s38, 0x1ffff
    s_add_u32 s38, s38, s69
    s_add_u32 s38, s38, 0x20000
    s_barrier
    s_mov_b32 m0, s75
    s_nop 0
    buffer_load_dwordx4 v20, s[20:23], s66 offen offset:0 nt lds
    buffer_load_dwordx4 v21, s[20:23], s66 offen offset:1024 nt lds
    buffer_load_dwordx4 v20, s[20:23], s66 offen offset:2048 nt lds
    buffer_load_dwordx4 v21, s[20:23], s66 offen offset:3072 nt lds
    s_add_u32 m0, s75, 16384
    s_mov_b32 s66, s38
    buffer_load_dwordx4 v20, s[20:23], s66 offen offset:0 nt lds
    buffer_load_dwordx4 v21, s[20:23], s66 offen offset:1024 nt lds
    buffer_load_dwordx4 v20, s[20:23], s66 offen offset:2048 nt lds
    buffer_load_dwordx4 v21, s[20:23], s66 offen offset:3072 nt lds
    s_mov_b32 m0, s8
    v_add_u32 v34, 4, v34
    global_load_lds_dword v34, s[96:97]
    s_add_u32 s75, s75, 32768
    s_and_b32 s75, s75, 0x1ffff
    s_add_u32 s66, s93, 65536
    s_and_b32 s66, s66, 0x1ffff
    s_add_u32 s66, s66, s69
    s_add_u32 s66, s66, 0x400000
    s_add_u32 s38, s93, 98304
    s_and_b32 s38, s38, 0x1ffff
    s_add_u32 s38, s38, s69
    s_add_u32 s38, s38, 0x420000
    s_mov_b32 m0, s75
    s_nop 0
    buffer_load_dwordx4 v20, s[20:23], s66 offen offset:0 nt lds
    buffer_load_dwordx4 v21, s[20:23], s66 offen offset:1024 nt lds
    buffer_load_dwordx4 v20, s[20:23], s66 offen offset:2048 nt lds
    buffer_load_dwordx4 v21, s[20:23], s66 offen offset:3072 nt lds
    s_add_u32 m0, s75, 16384
    s_mov_b32 s66, s38
    buffer_load_dwordx4 v20, s[20:23], s66 offen offset:0 nt lds
    buffer_load_dwordx4 v21, s[20:23], s66 offen offset:1024 nt lds
    buffer_load_dwordx4 v20, s[20:23], s66 offen offset:2048 nt lds
    buffer_load_dwordx4 v21, s[20:23], s66 offen offset:3072 nt lds
    s_mov_b32 m0, s8
    v_add_u32 v34, 4, v34
    global_load_lds_dword v34, s[96:97]
    s_add_u32 s75, s75, 32768
    s_and_b32 s75, s75, 0x1ffff
    s_add_u32 s93, s93, 16384
    s_sub_u32 s9, s9, 1
    s_cmp_lg_u32 s9, 0
    s_cbranch_scc1 .Lld_4
    s_mov_b32 s10, s73
    s_add_u32 s74, s75, 0x18000
    s_mov_b32 s66, s10
    s_add_u32 s10, s10, 32768
    s_barrier
    s_mov_b32 m0, s75
    s_nop 0
    buffer_load_dwordx4 v24, s[28:31], s66 offen offset:0 lds
    buffer_load_dwordx4 v25, s[28:31], s66 offen offset:1024 lds
    buffer_load_dwordx4 v26, s[28:31], s66 offen offset:2048 lds
    buffer_load_dwordx4 v27, s[28:31], s66 offen offset:3072 lds
    s_add_u32 m0, s75, 16384
    s_add_u32 s66, s66, 16384
    buffer_load_dwordx4 v24, s[28:31], s66 offen offset:0 lds
    buffer_load_dwordx4 v25, s[28:31], s66 offen offset:1024 lds
    buffer_load_dwordx4 v26, s[28:31], s66 offen offset:2048 lds
    buffer_load_dwordx4 v27, s[28:31], s66 offen offset:3072 lds
    s_mov_b32 m0, s8
    v_add_u32 v34, 4, v34
    global_load_lds_dword v34, s[96:97]
    s_add_u32 s75, s75, 32768
    s_cmp_eq_u32 s75, s74
    s_cselect_b32 s3, 0x18000, 0
    s_sub_u32 s75, s75, s3
    s_mov_b32 s66, s10
    s_add_u32 s10, s10, 32768
    s_mov_b32 m0, s75
    s_nop 0
    buffer_load_dwordx4 v24, s[28:31], s66 offen offset:0 lds
    buffer_load_dwordx4 v25, s[28:31], s66 offen offset:1024 lds
    buffer_load_dwordx4 v26, s[28:31], s66 offen offset:2048 lds
    buffer_load_dwordx4 v27, s[28:31], s66 offen offset:3072 lds
    s_add_u32 m0, s75, 16384
    s_add_u32 s66, s66, 16384
    buffer_load_dwordx4 v24, s[28:31], s66 offen offset:0 lds
    buffer_load_dwordx4 v25, s[28:31], s66 offen offset:1024 lds
    buffer_load_dwordx4 v26, s[28:31], s66 offen offset:2048 lds
    buffer_load_dwordx4 v27, s[28:31], s66 offen offset:3072 lds
    s_mov_b32 m0, s8
    v_add_u32 v34, 4, v34
    global_load_lds_dword v34, s[96:97]
    s_add_u32 s75, s75, 32768
    s_cmp_eq_u32 s75, s74
    s_cselect_b32 s3, 0x18000, 0
    s_sub_u32 s75, s75, s3
    s_mov_b32 s66, s10
    s_add_u32 s10, s10, 32768
    s_barrier
    s_barrier
    s_mov_b32 m0, s75
    s_nop 0
    buffer_load_dwordx4 v24, s[28:31], s66 offen offset:0 lds
    buffer_load_dwordx4 v25, s[28:31], s66 offen offset:1024 lds
    buffer_load_dwordx4 v26, s[28:31], s66 offen offset:2048 lds
    buffer_load_dwordx4 v27, s[28:31], s66 offen offset:3072 lds
    s_add_u32 m0, s75, 16384
    s_add_u32 s66, s66, 16384
    buffer_load_dwordx4 v24, s[28:31], s66 offen offset:0 lds
    buffer_load_dwordx4 v25, s[28:31], s66 offen offset:1024 lds
    buffer_load_dwordx4 v26, s[28:31], s66 offen offset:2048 lds
    buffer_load_dwordx4 v27, s[28:31], s66 offen offset:3072 lds
    s_mov_b32 m0, s8
    v_add_u32 v34, 4, v34
    global_load_lds_dword v34, s[96:97]
    s_add_u32 s75, s75, 32768
    s_cmp_eq_u32 s75, s74
    s_cselect_b32 s3, 0x18000, 0
    s_sub_u32 s75, s75, s3
    s_mov_b32 s66, s10
    s_add_u32 s10, s10, 32768
    s_barrier
    s_mov_b32 m0, s75
    s_nop 0
    buffer_load_dwordx4 v24, s[28:31], s66 offen offset:0 lds
    buffer_load_dwordx4 v25, s[28:31], s66 offen offset:1024 lds
    buffer_load_dwordx4 v26, s[28:31], s66 offen offset:2048 lds
    buffer_load_dwordx4 v27, s[28:31], s66 offen offset:3072 lds
    s_add_u32 m0, s75, 16384
    s_add_u32 s66, s66, 16384
    buffer_load_dwordx4 v24, s[28:31], s66 offen offset:0 lds
    buffer_load_dwordx4 v25, s[28:31], s66 offen offset:1024 lds
    buffer_load_dwordx4 v26, s[28:31], s66 offen offset:2048 lds
    buffer_load_dwordx4 v27, s[28:31], s66 offen offset:3072 lds
    s_mov_b32 m0, s8
    v_add_u32 v34, 4, v34
    global_load_lds_dword v34, s[96:97]
    s_add_u32 s75, s75, 32768
    s_cmp_eq_u32 s75, s74
    s_cselect_b32 s3, 0x18000, 0
    s_sub_u32 s75, s75, s3
    s_mov_b32 s9, 4
.Lld_5:
    s_mov_b32 s66, s10
    s_add_u32 s10, s10, 32768
    s_barrier
    s_mov_b32 m0, s75
    s_nop 0
    buffer_load_dwordx4 v24, s[28:31], s66 offen offset:0 lds
    buffer_load_dwordx4 v25, s[28:31], s66 offen offset:1024 lds
    buffer_load_dwordx4 v26, s[28:31], s66 offen offset:2048 lds
    buffer_load_dwordx4 v27, s[28:31], s66 offen offset:3072 lds
    s_add_u32 m0, s75, 16384
    s_add_u32 s66, s66, 16384
    buffer_load_dwordx4 v24, s[28:31], s66 offen offset:0 lds
    buffer_load_dwordx4 v25, s[28:31], s66 offen offset:1024 lds
    buffer_load_dwordx4 v26, s[28:31], s66 offen offset:2048 lds
    buffer_load_dwordx4 v27, s[28:31], s66 offen offset:3072 lds
    s_mov_b32 m0, s8
    v_add_u32 v34, 4, v34
    global_load_lds_dword v34, s[96:97]
    s_add_u32 s75, s75, 32768
    s_cmp_eq_u32 s75, s74
    s_cselect_b32 s3, 0x18000, 0
    s_sub_u32 s75, s75, s3
    s_sub_u32 s9, s9, 1
    s_cmp_lg_u32 s9, 0
    s_cbranch_scc1 .Lld_5
    s_branch .Ldrain
.Lld_a:
    v_lshrrev_b32 v12, 4, v32
    s_lshr_b32 s3, s94, 1
    s_lshl_b32 s3, s3, 7
    v_xor_b32 v4, s3, v2
    v_xor_b32 v28, 0, v4
    v_xor_b32 v29, 32, v4
    v_xor_b32 v30, 64, v4
    v_xor_b32 v31, 96, v4
    v_and_b32 v4, 7, v32
    v_xor_b32 v4, v4, v12
    v_lshlrev_b32 v4, 4, v4
    v_lshrrev_b32 v7, 3, v32
    v_lshl_add_u32 v36, v7, 10, v4
    v_xor_b32 v37, 64, v36
    s_lshr_b32 s92, s6, 1
    s_and_b32 s39, s6, 1
    s_lshl_b32 s39, s39, 18
    s_mov_b32 s12, s40
    s_mov_b32 s13, s41
    s_mov_b32 s14, 0xc0000
    s_mov_b32 s15, 0x20000
    s_mov_b32 s24, s46
    s_mov_b32 s25, s47
    s_mov_b32 s26, 0x400000
    s_mov_b32 s27, 0x20000
    s_min_u32 s3, s94, 2
    s_lshl_b32 s67, s3, 11
    s_lshl_b32 s3, s3, 14
    s_and_b32 s68, s6, 15
    s_mul_i32 s68, s68, 49152
    s_add_u32 s68, s68, s3
    s_lshl_b32 s72, s5, 10
    s_lshl_b32 s3, s94, 15
    s_add_u32 s72, s72, s3
    v_and_b32 v3, 15, v32
    v_lshrrev_b32 v5, 1, v3
    v_and_b32 v6, 1, v32
    v_lshlrev_b32 v6, 4, v6
    s_and_b32 s3, s94, 1
    s_lshl_b32 s3, s3, 7
    v_xor_b32 v4, v3, v12
    v_lshlrev_b32 v4, 4, v4
    v_lshl_add_u32 v4, v12, 8, v4
    v_xor_b32 v16, 0, v4
    v_xor_b32 v17, 64, v4
    v_xor_b32 v18, 128, v4
    v_xor_b32 v19, 192, v4
    v_xor_b32 v4, v5, v12
    v_lshl_add_u32 v4, v4, 5, v6
    v_lshl_add_u32 v20, v12, 8, v4
    v_xor_b32 v21, 0x80, v20
    v_xor_b32 v4, s3, v2
    v_xor_b32 v24, 0, v4
    v_xor_b32 v25, 32, v4
    v_xor_b32 v26, 64, v4
    v_xor_b32 v27, 96, v4
    s_mul_i32 s93, s6, 1
    s_mul_i32 s3, s5, 3
    s_add_u32 s93, s93, s3
    s_lshl_b32 s93, s93, 14
    s_mov_b32 s16, s42
    s_mov_b32 s17, s43
    s_mov_b32 s18, 0x1000000
    s_mov_b32 s19, 0x20000
    s_mov_b32 s20, s44
    s_mov_b32 s21, s45
    s_mov_b32 s22, 0x1000000
    s_mov_b32 s23, 0x20000
    s_mov_b32 s28, s48
    s_mov_b32 s29, s49
    s_mov_b32 s30, 0x400000
    s_mov_b32 s31, 0x20000
    s_lshl_b32 s3, s94, 12
    s_lshl_b32 s69, s6, 3
    s_add_u32 s69, s69, s5
    s_lshl_b32 s69, s69, 17
    s_add_u32 s69, s69, s3
    s_lshl_b32 s73, s5, 19
    s_add_u32 s73, s73, s3
    s_and_b32 s66, s93, 0x1ffff
    s_add_u32 s66, s66, s69
    s_add_u32 s93, s93, 16384
    s_mov_b32 m0, s75
    s_waitcnt vmcnt(1)
    buffer_load_dwordx4 v16, s[16:19], s66 offen offset:0 nt lds
    s_waitcnt vmcnt(1)
    buffer_load_dwordx4 v17, s[16:19], s66 offen offset:1024 nt lds
    s_waitcnt vmcnt(1)
    buffer_load_dwordx4 v18, s[16:19], s66 offen offset:2048 nt lds
    s_waitcnt vmcnt(1)
    buffer_load_dwordx4 v19, s[16:19], s66 offen offset:3072 nt lds
    s_add_u32 m0, s75, 16384
    s_waitcnt vmcnt(1)
    buffer_load_dwordx4 v20, s[20:23], s66 offen offset:0 nt lds
    s_waitcnt vmcnt(1)
    buffer_load_dwordx4 v21, s[20:23], s66 offen offset:1024 nt lds
    s_waitcnt vmcnt(1)
    buffer_load_dwordx4 v20, s[20:23], s66 offen offset:2048 nt lds
    s_waitcnt vmcnt(1)
    buffer_load_dwordx4 v21, s[20:23], s66 offen offset:3072 nt lds
    s_add_u32 s75, s75, 32768
    s_and_b32 s75, s75, 0x1ffff
    s_and_b32 s66, s93, 0x1ffff
    s_add_u32 s66, s66, s69
    s_add_u32 s93, s93, 16384
    s_mov_b32 m0, s75
    s_nop 0
    buffer_load_dwordx4 v16, s[16:19], s66 offen offset:0 nt lds
    buffer_load_dwordx4 v17, s[16:19], s66 offen offset:1024 nt lds
    buffer_load_dwordx4 v18, s[16:19], s66 offen offset:2048 nt lds
    buffer_load_dwordx4 v19, s[16:19], s66 offen offset:3072 nt lds
    s_add_u32 m0, s75, 16384
    s_nop 0
    buffer_load_dwordx4 v20, s[20:23], s66 offen offset:0 nt lds
    buffer_load_dwordx4 v21, s[20:23], s66 offen offset:1024 nt lds
    buffer_load_dwordx4 v20, s[20:23], s66 offen offset:2048 nt lds
    buffer_load_dwordx4 v21, s[20:23], s66 offen offset:3072 nt lds
    s_add_u32 s75, s75, 32768
    s_and_b32 s75, s75, 0x1ffff
    s_lshl_b32 s10, s92, 19
    s_lshl_b32 s92, s92, 7
    s_add_u32 s66, s92, 0
    s_and_b32 s66, s66, 1023
    s_add_u32 s66, s66, s68
    s_add_u32 m0, s67, 131072
    s_nop 0
    buffer_load_dwordx4 v36, s[12:15], s66 offen offset:0 lds
    s_add_u32 s66, s66, 7168
    buffer_load_dwordx4 v37, s[12:15], s66 offen offset:1024 lds
    s_xor_b32 s66, s10, s39
    s_add_u32 s66, s66, s72
    s_add_u32 s10, s10, 0x40000
    s_and_b32 s10, s10, 0x3fffff
    s_mov_b32 m0, s75
    s_nop 0
    buffer_load_dwordx4 v28, s[24:27], s66 offen offset:0 nt lds
    s_add_u32 s66, s66, 7168
    buffer_load_dwordx4 v29, s[24:27], s66 offen offset:1024 nt lds
    s_add_u32 s66, s66, 7168
    buffer_load_dwordx4 v30, s[24:27], s66 offen offset:2048 nt lds
    s_add_u32 s66, s66, 7168
    buffer_load_dwordx4 v31, s[24:27], s66 offen offset:3072 nt lds
    s_add_u32 m0, s75, 16384
    s_add_u32 s66, s66, 109568
    buffer_load_dwordx4 v28, s[24:27], s66 offen offset:0 nt lds
    s_add_u32 s66, s66, 7168
    buffer_load_dwordx4 v29, s[24:27], s66 offen offset:1024 nt lds
    s_add_u32 s66, s66, 7168
    buffer_load_dwordx4 v30, s[24:27], s66 offen offset:2048 nt lds
    s_add_u32 s66, s66, 7168
    buffer_load_dwordx4 v31, s[24:27], s66 offen offset:3072 nt lds
    s_barrier
    s_mov_b32 m0, s8
    v_add_u32 v34, 4, v34
    global_load_lds_dword v34, s[96:97]
    s_xor_b32 s75, s75, 0x8000
    s_cmp_lg_u32 s94, 0
    s_cbranch_scc1 .Lcl_6
    v_mov_b32 v41, 0
    s_lshl_b32 s3, s7, 4
    s_lshr_b32 s11, s6, s7
    s_add_u32 s3, s3, s11
    s_lshl_b32 s3, s3, 11
    s_add_u32 s3, s3, 0x1200000
    s_and_b32 s74, s6, s7
    s_lshl_b32 s11, s5, s7
    s_add_u32 s11, s11, s74
    s_lshl_b32 s11, s11, 2
    s_add_u32 s3, s3, s11
    v_lshl_add_u32 v40, v2, 3, s3
    s_mov_b64 exec, 0x1
    global_store_dword v40, v41, s[64:65] sc1
    s_mov_b64 exec, -1
.Lcl_6:
    s_add_u32 s66, s92, 128
    s_and_b32 s66, s66, 1023
    s_add_u32 s66, s66, s68
    s_add_u32 m0, s67, 139264
    s_nop 0
    buffer_load_dwordx4 v36, s[12:15], s66 offen offset:0 lds
    s_add_u32 s66, s66, 7168
    buffer_load_dwordx4 v37, s[12:15], s66 offen offset:1024 lds
    s_add_u32 s66, s92, 256
    s_and_b32 s66, s66, 1023
    s_add_u32 s66, s66, s68
    s_add_u32 m0, s67, 147456
    s_nop 0
    buffer_load_dwordx4 v36, s[12:15], s66 offen offset:0 lds
    s_add_u32 s66, s66, 7168
    buffer_load_dwordx4 v37, s[12:15], s66 offen offset:1024 lds
    s_add_u32 s66, s92, 384
    s_and_b32 s66, s66, 1023
    s_add_u32 s66, s66, s68
    s_add_u32 m0, s67, 155648
    s_nop 0
    buffer_load_dwordx4 v36, s[12:15], s66 offen offset:0 lds
    s_add_u32 s66, s66, 7168
    buffer_load_dwordx4 v37, s[12:15], s66 offen offset:1024 lds
    s_add_u32 s66, s92, 512
    s_and_b32 s66, s66, 1023
    s_add_u32 s66, s66, s68
    buffer_load_dwordx4 v[64:67], v36, s[12:15], s66 offen offset:0
    s_add_u32 s66, s66, 7168
    buffer_load_dwordx4 v[68:71], v37, s[12:15], s66 offen offset:1024
    s_add_u32 s66, s92, 640
    s_and_b32 s66, s66, 1023
    s_add_u32 s66, s66, s68
    buffer_load_dwordx4 v[64:67], v36, s[12:15], s66 offen offset:0
    s_add_u32 s66, s66, 7168
    buffer_load_dwordx4 v[68:71], v37, s[12:15], s66 offen offset:1024
    s_add_u32 s66, s92, 768
    s_and_b32 s66, s66, 1023
    s_add_u32 s66, s66, s68
    buffer_load_dwordx4 v[64:67], v36, s[12:15], s66 offen offset:0
    s_add_u32 s66, s66, 7168
    buffer_load_dwordx4 v[68:71], v37, s[12:15], s66 offen offset:1024
    s_add_u32 s66, s92, 896
    s_and_b32 s66, s66, 1023
    s_add_u32 s66, s66, s68
    buffer_load_dwordx4 v[64:67], v36, s[12:15], s66 offen offset:0
    s_add_u32 s66, s66, 7168
    buffer_load_dwordx4 v[68:71], v37, s[12:15], s66 offen offset:1024
    s_xor_b32 s66, s10, s39
    s_add_u32 s66, s66, s72
    s_add_u32 s10, s10, 0x40000
    s_and_b32 s10, s10, 0x3fffff
    s_mov_b32 m0, s75
    s_nop 0
    buffer_load_dwordx4 v28, s[24:27], s66 offen offset:0 lds
    s_add_u32 s66, s66, 7168
    buffer_load_dwordx4 v29, s[24:27], s66 offen offset:1024 lds
    s_add_u32 s66, s66, 7168
    buffer_load_dwordx4 v30, s[24:27], s66 offen offset:2048 lds
    s_add_u32 s66, s66, 7168
    buffer_load_dwordx4 v31, s[24:27], s66 offen offset:3072 lds
    s_add_u32 m0, s75, 16384
    s_add_u32 s66, s66, 109568
    buffer_load_dwordx4 v28, s[24:27], s66 offen offset:0 lds
    s_add_u32 s66, s66, 7168
    buffer_load_dwordx4 v29, s[24:27], s66 offen offset:1024 lds
    s_add_u32 s66, s66, 7168
    buffer_load_dwordx4 v30, s[24:27], s66 offen offset:2048 lds
    s_add_u32 s66, s66, 7168
    buffer_load_dwordx4 v31, s[24:27], s66 offen offset:3072 lds
    s_mov_b32 m0, s8
    v_add_u32 v34, 4, v34
    global_load_lds_dword v34, s[96:97]
    s_xor_b32 s75, s75, 0x8000
    s_mov_b32 s32, s58
    s_mov_b32 s33, s59
    s_mov_b32 s34, 0x400000
    s_mov_b32 s35, 0x20000
    s_lshl_b32 s3, s6, 2
    s_add_u32 s3, s3, s94
    s_lshl_b32 s3, s3, 13
    s_lshl_b32 s66, s5, 19
    s_add_u32 s66, s66, s3
    buffer_load_dwordx4 v[64:67], v2, s[32:35], s66 offen offset:0
    buffer_load_dwordx4 v[68:71], v2, s[32:35], s66 offen offset:1024
    buffer_load_dwordx4 v[72:75], v2, s[32:35], s66 offen offset:2048
    buffer_load_dwordx4 v[76:79], v2, s[32:35], s66 offen offset:3072
    s_add_u32 s66, s66, 4096
    buffer_load_dwordx4 v[80:83], v2, s[32:35], s66 offen offset:0
    buffer_load_dwordx4 v[84:87], v2, s[32:35], s66 offen offset:1024
    buffer_load_dwordx4 v[88:91], v2, s[32:35], s66 offen offset:2048
    buffer_load_dwordx4 v[92:95], v2, s[32:35], s66 offen offset:3072
    s_mov_b32 s32, s48
    s_mov_b32 s33, s49
    s_mov_b32 s34, 0x400000
    s_mov_b32 s35, 0x20000
    s_lshl_b32 s3, s6, 2
    s_add_u32 s3, s3, s94
    s_lshl_b32 s3, s3, 13
    s_lshl_b32 s66, s5, 19
    s_add_u32 s66, s66, s3
    buffer_load_dwordx4 v[64:67], v2, s[32:35], s66 offen offset:0
    buffer_load_dwordx4 v[68:71], v2, s[32:35], s66 offen offset:1024
    buffer_load_dwordx4 v[72:75], v2, s[32:35], s66 offen offset:2048
    buffer_load_dwordx4 v[76:79], v2, s[32:35], s66 offen offset:3072
    s_add_u32 s66, s66, 4096
    buffer_load_dwordx4 v[80:83], v2, s[32:35], s66 offen offset:0
    buffer_load_dwordx4 v[84:87], v2, s[32:35], s66 offen offset:1024
    buffer_load_dwordx4 v[88:91], v2, s[32:35], s66 offen offset:2048
    buffer_load_dwordx4 v[92:95], v2, s[32:35], s66 offen offset:3072
    s_barrier
    s_xor_b32 s66, s10, s39
    s_add_u32 s66, s66, s72
    s_add_u32 s10, s10, 0x40000
    s_and_b32 s10, s10, 0x3fffff
    s_mov_b32 m0, s75
    s_nop 0
    buffer_load_dwordx4 v28, s[24:27], s66 offen offset:0 lds
    s_add_u32 s66, s66, 7168
    buffer_load_dwordx4 v29, s[24:27], s66 offen offset:1024 lds
    s_add_u32 s66, s66, 7168
    buffer_load_dwordx4 v30, s[24:27], s66 offen offset:2048 lds
    s_add_u32 s66, s66, 7168
    buffer_load_dwordx4 v31, s[24:27], s66 offen offset:3072 lds
    s_add_u32 m0, s75, 16384
    s_add_u32 s66, s66, 109568
    buffer_load_dwordx4 v28, s[24:27], s66 offen offset:0 lds
    s_add_u32 s66, s66, 7168
    buffer_load_dwordx4 v29, s[24:27], s66 offen offset:1024 lds
    s_add_u32 s66, s66, 7168
    buffer_load_dwordx4 v30, s[24:27], s66 offen offset:2048 lds
    s_add_u32 s66, s66, 7168
    buffer_load_dwordx4 v31, s[24:27], s66 offen offset:3072 lds
    s_mov_b32 m0, s8
    v_add_u32 v34, 4, v34
    global_load_lds_dword v34, s[96:97]
    s_xor_b32 s75, s75, 0x8000
    s_barrier
    s_xor_b32 s66, s10, s39
    s_add_u32 s66, s66, s72
    s_add_u32 s10, s10, 0x40000
    s_and_b32 s10, s10, 0x3fffff
    s_mov_b32 m0, s75
    s_nop 0
    buffer_load_dwordx4 v28, s[24:27], s66 offen offset:0 lds
    s_add_u32 s66, s66, 7168
    buffer_load_dwordx4 v29, s[24:27], s66 offen offset:1024 lds
    s_add_u32 s66, s66, 7168
    buffer_load_dwordx4 v30, s[24:27], s66 offen offset:2048 lds
    s_add_u32 s66, s66, 7168
    buffer_load_dwordx4 v31, s[24:27], s66 offen offset:3072 lds
    s_add_u32 m0, s75, 16384
    s_add_u32 s66, s66, 109568
    buffer_load_dwordx4 v28, s[24:27], s66 offen offset:0 lds
    s_add_u32 s66, s66, 7168
    buffer_load_dwordx4 v29, s[24:27], s66 offen offset:1024 lds
    s_add_u32 s66, s66, 7168
    buffer_load_dwordx4 v30, s[24:27], s66 offen offset:2048 lds
    s_add_u32 s66, s66, 7168
    buffer_load_dwordx4 v31, s[24:27], s66 offen offset:3072 lds
    s_mov_b32 m0, s8
    v_add_u32 v34, 4, v34
    global_load_lds_dword v34, s[96:97]
    s_xor_b32 s75, s75, 0x8000
    s_barrier
    s_cmp_lg_u32 s94, 0
    s_cbranch_scc1 .Lcc_7
    v_mov_b32 v42, 0
    v_mov_b32 v43, 1
    s_waitcnt vmcnt(8)
    s_mov_b64 exec, 1
    global_atomic_add v42, v43, s[62:63] sc1
    s_mov_b64 exec, -1
.Lcc_7:
    s_xor_b32 s66, s10, s39
    s_add_u32 s66, s66, s72
    s_add_u32 s10, s10, 0x40000
    s_and_b32 s10, s10, 0x3fffff
    s_mov_b32 m0, s75
    s_nop 0
    buffer_load_dwordx4 v28, s[24:27], s66 offen offset:0 lds
    s_add_u32 s66, s66, 7168
    buffer_load_dwordx4 v29, s[24:27], s66 offen offset:1024 lds
    s_add_u32 s66, s66, 7168
    buffer_load_dwordx4 v30, s[24:27], s66 offen offset:2048 lds
    s_add_u32 s66, s66, 7168
    buffer_load_dwordx4 v31, s[24:27], s66 offen offset:3072 lds
    s_add_u32 m0, s75, 16384
    s_add_u32 s66, s66, 109568
    buffer_load_dwordx4 v28, s[24:27], s66 offen offset:0 lds
    s_add_u32 s66, s66, 7168
    buffer_load_dwordx4 v29, s[24:27], s66 offen offset:1024 lds
    s_add_u32 s66, s66, 7168
    buffer_load_dwordx4 v30, s[24:27], s66 offen offset:2048 lds
    s_add_u32 s66, s66, 7168
    buffer_load_dwordx4 v31, s[24:27], s66 offen offset:3072 lds
    s_mov_b32 m0, s8
    v_add_u32 v34, 4, v34
    global_load_lds_dword v34, s[96:97]
    s_xor_b32 s75, s75, 0x8000
    s_barrier
    s_xor_b32 s66, s10, s39
    s_add_u32 s66, s66, s72
    s_add_u32 s10, s10, 0x40000
    s_and_b32 s10, s10, 0x3fffff
    s_mov_b32 m0, s75
    s_nop 0
    buffer_load_dwordx4 v28, s[24:27], s66 offen offset:0 lds
    s_add_u32 s66, s66, 7168
    buffer_load_dwordx4 v29, s[24:27], s66 offen offset:1024 lds
    s_add_u32 s66, s66, 7168
    buffer_load_dwordx4 v30, s[24:27], s66 offen offset:2048 lds
    s_add_u32 s66, s66, 7168
    buffer_load_dwordx4 v31, s[24:27], s66 offen offset:3072 lds
    s_add_u32 m0, s75, 16384
    s_add_u32 s66, s66, 109568
    buffer_load_dwordx4 v28, s[24:27], s66 offen offset:0 lds
    s_add_u32 s66, s66, 7168
    buffer_load_dwordx4 v29, s[24:27], s66 offen offset:1024 lds
    s_add_u32 s66, s66, 7168
    buffer_load_dwordx4 v30, s[24:27], s66 offen offset:2048 lds
    s_add_u32 s66, s66, 7168
    buffer_load_dwordx4 v31, s[24:27], s66 offen offset:3072 lds
    s_mov_b32 m0, s8
    v_add_u32 v34, 4, v34
    global_load_lds_dword v34, s[96:97]
    s_xor_b32 s75, s75, 0x8000
    s_barrier
    s_xor_b32 s66, s10, s39
    s_add_u32 s66, s66, s72
    s_add_u32 s10, s10, 0x40000
    s_and_b32 s10, s10, 0x3fffff
    s_mov_b32 m0, s75
    s_nop 0
    buffer_load_dwordx4 v28, s[24:27], s66 offen offset:0 lds
    s_add_u32 s66, s66, 7168
    buffer_load_dwordx4 v29, s[24:27], s66 offen offset:1024 lds
    s_add_u32 s66, s66, 7168
    buffer_load_dwordx4 v30, s[24:27], s66 offen offset:2048 lds
    s_add_u32 s66, s66, 7168
    buffer_load_dwordx4 v31, s[24:27], s66 offen offset:3072 lds
    s_add_u32 m0, s75, 16384
    s_add_u32 s66, s66, 109568
    buffer_load_dwordx4 v28, s[24:27], s66 offen offset:0 lds
    s_add_u32 s66, s66, 7168
    buffer_load_dwordx4 v29, s[24:27], s66 offen offset:1024 lds
    s_add_u32 s66, s66, 7168
    buffer_load_dwordx4 v30, s[24:27], s66 offen offset:2048 lds
    s_add_u32 s66, s66, 7168
    buffer_load_dwordx4 v31, s[24:27], s66 offen offset:3072 lds
    s_mov_b32 m0, s8
    v_add_u32 v34, 4, v34
    global_load_lds_dword v34, s[96:97]
    s_xor_b32 s75, s75, 0x8000
    s_barrier
    s_xor_b32 s66, s10, s39
    s_add_u32 s66, s66, s72
    s_add_u32 s10, s10, 0x40000
    s_and_b32 s10, s10, 0x3fffff
    s_mov_b32 m0, s75
    s_nop 0
    buffer_load_dwordx4 v28, s[24:27], s66 offen offset:0 lds
    s_add_u32 s66, s66, 7168
    buffer_load_dwordx4 v29, s[24:27], s66 offen offset:1024 lds
    s_add_u32 s66, s66, 7168
    buffer_load_dwordx4 v30, s[24:27], s66 offen offset:2048 lds
    s_add_u32 s66, s66, 7168
    buffer_load_dwordx4 v31, s[24:27], s66 offen offset:3072 lds
    s_add_u32 m0, s75, 16384
    s_add_u32 s66, s66, 109568
    buffer_load_dwordx4 v28, s[24:27], s66 offen offset:0 lds
    s_add_u32 s66, s66, 7168
    buffer_load_dwordx4 v29, s[24:27], s66 offen offset:1024 lds
    s_add_u32 s66, s66, 7168
    buffer_load_dwordx4 v30, s[24:27], s66 offen offset:2048 lds
    s_add_u32 s66, s66, 7168
    buffer_load_dwordx4 v31, s[24:27], s66 offen offset:3072 lds
    s_mov_b32 m0, s8
    v_add_u32 v34, 4, v34
    global_load_lds_dword v34, s[96:97]
    s_xor_b32 s75, s75, 0x8000
    s_barrier
    s_add_u32 s66, s92, 512
    s_and_b32 s66, s66, 1023
    s_add_u32 s66, s66, s68
    s_add_u32 m0, s67, 131072
    s_nop 0
    buffer_load_dwordx4 v36, s[12:15], s66 offen offset:0 lds
    s_add_u32 s66, s66, 7168
    buffer_load_dwordx4 v37, s[12:15], s66 offen offset:1024 lds
    s_add_u32 s66, s92, 640
    s_and_b32 s66, s66, 1023
    s_add_u32 s66, s66, s68
    s_add_u32 m0, s67, 139264
    s_nop 0
    buffer_load_dwordx4 v36, s[12:15], s66 offen offset:0 lds
    s_add_u32 s66, s66, 7168
    buffer_load_dwordx4 v37, s[12:15], s66 offen offset:1024 lds
    s_xor_b32 s66, s10, s39
    s_add_u32 s66, s66, s72
    s_add_u32 s10, s10, 0x40000
    s_and_b32 s10, s10, 0x3fffff
    s_mov_b32 m0, s75
    s_nop 0
    buffer_load_dwordx4 v28, s[24:27], s66 offen offset:0 lds
    s_add_u32 s66, s66, 7168
    buffer_load_dwordx4 v29, s[24:27], s66 offen offset:1024 lds
    s_add_u32 s66, s66, 7168
    buffer_load_dwordx4 v30, s[24:27], s66 offen offset:2048 lds
    s_add_u32 s66, s66, 7168
    buffer_load_dwordx4 v31, s[24:27], s66 offen offset:3072 lds
    s_add_u32 m0, s75, 16384
    s_add_u32 s66, s66, 109568
    buffer_load_dwordx4 v28, s[24:27], s66 offen offset:0 lds
    s_add_u32 s66, s66, 7168
    buffer_load_dwordx4 v29, s[24:27], s66 offen offset:1024 lds
    s_add_u32 s66, s66, 7168
    buffer_load_dwordx4 v30, s[24:27], s66 offen offset:2048 lds
    s_add_u32 s66, s66, 7168
    buffer_load_dwordx4 v31, s[24:27], s66 offen offset:3072 lds
    s_mov_b32 m0, s8
    v_add_u32 v34, 4, v34
    global_load_lds_dword v34, s[96:97]
    s_xor_b32 s75, s75, 0x8000
    s_mov_b32 s9, 3
.Lld_8:
    s_barrier
    s_xor_b32 s66, s10, s39
    s_add_u32 s66, s66, s72
    s_add_u32 s10, s10, 0x40000
    s_and_b32 s10, s10, 0x3fffff
    s_mov_b32 m0, s75
    s_nop 0
    buffer_load_dwordx4 v28, s[24:27], s66 offen offset:0 lds
    s_add_u32 s66, s66, 7168
    buffer_load_dwordx4 v29, s[24:27], s66 offen offset:1024 lds
    s_add_u32 s66, s66, 7168
    buffer_load_dwordx4 v30, s[24:27], s66 offen offset:2048 lds
    s_add_u32 s66, s66, 7168
    buffer_load_dwordx4 v31, s[24:27], s66 offen offset:3072 lds
    s_add_u32 m0, s75, 16384
    s_add_u32 s66, s66, 109568
    buffer_load_dwordx4 v28, s[24:27], s66 offen offset:0 lds
    s_add_u32 s66, s66, 7168
    buffer_load_dwordx4 v29, s[24:27], s66 offen offset:1024 lds
    s_add_u32 s66, s66, 7168
    buffer_load_dwordx4 v30, s[24:27], s66 offen offset:2048 lds
    s_add_u32 s66, s66, 7168
    buffer_load_dwordx4 v31, s[24:27], s66 offen offset:3072 lds
    s_mov_b32 m0, s8
    v_add_u32 v34, 4, v34
    global_load_lds_dword v34, s[96:97]
    s_xor_b32 s75, s75, 0x8000
    s_sub_u32 s9, s9, 1
    s_cmp_lg_u32 s9, 0
    s_cbranch_scc1 .Lld_8
    s_barrier
    s_add_u32 s66, s92, 768
    s_and_b32 s66, s66, 1023
    s_add_u32 s66, s66, s68
    s_add_u32 m0, s67, 147456
    s_nop 0
    buffer_load_dwordx4 v36, s[12:15], s66 offen offset:0 lds
    s_add_u32 s66, s66, 7168
    buffer_load_dwordx4 v37, s[12:15], s66 offen offset:1024 lds
    s_add_u32 s66, s92, 896
    s_and_b32 s66, s66, 1023
    s_add_u32 s66, s66, s68
    s_add_u32 m0, s67, 155648
    s_nop 0
    buffer_load_dwordx4 v36, s[12:15], s66 offen offset:0 lds
    s_add_u32 s66, s66, 7168
    buffer_load_dwordx4 v37, s[12:15], s66 offen offset:1024 lds
    s_xor_b32 s66, s10, s39
    s_add_u32 s66, s66, s72
    s_add_u32 s10, s10, 0x40000
    s_and_b32 s10, s10, 0x3fffff
    s_mov_b32 m0, s75
    s_nop 0
    buffer_load_dwordx4 v28, s[24:27], s66 offen offset:0 lds
    s_add_u32 s66, s66, 7168
    buffer_load_dwordx4 v29, s[24:27], s66 offen offset:1024 lds
    s_add_u32 s66, s66, 7168
    buffer_load_dwordx4 v30, s[24:27], s66 offen offset:2048 lds
    s_add_u32 s66, s66, 7168
    buffer_load_dwordx4 v31, s[24:27], s66 offen offset:3072 lds
    s_add_u32 m0, s75, 16384
    s_add_u32 s66, s66, 109568
    buffer_load_dwordx4 v28, s[24:27], s66 offen offset:0 lds
    s_add_u32 s66, s66, 7168
    buffer_load_dwordx4 v29, s[24:27], s66 offen offset:1024 lds
    s_add_u32 s66, s66, 7168
    buffer_load_dwordx4 v30, s[24:27], s66 offen offset:2048 lds
    s_add_u32 s66, s66, 7168
    buffer_load_dwordx4 v31, s[24:27], s66 offen offset:3072 lds
    s_mov_b32 m0, s8
    v_add_u32 v34, 4, v34
    global_load_lds_dword v34, s[96:97]
    s_xor_b32 s75, s75, 0x8000
    s_mov_b32 s9, 3
.Lld_9:
    s_barrier
    s_xor_b32 s66, s10, s39
    s_add_u32 s66, s66, s72
    s_add_u32 s10, s10, 0x40000
    s_and_b32 s10, s10, 0x3fffff
    s_mov_b32 m0, s75
    s_nop 0
    buffer_load_dwordx4 v28, s[24:27], s66 offen offset:0 lds
    s_add_u32 s66, s66, 7168
    buffer_load_dwordx4 v29, s[24:27], s66 offen offset:1024 lds
    s_add_u32 s66, s66, 7168
    buffer_load_dwordx4 v30, s[24:27], s66 offen offset:2048 lds
    s_add_u32 s66, s66, 7168
    buffer_load_dwordx4 v31, s[24:27], s66 offen offset:3072 lds
    s_add_u32 m0, s75, 16384
    s_add_u32 s66, s66, 109568
    buffer_load_dwordx4 v28, s[24:27], s66 offen offset:0 lds
    s_add_u32 s66, s66, 7168
    buffer_load_dwordx4 v29, s[24:27], s66 offen offset:1024 lds
    s_add_u32 s66, s66, 7168
    buffer_load_dwordx4 v30, s[24:27], s66 offen offset:2048 lds
    s_add_u32 s66, s66, 7168
    buffer_load_dwordx4 v31, s[24:27], s66 offen offset:3072 lds
    s_mov_b32 m0, s8
    v_add_u32 v34, 4, v34
    global_load_lds_dword v34, s[96:97]
    s_xor_b32 s75, s75, 0x8000
    s_sub_u32 s9, s9, 1
    s_cmp_lg_u32 s9, 0
    s_cbranch_scc1 .Lld_9
    s_mov_b32 m0, s8
    v_add_u32 v34, 32, v34
    global_load_lds_dword v34, s[96:97]
    s_barrier
    s_and_b32 s66, s93, 0x1ffff
    s_add_u32 s66, s66, s69
    s_add_u32 s93, s93, 16384
    s_barrier
    s_mov_b32 m0, s75
    s_waitcnt vmcnt(2)
    buffer_load_dwordx4 v16, s[16:19], s66 offen offset:0 nt lds
    s_waitcnt vmcnt(2)
    buffer_load_dwordx4 v17, s[16:19], s66 offen offset:1024 nt lds
    s_waitcnt vmcnt(2)
    buffer_load_dwordx4 v18, s[16:19], s66 offen offset:2048 nt lds
    s_waitcnt vmcnt(2)
    buffer_load_dwordx4 v19, s[16:19], s66 offen offset:3072 nt lds
    s_add_u32 m0, s75, 16384
    s_waitcnt vmcnt(2)
    buffer_load_dwordx4 v20, s[20:23], s66 offen offset:0 nt lds
    s_waitcnt vmcnt(2)
    buffer_load_dwordx4 v21, s[20:23], s66 offen offset:1024 nt lds
    s_waitcnt vmcnt(2)
    buffer_load_dwordx4 v20, s[20:23], s66 offen offset:2048 nt lds
    s_waitcnt vmcnt(2)
    buffer_load_dwordx4 v21, s[20:23], s66 offen offset:3072 nt lds
    s_mov_b32 m0, s8
    v_add_u32 v34, 16, v34
    global_load_lds_dword v34, s[96:97]
    s_add_u32 s75, s75, 32768
    s_and_b32 s75, s75, 0x1ffff
    s_and_b32 s66, s93, 0x1ffff
    s_add_u32 s66, s66, s69
    s_add_u32 s93, s93, 16384
    s_barrier
    s_mov_b32 m0, s75
    s_waitcnt vmcnt(2)
    buffer_load_dwordx4 v16, s[16:19], s66 offen offset:0 nt lds
    s_waitcnt vmcnt(2)
    buffer_load_dwordx4 v17, s[16:19], s66 offen offset:1024 nt lds
    s_waitcnt vmcnt(2)
    buffer_load_dwordx4 v18, s[16:19], s66 offen offset:2048 nt lds
    s_waitcnt vmcnt(2)
    buffer_load_dwordx4 v19, s[16:19], s66 offen offset:3072 nt lds
    s_add_u32 m0, s75, 16384
    s_waitcnt vmcnt(2)
    buffer_load_dwordx4 v20, s[20:23], s66 offen offset:0 nt lds
    s_waitcnt vmcnt(2)
    buffer_load_dwordx4 v21, s[20:23], s66 offen offset:1024 nt lds
    s_waitcnt vmcnt(2)
    buffer_load_dwordx4 v20, s[20:23], s66 offen offset:2048 nt lds
    s_waitcnt vmcnt(2)
    buffer_load_dwordx4 v21, s[20:23], s66 offen offset:3072 nt lds
    s_mov_b32 m0, s8
    v_add_u32 v34, 16, v34
    global_load_lds_dword v34, s[96:97]
    s_add_u32 s75, s75, 32768
    s_and_b32 s75, s75, 0x1ffff
    s_and_b32 s66, s93, 0x1ffff
    s_add_u32 s66, s66, s69
    s_add_u32 s93, s93, 16384
    s_barrier
    s_mov_b32 m0, s75
    s_waitcnt vmcnt(2)
    buffer_load_dwordx4 v16, s[16:19], s66 offen offset:0 nt lds
    s_waitcnt vmcnt(2)
    buffer_load_dwordx4 v17, s[16:19], s66 offen offset:1024 nt lds
    s_waitcnt vmcnt(2)
    buffer_load_dwordx4 v18, s[16:19], s66 offen offset:2048 nt lds
    s_waitcnt vmcnt(2)
    buffer_load_dwordx4 v19, s[16:19], s66 offen offset:3072 nt lds
    s_add_u32 m0, s75, 16384
    s_waitcnt vmcnt(2)
    buffer_load_dwordx4 v20, s[20:23], s66 offen offset:0 nt lds
    s_waitcnt vmcnt(2)
    buffer_load_dwordx4 v21, s[20:23], s66 offen offset:1024 nt lds
    s_waitcnt vmcnt(2)
    buffer_load_dwordx4 v20, s[20:23], s66 offen offset:2048 nt lds
    s_waitcnt vmcnt(2)
    buffer_load_dwordx4 v21, s[20:23], s66 offen offset:3072 nt lds
    s_mov_b32 m0, s8
    v_add_u32 v34, 16, v34
    global_load_lds_dword v34, s[96:97]
    s_add_u32 s75, s75, 32768
    s_and_b32 s75, s75, 0x1ffff
    s_and_b32 s66, s93, 0x1ffff
    s_add_u32 s66, s66, s69
    s_add_u32 s93, s93, 16384
    s_barrier
    s_mov_b32 m0, s75
    s_waitcnt vmcnt(2)
    buffer_load_dwordx4 v16, s[16:19], s66 offen offset:0 nt lds
    s_waitcnt vmcnt(2)
    buffer_load_dwordx4 v17, s[16:19], s66 offen offset:1024 nt lds
    s_waitcnt vmcnt(2)
    buffer_load_dwordx4 v18, s[16:19], s66 offen offset:2048 nt lds
    s_waitcnt vmcnt(2)
    buffer_load_dwordx4 v19, s[16:19], s66 offen offset:3072 nt lds
    s_add_u32 m0, s75, 16384
    s_waitcnt vmcnt(2)
    buffer_load_dwordx4 v20, s[20:23], s66 offen offset:0 nt lds
    s_waitcnt vmcnt(2)
    buffer_load_dwordx4 v21, s[20:23], s66 offen offset:1024 nt lds
    s_waitcnt vmcnt(2)
    buffer_load_dwordx4 v20, s[20:23], s66 offen offset:2048 nt lds
    s_waitcnt vmcnt(2)
    buffer_load_dwordx4 v21, s[20:23], s66 offen offset:3072 nt lds
    s_mov_b32 m0, s8
    v_add_u32 v34, 16, v34
    global_load_lds_dword v34, s[96:97]
    s_add_u32 s75, s75, 32768
    s_and_b32 s75, s75, 0x1ffff
    s_and_b32 s66, s93, 0x1ffff
    s_add_u32 s66, s66, s69
    s_add_u32 s93, s93, 16384
    s_barrier
    s_mov_b32 m0, s75
    s_waitcnt vmcnt(2)
    buffer_load_dwordx4 v16, s[16:19], s66 offen offset:0 nt lds
    s_waitcnt vmcnt(2)
    buffer_load_dwordx4 v17, s[16:19], s66 offen offset:1024 nt lds
    s_waitcnt vmcnt(2)
    buffer_load_dwordx4 v18, s[16:19], s66 offen offset:2048 nt lds
    s_waitcnt vmcnt(2)
    buffer_load_dwordx4 v19, s[16:19], s66 offen offset:3072 nt lds
    s_add_u32 m0, s75, 16384
    s_waitcnt vmcnt(2)
    buffer_load_dwordx4 v20, s[20:23], s66 offen offset:0 nt lds
    s_waitcnt vmcnt(2)
    buffer_load_dwordx4 v21, s[20:23], s66 offen offset:1024 nt lds
    s_waitcnt vmcnt(2)
    buffer_load_dwordx4 v20, s[20:23], s66 offen offset:2048 nt lds
    s_waitcnt vmcnt(2)
    buffer_load_dwordx4 v21, s[20:23], s66 offen offset:3072 nt lds
    s_mov_b32 m0, s8
    v_add_u32 v34, 16, v34
    global_load_lds_dword v34, s[96:97]
    s_add_u32 s75, s75, 32768
    s_and_b32 s75, s75, 0x1ffff
    s_mov_b32 s32, s48
    s_mov_b32 s33, s49
    s_mov_b32 s34, 0x400000
    s_mov_b32 s35, 0x20000
    s_lshl_b32 s3, s6, 2
    s_add_u32 s3, s3, s94
    s_lshl_b32 s3, s3, 13
    s_lshl_b32 s66, s5, 19
    s_add_u32 s66, s66, s3
    buffer_load_dwordx4 v[64:67], v2, s[32:35], s66 offen offset:0
    buffer_load_dwordx4 v[68:71], v2, s[32:35], s66 offen offset:1024
    buffer_load_dwordx4 v[72:75], v2, s[32:35], s66 offen offset:2048
    buffer_load_dwordx4 v[76:79], v2, s[32:35], s66 offen offset:3072
    s_add_u32 s66, s66, 4096
    buffer_load_dwordx4 v[80:83], v2, s[32:35], s66 offen offset:0
    buffer_load_dwordx4 v[84:87], v2, s[32:35], s66 offen offset:1024
    buffer_load_dwordx4 v[88:91], v2, s[32:35], s66 offen offset:2048
    buffer_load_dwordx4 v[92:95], v2, s[32:35], s66 offen offset:3072
    s_and_b32 s66, s93, 0x1ffff
    s_add_u32 s66, s66, s69
    s_add_u32 s93, s93, 16384
    s_barrier
    s_mov_b32 m0, s75
    s_waitcnt vmcnt(2)
    buffer_load_dwordx4 v16, s[16:19], s66 offen offset:0 nt lds
    s_waitcnt vmcnt(2)
    buffer_load_dwordx4 v17, s[16:19], s66 offen offset:1024 nt lds
    s_waitcnt vmcnt(2)
    buffer_load_dwordx4 v18, s[16:19], s66 offen offset:2048 nt lds
    s_waitcnt vmcnt(2)
    buffer_load_dwordx4 v19, s[16:19], s66 offen offset:3072 nt lds
    s_add_u32 m0, s75, 16384
    s_waitcnt vmcnt(2)
    buffer_load_dwordx4 v20, s[20:23], s66 offen offset:0 nt lds
    s_waitcnt vmcnt(2)
    buffer_load_dwordx4 v21, s[20:23], s66 offen offset:1024 nt lds
    s_waitcnt vmcnt(2)
    buffer_load_dwordx4 v20, s[20:23], s66 offen offset:2048 nt lds
    s_waitcnt vmcnt(2)
    buffer_load_dwordx4 v21, s[20:23], s66 offen offset:3072 nt lds
    s_mov_b32 m0, s8
    v_add_u32 v34, 16, v34
    global_load_lds_dword v34, s[96:97]
    s_add_u32 s75, s75, 32768
    s_and_b32 s75, s75, 0x1ffff
    s_mov_b32 s10, s73
    s_add_u32 s74, s75, 0x18000
    s_mov_b32 s66, s10
    s_add_u32 s10, s10, 32768
    s_mov_b32 m0, s75
    s_nop 0
    buffer_load_dwordx4 v24, s[28:31], s66 offen offset:0 lds
    buffer_load_dwordx4 v25, s[28:31], s66 offen offset:1024 lds
    buffer_load_dwordx4 v26, s[28:31], s66 offen offset:2048 lds
    buffer_load_dwordx4 v27, s[28:31], s66 offen offset:3072 lds
    s_add_u32 m0, s75, 16384
    s_add_u32 s66, s66, 16384
    buffer_load_dwordx4 v24, s[28:31], s66 offen offset:0 lds
    buffer_load_dwordx4 v25, s[28:31], s66 offen offset:1024 lds
    buffer_load_dwordx4 v26, s[28:31], s66 offen offset:2048 lds
    buffer_load_dwordx4 v27, s[28:31], s66 offen offset:3072 lds
    s_mov_b32 m0, s8
    v_add_u32 v34, 4, v34
    global_load_lds_dword v34, s[96:97]
    s_add_u32 s75, s75, 32768
    s_cmp_eq_u32 s75, s74
    s_cselect_b32 s3, 0x18000, 0
    s_sub_u32 s75, s75, s3
    s_mov_b32 s66, s10
    s_add_u32 s10, s10, 32768
    s_barrier
    s_mov_b32 m0, s75
    s_nop 0
    buffer_load_dwordx4 v24, s[28:31], s66 offen offset:0 lds
    buffer_load_dwordx4 v25, s[28:31], s66 offen offset:1024 lds
    buffer_load_dwordx4 v26, s[28:31], s66 offen offset:2048 lds
    buffer_load_dwordx4 v27, s[28:31], s66 offen offset:3072 lds
    s_add_u32 m0, s75, 16384
    s_add_u32 s66, s66, 16384
    buffer_load_dwordx4 v24, s[28:31], s66 offen offset:0 lds
    buffer_load_dwordx4 v25, s[28:31], s66 offen offset:1024 lds
    buffer_load_dwordx4 v26, s[28:31], s66 offen offset:2048 lds
    buffer_load_dwordx4 v27, s[28:31], s66 offen offset:3072 lds
    s_mov_b32 m0, s8
    v_add_u32 v34, 4, v34
    global_load_lds_dword v34, s[96:97]
    s_add_u32 s75, s75, 32768
    s_cmp_eq_u32 s75, s74
    s_cselect_b32 s3, 0x18000, 0
    s_sub_u32 s75, s75, s3
    s_mov_b32 s32, s58
    s_mov_b32 s33, s59
    s_mov_b32 s34, 0x400000
    s_mov_b32 s35, 0x20000
    s_lshl_b32 s3, s6, 2
    s_add_u32 s3, s3, s94
    s_lshl_b32 s3, s3, 13
    s_lshl_b32 s66, s5, 19
    s_add_u32 s66, s66, s3
    buffer_load_dwordx4 v[64:67], v2, s[32:35], s66 offen offset:0
    buffer_load_dwordx4 v[68:71], v2, s[32:35], s66 offen offset:1024
    buffer_load_dwordx4 v[72:75], v2, s[32:35], s66 offen offset:2048
    buffer_load_dwordx4 v[76:79], v2, s[32:35], s66 offen offset:3072
    s_add_u32 s66, s66, 4096
    buffer_load_dwordx4 v[80:83], v2, s[32:35], s66 offen offset:0
    buffer_load_dwordx4 v[84:87], v2, s[32:35], s66 offen offset:1024
    buffer_load_dwordx4 v[88:91], v2, s[32:35], s66 offen offset:2048
    buffer_load_dwordx4 v[92:95], v2, s[32:35], s66 offen offset:3072
    s_mov_b32 s66, s10
    s_add_u32 s10, s10, 32768
    s_barrier
    s_mov_b32 m0, s75
    s_nop 0
    buffer_load_dwordx4 v24, s[28:31], s66 offen offset:0 lds
    buffer_load_dwordx4 v25, s[28:31], s66 offen offset:1024 lds
    buffer_load_dwordx4 v26, s[28:31], s66 offen offset:2048 lds
    buffer_load_dwordx4 v27, s[28:31], s66 offen offset:3072 lds
    s_add_u32 m0, s75, 16384
    s_add_u32 s66, s66, 16384
    buffer_load_dwordx4 v24, s[28:31], s66 offen offset:0 lds
    buffer_load_dwordx4 v25, s[28:31], s66 offen offset:1024 lds
    buffer_load_dwordx4 v26, s[28:31], s66 offen offset:2048 lds
    buffer_load_dwordx4 v27, s[28:31], s66 offen offset:3072 lds
    s_mov_b32 m0, s8
    v_add_u32 v34, 4, v34
    global_load_lds_dword v34, s[96:97]
    s_add_u32 s75, s75, 32768
    s_cmp_eq_u32 s75, s74
    s_cselect_b32 s3, 0x18000, 0
    s_sub_u32 s75, s75, s3
    s_barrier
    s_barrier
    s_mov_b32 s66, s10
    s_add_u32 s10, s10, 32768
    s_barrier
    s_mov_b32 m0, s75
    s_nop 0
    buffer_load_dwordx4 v24, s[28:31], s66 offen offset:0 lds
    buffer_load_dwordx4 v25, s[28:31], s66 offen offset:1024 lds
    buffer_load_dwordx4 v26, s[28:31], s66 offen offset:2048 lds
    buffer_load_dwordx4 v27, s[28:31], s66 offen offset:3072 lds
    s_add_u32 m0, s75, 16384
    s_add_u32 s66, s66, 16384
    buffer_load_dwordx4 v24, s[28:31], s66 offen offset:0 lds
    buffer_load_dwordx4 v25, s[28:31], s66 offen offset:1024 lds
    buffer_load_dwordx4 v26, s[28:31], s66 offen offset:2048 lds
    buffer_load_dwordx4 v27, s[28:31], s66 offen offset:3072 lds
    s_mov_b32 m0, s8
    v_add_u32 v34, 4, v34
    global_load_lds_dword v34, s[96:97]
    s_add_u32 s75, s75, 32768
    s_cmp_eq_u32 s75, s74
    s_cselect_b32 s3, 0x18000, 0
    s_sub_u32 s75, s75, s3
    s_mov_b32 s9, 12
.Lld_10:
    s_mov_b32 s66, s10
    s_add_u32 s10, s10, 32768
    s_barrier
    s_mov_b32 m0, s75
    s_nop 0
    buffer_load_dwordx4 v24, s[28:31], s66 offen offset:0 lds
    buffer_load_dwordx4 v25, s[28:31], s66 offen offset:1024 lds
    buffer_load_dwordx4 v26, s[28:31], s66 offen offset:2048 lds
    buffer_load_dwordx4 v27, s[28:31], s66 offen offset:3072 lds
    s_add_u32 m0, s75, 16384
    s_add_u32 s66, s66, 16384
    buffer_load_dwordx4 v24, s[28:31], s66 offen offset:0 lds
    buffer_load_dwordx4 v25, s[28:31], s66 offen offset:1024 lds
    buffer_load_dwordx4 v26, s[28:31], s66 offen offset:2048 lds
    buffer_load_dwordx4 v27, s[28:31], s66 offen offset:3072 lds
    s_mov_b32 m0, s8
    v_add_u32 v34, 4, v34
    global_load_lds_dword v34, s[96:97]
    s_add_u32 s75, s75, 32768
    s_cmp_eq_u32 s75, s74
    s_cselect_b32 s3, 0x18000, 0
    s_sub_u32 s75, s75, s3
    s_sub_u32 s9, s9, 1
    s_cmp_lg_u32 s9, 0
    s_cbranch_scc1 .Lld_10
.Ldrain:
    s_branch .Lreduce
.Lconsumer:
    global_load_dword v63, v33, s[96:97]
    v_add_u32 v34, 0x8000, v33
    v_min_u32 v34, .Lcode_end-.Lcode_begin-4, v34
    global_load_dword v62, v34, s[96:97]
    s_waitcnt lgkmcnt(0)
    v_lshrrev_b32 v24, 4, v32
    v_bfe_u32 v25, v32, 2, 2
    v_and_b32 v26, 3, v32
    v_and_b32 v27, 15, v32
    v_and_b32 v28, 1, v24
    v_lshl_add_u32 v28, v28, 2, v25
    v_lshlrev_b32 v28, 5, v28
    v_lshl_add_u32 v28, v26, 3, v28
    v_lshl_add_u32 v29, v24, 3, v25
    v_lshl_add_u32 v30, v24, 2, v25
    s_lshl_b32 s3, s4, 8
    s_mul_i32 s11, s4, s7
    s_lshl_b32 s11, s11, 14
    s_sub_u32 s74, 10, s7
    v_lshlrev_b32 v29, s74, v29
    v_add_u32 v3, v29, v28
    v_lshl_add_u32 v4, v30, 8, v28
    v_add_u32 v4, s11, v4
    v_lshl_add_u32 v5, v30, 10, v28
    v_add_u32 v5, s3, v5
    v_xor_b32 v31, v24, v27
    v_lshlrev_b32 v31, 4, v31
    v_lshl_add_u32 v6, v27, 8, v31
    v_add_u32 v6, s11, v6
    v_lshrrev_b32 v31, 1, v27
    v_xor_b32 v31, v24, v31
    v_lshlrev_b32 v31, 4, v31
    v_lshl_add_u32 v31, v27, 7, v31
    v_add_u32 v7, 131072, v31
    s_lshl_b32 s3, s4, 8
    s_add_u32 s3, s3, 137216
    v_lshl_add_u32 v31, v32, 2, s3
    v_mov_b32 v30, 0
    ds_write_b32 v31, v30
    v_and_b32 v1, 3, v32
    v_lshlrev_b32 v1, 8, v1
    v_add_u32 v1, 137216, v1
    s_mov_b32 s36, 0x3e0293ee
    s_mov_b32 s37, 0x3e0293ee
    s_mov_b32 s32, s64
    s_mov_b32 s33, s65
    s_mov_b32 s34, 0x1200000
    s_mov_b32 s35, 0x20000
    s_mov_b32 s85, 0
    s_mov_b32 s86, 0
    s_cmp_eq_u32 s7, 0
    s_cbranch_scc1 .Lcons_a
    s_and_b32 s3, s4, 1
    s_lshl_b32 s3, s3, 8
    v_add_u32 v3, s3, v3
    v_mov_b32 v24, v3
    v_xor_b32 v25, 32, v3
    v_xor_b32 v26, 64, v3
    v_xor_b32 v27, 96, v3
    v_xor_b32 v28, 128, v3
    v_xor_b32 v29, 160, v3
    v_xor_b32 v30, 192, v3
    v_xor_b32 v31, 224, v3
    v_xor_b32 v32, 0x10000, v24
    v_xor_b32 v33, 0x10000, v25
    v_xor_b32 v34, 0x10000, v26
    v_xor_b32 v35, 0x10000, v27
    v_xor_b32 v36, 0x10000, v28
    v_xor_b32 v37, 0x10000, v29
    v_xor_b32 v38, 0x10000, v30
    v_xor_b32 v39, 0x10000, v31
    s_lshr_b32 s3, s4, 1
    s_lshl_b32 s3, s3, 13
    v_add_u32 v40, s3, v7
    v_xor_b32 v41, 64, v40
    v_mov_b32 v160, 0
    v_mov_b32 v161, 0
    v_mov_b32 v162, 0
    v_mov_b32 v163, 0
    v_mov_b32 v164, 0
    v_mov_b32 v165, 0
    v_mov_b32 v166, 0
    v_mov_b32 v167, 0
    v_mov_b32 v168, 0
    v_mov_b32 v169, 0
    v_mov_b32 v170, 0
    v_mov_b32 v171, 0
    v_mov_b32 v172, 0
    v_mov_b32 v173, 0
    v_mov_b32 v174, 0
    v_mov_b32 v175, 0
    v_mov_b32 v176, 0
    v_mov_b32 v177, 0
    v_mov_b32 v178, 0
    v_mov_b32 v179, 0
    v_mov_b32 v180, 0
    v_mov_b32 v181, 0
    v_mov_b32 v182, 0
    v_mov_b32 v183, 0
    v_mov_b32 v184, 0
    v_mov_b32 v185, 0
    v_mov_b32 v186, 0
    v_mov_b32 v187, 0
    v_mov_b32 v188, 0
    v_mov_b32 v189, 0
    v_mov_b32 v190, 0
    v_mov_b32 v191, 0
    v_mov_b32 v192, 0
    v_mov_b32 v193, 0
    v_mov_b32 v194, 0
    v_mov_b32 v195, 0
    v_mov_b32 v196, 0
    v_mov_b32 v197, 0
    v_mov_b32 v198, 0
    v_mov_b32 v199, 0
    v_mov_b32 v200, 0
    v_mov_b32 v201, 0
    v_mov_b32 v202, 0
    v_mov_b32 v203, 0
    v_mov_b32 v204, 0
    v_mov_b32 v205, 0
    v_mov_b32 v206, 0
    v_mov_b32 v207, 0
    v_mov_b32 v208, 0
    v_mov_b32 v209, 0
    v_mov_b32 v210, 0
    v_mov_b32 v211, 0
    v_mov_b32 v212, 0
    v_mov_b32 v213, 0
    v_mov_b32 v214, 0
    v_mov_b32 v215, 0
    v_mov_b32 v216, 0
    v_mov_b32 v217, 0
    v_mov_b32 v218, 0
    v_mov_b32 v219, 0
    v_mov_b32 v220, 0
    v_mov_b32 v221, 0
    v_mov_b32 v222, 0
    v_mov_b32 v223, 0
    v_mov_b32 v224, 0
    v_mov_b32 v225, 0
    v_mov_b32 v226, 0
    v_mov_b32 v227, 0
    v_mov_b32 v228, 0
    v_mov_b32 v229, 0
    v_mov_b32 v230, 0
    v_mov_b32 v231, 0
    v_mov_b32 v232, 0
    v_mov_b32 v233, 0
    v_mov_b32 v234, 0
    v_mov_b32 v235, 0
    v_mov_b32 v236, 0
    v_mov_b32 v237, 0
    v_mov_b32 v238, 0
    v_mov_b32 v239, 0
    v_mov_b32 v240, 0
    v_mov_b32 v241, 0
    v_mov_b32 v242, 0
    v_mov_b32 v243, 0
    v_mov_b32 v244, 0
    v_mov_b32 v245, 0
    v_mov_b32 v246, 0
    v_mov_b32 v247, 0
    v_mov_b32 v248, 0
    v_mov_b32 v249, 0
    v_mov_b32 v250, 0
    v_mov_b32 v251, 0
    v_mov_b32 v252, 0
    v_mov_b32 v253, 0
    v_mov_b32 v254, 0
    v_mov_b32 v255, 0
    s_mov_b32 s9, 0
    s_waitcnt lgkmcnt(0)
    s_barrier
.Lq_loop1:
    s_add_u32 s85, s85, 1
    s_cmp_ge_u32 s86, s85
    s_cbranch_scc0 .Lck_11_s
.Lck_11:
    ds_read_b128 v[96:99], v40 offset:0
    ds_read_b64_tr_b16 v[64:65], v24 offset:0
    ds_read_b64_tr_b16 v[66:67], v24 offset:2048
    ds_read_b128 v[100:103], v40 offset:2048
    ds_read_b128 v[104:107], v40 offset:4096
    ds_read_b64_tr_b16 v[68:69], v25 offset:0
    ds_read_b64_tr_b16 v[70:71], v25 offset:2048
    ds_read_b64_tr_b16 v[72:73], v26 offset:0
    ds_read_b64_tr_b16 v[74:75], v26 offset:2048
    ds_read_b64_tr_b16 v[76:77], v27 offset:0
    ds_read_b64_tr_b16 v[78:79], v27 offset:2048
    ds_read_b64_tr_b16 v[80:81], v28 offset:0
    ds_read_b64_tr_b16 v[82:83], v28 offset:2048
    ds_read_b64_tr_b16 v[84:85], v29 offset:0
    ds_read_b64_tr_b16 v[86:87], v29 offset:2048
    s_waitcnt lgkmcnt(12)
    v_mfma_f32_16x16x32_bf16 v[160:163], v[64:67], v[96:99], v[160:163]
    ds_read_b64_tr_b16 v[88:89], v30 offset:0
    s_waitcnt lgkmcnt(12)
    v_mfma_f32_16x16x32_bf16 v[164:167], v[64:67], v[100:103], v[164:167]
    ds_read_b64_tr_b16 v[90:91], v30 offset:2048
    s_waitcnt lgkmcnt(12)
    v_mfma_f32_16x16x32_bf16 v[168:171], v[64:67], v[104:107], v[168:171]
    ds_read_b64_tr_b16 v[92:93], v31 offset:0
    s_waitcnt lgkmcnt(11)
    v_mfma_f32_16x16x32_bf16 v[172:175], v[68:71], v[96:99], v[172:175]
    ds_read_b64_tr_b16 v[94:95], v31 offset:2048
    ds_read_b128 v[108:111], v41 offset:0
    v_mfma_f32_16x16x32_bf16 v[176:179], v[68:71], v[100:103], v[176:179]
    ds_read_b64_tr_b16 v[64:65], v24 offset:16384
    ds_read_b64_tr_b16 v[66:67], v24 offset:18432
    v_mfma_f32_16x16x32_bf16 v[180:183], v[68:71], v[104:107], v[180:183]
    s_waitcnt lgkmcnt(13)
    v_mfma_f32_16x16x32_bf16 v[184:187], v[72:75], v[96:99], v[184:187]
    ds_read_b128 v[112:115], v41 offset:2048
    ds_read_b128 v[116:119], v41 offset:4096
    v_mfma_f32_16x16x32_bf16 v[188:191], v[72:75], v[100:103], v[188:191]
    v_mfma_f32_16x16x32_bf16 v[192:195], v[72:75], v[104:107], v[192:195]
    s_waitcnt lgkmcnt(8)
    v_mfma_f32_16x16x32_bf16 v[196:199], v[76:79], v[96:99], v[196:199]
    ds_read_b64_tr_b16 v[68:69], v25 offset:16384
    ds_read_b64_tr_b16 v[70:71], v25 offset:18432
    v_mfma_f32_16x16x32_bf16 v[200:203], v[76:79], v[100:103], v[200:203]
    ds_read_b64_tr_b16 v[72:73], v26 offset:16384
    ds_read_b64_tr_b16 v[74:75], v26 offset:18432
    v_mfma_f32_16x16x32_bf16 v[204:207], v[76:79], v[104:107], v[204:207]
    ds_read_b64_tr_b16 v[76:77], v27 offset:16384
    ds_read_b64_tr_b16 v[78:79], v27 offset:18432
    v_mfma_f32_16x16x32_bf16 v[208:211], v[80:83], v[96:99], v[208:211]
    v_mfma_f32_16x16x32_bf16 v[212:215], v[80:83], v[100:103], v[212:215]
    v_mfma_f32_16x16x32_bf16 v[216:219], v[80:83], v[104:107], v[216:219]
    ds_read_b64_tr_b16 v[80:81], v28 offset:16384
    v_mfma_f32_16x16x32_bf16 v[220:223], v[84:87], v[96:99], v[220:223]
    v_mfma_f32_16x16x32_bf16 v[224:227], v[84:87], v[100:103], v[224:227]
    v_mfma_f32_16x16x32_bf16 v[228:231], v[84:87], v[104:107], v[228:231]
    s_waitcnt lgkmcnt(5)
    v_mfma_f32_16x16x32_bf16 v[232:235], v[88:91], v[96:99], v[232:235]
    ds_read_b64_tr_b16 v[82:83], v28 offset:18432
    ds_read_b64_tr_b16 v[84:85], v29 offset:16384
    v_mfma_f32_16x16x32_bf16 v[236:239], v[88:91], v[100:103], v[236:239]
    ds_read_b64_tr_b16 v[86:87], v29 offset:18432
    ds_read_b32 v0, v1
    v_mfma_f32_16x16x32_bf16 v[240:243], v[88:91], v[104:107], v[240:243]
    ds_read_b64_tr_b16 v[88:89], v30 offset:16384
    ds_read_b64_tr_b16 v[90:91], v30 offset:18432
    v_mfma_f32_16x16x32_bf16 v[244:247], v[92:95], v[96:99], v[244:247]
    v_mfma_f32_16x16x32_bf16 v[248:251], v[92:95], v[100:103], v[248:251]
    v_mfma_f32_16x16x32_bf16 v[252:255], v[92:95], v[104:107], v[252:255]
    ds_read_b64_tr_b16 v[92:93], v31 offset:16384
    ds_read_b64_tr_b16 v[94:95], v31 offset:18432
    v_mfma_f32_16x16x32_bf16 v[160:163], v[64:67], v[108:111], v[160:163]
    v_mfma_f32_16x16x32_bf16 v[164:167], v[64:67], v[112:115], v[164:167]
    v_mfma_f32_16x16x32_bf16 v[168:171], v[64:67], v[116:119], v[168:171]
    v_mfma_f32_16x16x32_bf16 v[172:175], v[68:71], v[108:111], v[172:175]
    s_waitcnt lgkmcnt(4)
    v_min_u32_dpp v0, v0, v0 quad_perm:[1,0,3,2] row_mask:0xf bank_mask:0xf
    v_mfma_f32_16x16x32_bf16 v[176:179], v[68:71], v[112:115], v[176:179]
    v_mfma_f32_16x16x32_bf16 v[180:183], v[68:71], v[116:119], v[180:183]
    v_min_u32_dpp v0, v0, v0 quad_perm:[2,3,0,1] row_mask:0xf bank_mask:0xf
    v_mfma_f32_16x16x32_bf16 v[184:187], v[72:75], v[108:111], v[184:187]
    v_readfirstlane_b32 s86, v0
    v_mfma_f32_16x16x32_bf16 v[188:191], v[72:75], v[112:115], v[188:191]
    s_waitcnt lgkmcnt(0)
    s_barrier
    v_mfma_f32_16x16x32_bf16 v[192:195], v[72:75], v[116:119], v[192:195]
    s_add_u32 s85, s85, 1
    s_cmp_ge_u32 s86, s85
    s_cbranch_scc0 .Lck_12_s
.Lck_12:
    ds_read_b128 v[96:99], v40 offset:16384
    v_mfma_f32_16x16x32_bf16 v[196:199], v[76:79], v[108:111], v[196:199]
    ds_read_b64_tr_b16 v[64:65], v24 offset:32768
    ds_read_b64_tr_b16 v[66:67], v24 offset:34816
    v_mfma_f32_16x16x32_bf16 v[200:203], v[76:79], v[112:115], v[200:203]
    ds_read_b128 v[100:103], v40 offset:18432
    ds_read_b128 v[104:107], v40 offset:20480
    v_mfma_f32_16x16x32_bf16 v[204:207], v[76:79], v[116:119], v[204:207]
    ds_read_b64_tr_b16 v[68:69], v25 offset:32768
    ds_read_b64_tr_b16 v[70:71], v25 offset:34816
    v_mfma_f32_16x16x32_bf16 v[208:211], v[80:83], v[108:111], v[208:211]
    ds_read_b64_tr_b16 v[72:73], v26 offset:32768
    ds_read_b64_tr_b16 v[74:75], v26 offset:34816
    v_mfma_f32_16x16x32_bf16 v[212:215], v[80:83], v[112:115], v[212:215]
    ds_read_b64_tr_b16 v[76:77], v27 offset:32768
    ds_read_b64_tr_b16 v[78:79], v27 offset:34816
    v_mfma_f32_16x16x32_bf16 v[216:219], v[80:83], v[116:119], v[216:219]
    ds_read_b64_tr_b16 v[80:81], v28 offset:32768
    ds_read_b64_tr_b16 v[82:83], v28 offset:34816
    v_mfma_f32_16x16x32_bf16 v[220:223], v[84:87], v[108:111], v[220:223]
    v_mfma_f32_16x16x32_bf16 v[224:227], v[84:87], v[112:115], v[224:227]
    v_mfma_f32_16x16x32_bf16 v[228:231], v[84:87], v[116:119], v[228:231]
    ds_read_b64_tr_b16 v[84:85], v29 offset:32768
    ds_read_b64_tr_b16 v[86:87], v29 offset:34816
    v_mfma_f32_16x16x32_bf16 v[232:235], v[88:91], v[108:111], v[232:235]
    v_mfma_f32_16x16x32_bf16 v[236:239], v[88:91], v[112:115], v[236:239]
    v_mfma_f32_16x16x32_bf16 v[240:243], v[88:91], v[116:119], v[240:243]
    v_mfma_f32_16x16x32_bf16 v[244:247], v[92:95], v[108:111], v[244:247]
    v_mfma_f32_16x16x32_bf16 v[248:251], v[92:95], v[112:115], v[248:251]
    v_mfma_f32_16x16x32_bf16 v[252:255], v[92:95], v[116:119], v[252:255]
    s_waitcnt lgkmcnt(2)
    v_mfma_f32_16x16x32_bf16 v[160:163], v[64:67], v[96:99], v[160:163]
    ds_read_b64_tr_b16 v[88:89], v30 offset:32768
    ds_read_b64_tr_b16 v[90:91], v30 offset:34816
    v_mfma_f32_16x16x32_bf16 v[164:167], v[64:67], v[100:103], v[164:167]
    ds_read_b64_tr_b16 v[92:93], v31 offset:32768
    ds_read_b64_tr_b16 v[94:95], v31 offset:34816
    v_mfma_f32_16x16x32_bf16 v[168:171], v[64:67], v[104:107], v[168:171]
    ds_read_b128 v[108:111], v41 offset:16384
    ds_read_b64_tr_b16 v[64:65], v24 offset:49152
    v_mfma_f32_16x16x32_bf16 v[172:175], v[68:71], v[96:99], v[172:175]
    ds_read_b64_tr_b16 v[66:67], v24 offset:51200
    ds_read_b128 v[112:115], v41 offset:18432
    v_mfma_f32_16x16x32_bf16 v[176:179], v[68:71], v[100:103], v[176:179]
    ds_read_b128 v[116:119], v41 offset:20480
    v_mfma_f32_16x16x32_bf16 v[180:183], v[68:71], v[104:107], v[180:183]
    ds_read_b64_tr_b16 v[68:69], v25 offset:49152
    ds_read_b64_tr_b16 v[70:71], v25 offset:51200
    v_mfma_f32_16x16x32_bf16 v[184:187], v[72:75], v[96:99], v[184:187]
    v_mfma_f32_16x16x32_bf16 v[188:191], v[72:75], v[100:103], v[188:191]
    v_mfma_f32_16x16x32_bf16 v[192:195], v[72:75], v[104:107], v[192:195]
    ds_read_b64_tr_b16 v[72:73], v26 offset:49152
    ds_read_b64_tr_b16 v[74:75], v26 offset:51200
    v_mfma_f32_16x16x32_bf16 v[196:199], v[76:79], v[96:99], v[196:199]
    v_mfma_f32_16x16x32_bf16 v[200:203], v[76:79], v[100:103], v[200:203]
    v_mfma_f32_16x16x32_bf16 v[204:207], v[76:79], v[104:107], v[204:207]
    v_mfma_f32_16x16x32_bf16 v[208:211], v[80:83], v[96:99], v[208:211]
    v_mfma_f32_16x16x32_bf16 v[212:215], v[80:83], v[100:103], v[212:215]
    v_mfma_f32_16x16x32_bf16 v[216:219], v[80:83], v[104:107], v[216:219]
    s_waitcnt lgkmcnt(2)
    v_mfma_f32_16x16x32_bf16 v[220:223], v[84:87], v[96:99], v[220:223]
    ds_read_b64_tr_b16 v[76:77], v27 offset:49152
    ds_read_b64_tr_b16 v[78:79], v27 offset:51200
    v_mfma_f32_16x16x32_bf16 v[224:227], v[84:87], v[100:103], v[224:227]
    ds_read_b64_tr_b16 v[80:81], v28 offset:49152
    ds_read_b64_tr_b16 v[82:83], v28 offset:51200
    v_mfma_f32_16x16x32_bf16 v[228:231], v[84:87], v[104:107], v[228:231]
    ds_read_b64_tr_b16 v[84:85], v29 offset:49152
    ds_read_b64_tr_b16 v[86:87], v29 offset:51200
    v_mfma_f32_16x16x32_bf16 v[232:235], v[88:91], v[96:99], v[232:235]
    ds_read_b32 v0, v1
    v_mfma_f32_16x16x32_bf16 v[236:239], v[88:91], v[100:103], v[236:239]
    v_mfma_f32_16x16x32_bf16 v[240:243], v[88:91], v[104:107], v[240:243]
    ds_read_b64_tr_b16 v[88:89], v30 offset:49152
    ds_read_b64_tr_b16 v[90:91], v30 offset:51200
    v_mfma_f32_16x16x32_bf16 v[244:247], v[92:95], v[96:99], v[244:247]
    v_mfma_f32_16x16x32_bf16 v[248:251], v[92:95], v[100:103], v[248:251]
    v_mfma_f32_16x16x32_bf16 v[252:255], v[92:95], v[104:107], v[252:255]
    ds_read_b64_tr_b16 v[92:93], v31 offset:49152
    ds_read_b64_tr_b16 v[94:95], v31 offset:51200
    v_mfma_f32_16x16x32_bf16 v[160:163], v[64:67], v[108:111], v[160:163]
    v_mfma_f32_16x16x32_bf16 v[164:167], v[64:67], v[112:115], v[164:167]
    v_mfma_f32_16x16x32_bf16 v[168:171], v[64:67], v[116:119], v[168:171]
    s_waitcnt lgkmcnt(4)
    v_min_u32_dpp v0, v0, v0 quad_perm:[1,0,3,2] row_mask:0xf bank_mask:0xf
    v_mfma_f32_16x16x32_bf16 v[172:175], v[68:71], v[108:111], v[172:175]
    v_mfma_f32_16x16x32_bf16 v[176:179], v[68:71], v[112:115], v[176:179]
    v_min_u32_dpp v0, v0, v0 quad_perm:[2,3,0,1] row_mask:0xf bank_mask:0xf
    v_mfma_f32_16x16x32_bf16 v[180:183], v[68:71], v[116:119], v[180:183]
    v_readfirstlane_b32 s86, v0
    v_mfma_f32_16x16x32_bf16 v[184:187], v[72:75], v[108:111], v[184:187]
    v_mfma_f32_16x16x32_bf16 v[188:191], v[72:75], v[112:115], v[188:191]
    s_waitcnt lgkmcnt(0)
    s_barrier
    v_mfma_f32_16x16x32_bf16 v[192:195], v[72:75], v[116:119], v[192:195]
    s_add_u32 s85, s85, 1
    s_cmp_ge_u32 s86, s85
    s_cbranch_scc0 .Lck_13_s
.Lck_13:
    ds_read_b128 v[96:99], v40 offset:0
    v_mfma_f32_16x16x32_bf16 v[196:199], v[76:79], v[108:111], v[196:199]
    ds_read_b64_tr_b16 v[64:65], v32 offset:0
    ds_read_b64_tr_b16 v[66:67], v32 offset:2048
    v_mfma_f32_16x16x32_bf16 v[200:203], v[76:79], v[112:115], v[200:203]
    ds_read_b128 v[100:103], v40 offset:2048
    ds_read_b128 v[104:107], v40 offset:4096
    v_mfma_f32_16x16x32_bf16 v[204:207], v[76:79], v[116:119], v[204:207]
    ds_read_b64_tr_b16 v[68:69], v33 offset:0
    ds_read_b64_tr_b16 v[70:71], v33 offset:2048
    v_mfma_f32_16x16x32_bf16 v[208:211], v[80:83], v[108:111], v[208:211]
    ds_read_b64_tr_b16 v[72:73], v34 offset:0
    ds_read_b64_tr_b16 v[74:75], v34 offset:2048
    v_mfma_f32_16x16x32_bf16 v[212:215], v[80:83], v[112:115], v[212:215]
    ds_read_b64_tr_b16 v[76:77], v35 offset:0
    ds_read_b64_tr_b16 v[78:79], v35 offset:2048
    v_mfma_f32_16x16x32_bf16 v[216:219], v[80:83], v[116:119], v[216:219]
    ds_read_b64_tr_b16 v[80:81], v36 offset:0
    ds_read_b64_tr_b16 v[82:83], v36 offset:2048
    v_mfma_f32_16x16x32_bf16 v[220:223], v[84:87], v[108:111], v[220:223]
    v_mfma_f32_16x16x32_bf16 v[224:227], v[84:87], v[112:115], v[224:227]
    v_mfma_f32_16x16x32_bf16 v[228:231], v[84:87], v[116:119], v[228:231]
    ds_read_b64_tr_b16 v[84:85], v37 offset:0
    ds_read_b64_tr_b16 v[86:87], v37 offset:2048
    v_mfma_f32_16x16x32_bf16 v[232:235], v[88:91], v[108:111], v[232:235]
    v_mfma_f32_16x16x32_bf16 v[236:239], v[88:91], v[112:115], v[236:239]
    v_mfma_f32_16x16x32_bf16 v[240:243], v[88:91], v[116:119], v[240:243]
    v_mfma_f32_16x16x32_bf16 v[244:247], v[92:95], v[108:111], v[244:247]
    v_mfma_f32_16x16x32_bf16 v[248:251], v[92:95], v[112:115], v[248:251]
    v_mfma_f32_16x16x32_bf16 v[252:255], v[92:95], v[116:119], v[252:255]
    s_waitcnt lgkmcnt(2)
    v_mfma_f32_16x16x32_bf16 v[160:163], v[64:67], v[96:99], v[160:163]
    ds_read_b64_tr_b16 v[88:89], v38 offset:0
    ds_read_b64_tr_b16 v[90:91], v38 offset:2048
    v_mfma_f32_16x16x32_bf16 v[164:167], v[64:67], v[100:103], v[164:167]
    ds_read_b64_tr_b16 v[92:93], v39 offset:0
    ds_read_b64_tr_b16 v[94:95], v39 offset:2048
    v_mfma_f32_16x16x32_bf16 v[168:171], v[64:67], v[104:107], v[168:171]
    ds_read_b128 v[108:111], v41 offset:0
    ds_read_b64_tr_b16 v[64:65], v32 offset:16384
    v_mfma_f32_16x16x32_bf16 v[172:175], v[68:71], v[96:99], v[172:175]
    ds_read_b64_tr_b16 v[66:67], v32 offset:18432
    ds_read_b128 v[112:115], v41 offset:2048
    v_mfma_f32_16x16x32_bf16 v[176:179], v[68:71], v[100:103], v[176:179]
    ds_read_b128 v[116:119], v41 offset:4096
    v_mfma_f32_16x16x32_bf16 v[180:183], v[68:71], v[104:107], v[180:183]
    ds_read_b64_tr_b16 v[68:69], v33 offset:16384
    ds_read_b64_tr_b16 v[70:71], v33 offset:18432
    v_mfma_f32_16x16x32_bf16 v[184:187], v[72:75], v[96:99], v[184:187]
    v_mfma_f32_16x16x32_bf16 v[188:191], v[72:75], v[100:103], v[188:191]
    v_mfma_f32_16x16x32_bf16 v[192:195], v[72:75], v[104:107], v[192:195]
    ds_read_b64_tr_b16 v[72:73], v34 offset:16384
    ds_read_b64_tr_b16 v[74:75], v34 offset:18432
    v_mfma_f32_16x16x32_bf16 v[196:199], v[76:79], v[96:99], v[196:199]
    v_mfma_f32_16x16x32_bf16 v[200:203], v[76:79], v[100:103], v[200:203]
    v_mfma_f32_16x16x32_bf16 v[204:207], v[76:79], v[104:107], v[204:207]
    v_mfma_f32_16x16x32_bf16 v[208:211], v[80:83], v[96:99], v[208:211]
    v_mfma_f32_16x16x32_bf16 v[212:215], v[80:83], v[100:103], v[212:215]
    v_mfma_f32_16x16x32_bf16 v[216:219], v[80:83], v[104:107], v[216:219]
    s_waitcnt lgkmcnt(2)
    v_mfma_f32_16x16x32_bf16 v[220:223], v[84:87], v[96:99], v[220:223]
    ds_read_b64_tr_b16 v[76:77], v35 offset:16384
    ds_read_b64_tr_b16 v[78:79], v35 offset:18432
    v_mfma_f32_16x16x32_bf16 v[224:227], v[84:87], v[100:103], v[224:227]
    ds_read_b64_tr_b16 v[80:81], v36 offset:16384
    ds_read_b64_tr_b16 v[82:83], v36 offset:18432
    v_mfma_f32_16x16x32_bf16 v[228:231], v[84:87], v[104:107], v[228:231]
    ds_read_b64_tr_b16 v[84:85], v37 offset:16384
    ds_read_b64_tr_b16 v[86:87], v37 offset:18432
    v_mfma_f32_16x16x32_bf16 v[232:235], v[88:91], v[96:99], v[232:235]
    ds_read_b32 v0, v1
    v_mfma_f32_16x16x32_bf16 v[236:239], v[88:91], v[100:103], v[236:239]
    v_mfma_f32_16x16x32_bf16 v[240:243], v[88:91], v[104:107], v[240:243]
    ds_read_b64_tr_b16 v[88:89], v38 offset:16384
    ds_read_b64_tr_b16 v[90:91], v38 offset:18432
    v_mfma_f32_16x16x32_bf16 v[244:247], v[92:95], v[96:99], v[244:247]
    v_mfma_f32_16x16x32_bf16 v[248:251], v[92:95], v[100:103], v[248:251]
    v_mfma_f32_16x16x32_bf16 v[252:255], v[92:95], v[104:107], v[252:255]
    ds_read_b64_tr_b16 v[92:93], v39 offset:16384
    ds_read_b64_tr_b16 v[94:95], v39 offset:18432
    v_mfma_f32_16x16x32_bf16 v[160:163], v[64:67], v[108:111], v[160:163]
    v_mfma_f32_16x16x32_bf16 v[164:167], v[64:67], v[112:115], v[164:167]
    v_mfma_f32_16x16x32_bf16 v[168:171], v[64:67], v[116:119], v[168:171]
    s_waitcnt lgkmcnt(4)
    v_min_u32_dpp v0, v0, v0 quad_perm:[1,0,3,2] row_mask:0xf bank_mask:0xf
    v_mfma_f32_16x16x32_bf16 v[172:175], v[68:71], v[108:111], v[172:175]
    v_mfma_f32_16x16x32_bf16 v[176:179], v[68:71], v[112:115], v[176:179]
    v_min_u32_dpp v0, v0, v0 quad_perm:[2,3,0,1] row_mask:0xf bank_mask:0xf
    v_mfma_f32_16x16x32_bf16 v[180:183], v[68:71], v[116:119], v[180:183]
    v_readfirstlane_b32 s86, v0
    v_mfma_f32_16x16x32_bf16 v[184:187], v[72:75], v[108:111], v[184:187]
    v_mfma_f32_16x16x32_bf16 v[188:191], v[72:75], v[112:115], v[188:191]
    s_waitcnt lgkmcnt(0)
    s_barrier
    v_mfma_f32_16x16x32_bf16 v[192:195], v[72:75], v[116:119], v[192:195]
    s_add_u32 s85, s85, 1
    s_cmp_ge_u32 s86, s85
    s_cbranch_scc0 .Lck_14_s
.Lck_14:
    ds_read_b128 v[96:99], v40 offset:16384
    v_mfma_f32_16x16x32_bf16 v[196:199], v[76:79], v[108:111], v[196:199]
    ds_read_b64_tr_b16 v[64:65], v32 offset:32768
    ds_read_b64_tr_b16 v[66:67], v32 offset:34816
    v_mfma_f32_16x16x32_bf16 v[200:203], v[76:79], v[112:115], v[200:203]
    ds_read_b128 v[100:103], v40 offset:18432
    ds_read_b128 v[104:107], v40 offset:20480
    v_mfma_f32_16x16x32_bf16 v[204:207], v[76:79], v[116:119], v[204:207]
    ds_read_b64_tr_b16 v[68:69], v33 offset:32768
    ds_read_b64_tr_b16 v[70:71], v33 offset:34816
    v_mfma_f32_16x16x32_bf16 v[208:211], v[80:83], v[108:111], v[208:211]
    ds_read_b64_tr_b16 v[72:73], v34 offset:32768
    ds_read_b64_tr_b16 v[74:75], v34 offset:34816
    v_mfma_f32_16x16x32_bf16 v[212:215], v[80:83], v[112:115], v[212:215]
    ds_read_b64_tr_b16 v[76:77], v35 offset:32768
    ds_read_b64_tr_b16 v[78:79], v35 offset:34816
    v_mfma_f32_16x16x32_bf16 v[216:219], v[80:83], v[116:119], v[216:219]
    ds_read_b64_tr_b16 v[80:81], v36 offset:32768
    ds_read_b64_tr_b16 v[82:83], v36 offset:34816
    v_mfma_f32_16x16x32_bf16 v[220:223], v[84:87], v[108:111], v[220:223]
    v_mfma_f32_16x16x32_bf16 v[224:227], v[84:87], v[112:115], v[224:227]
    v_mfma_f32_16x16x32_bf16 v[228:231], v[84:87], v[116:119], v[228:231]
    ds_read_b64_tr_b16 v[84:85], v37 offset:32768
    ds_read_b64_tr_b16 v[86:87], v37 offset:34816
    v_mfma_f32_16x16x32_bf16 v[232:235], v[88:91], v[108:111], v[232:235]
    v_mfma_f32_16x16x32_bf16 v[236:239], v[88:91], v[112:115], v[236:239]
    v_mfma_f32_16x16x32_bf16 v[240:243], v[88:91], v[116:119], v[240:243]
    v_mfma_f32_16x16x32_bf16 v[244:247], v[92:95], v[108:111], v[244:247]
    v_mfma_f32_16x16x32_bf16 v[248:251], v[92:95], v[112:115], v[248:251]
    v_mfma_f32_16x16x32_bf16 v[252:255], v[92:95], v[116:119], v[252:255]
    s_waitcnt lgkmcnt(2)
    v_mfma_f32_16x16x32_bf16 v[160:163], v[64:67], v[96:99], v[160:163]
    ds_read_b64_tr_b16 v[88:89], v38 offset:32768
    ds_read_b64_tr_b16 v[90:91], v38 offset:34816
    v_mfma_f32_16x16x32_bf16 v[164:167], v[64:67], v[100:103], v[164:167]
    ds_read_b64_tr_b16 v[92:93], v39 offset:32768
    ds_read_b64_tr_b16 v[94:95], v39 offset:34816
    v_mfma_f32_16x16x32_bf16 v[168:171], v[64:67], v[104:107], v[168:171]
    ds_read_b128 v[108:111], v41 offset:16384
    ds_read_b64_tr_b16 v[64:65], v32 offset:49152
    v_mfma_f32_16x16x32_bf16 v[172:175], v[68:71], v[96:99], v[172:175]
    ds_read_b64_tr_b16 v[66:67], v32 offset:51200
    ds_read_b128 v[112:115], v41 offset:18432
    v_mfma_f32_16x16x32_bf16 v[176:179], v[68:71], v[100:103], v[176:179]
    ds_read_b128 v[116:119], v41 offset:20480
    v_mfma_f32_16x16x32_bf16 v[180:183], v[68:71], v[104:107], v[180:183]
    ds_read_b64_tr_b16 v[68:69], v33 offset:49152
    ds_read_b64_tr_b16 v[70:71], v33 offset:51200
    v_mfma_f32_16x16x32_bf16 v[184:187], v[72:75], v[96:99], v[184:187]
    v_mfma_f32_16x16x32_bf16 v[188:191], v[72:75], v[100:103], v[188:191]
    v_mfma_f32_16x16x32_bf16 v[192:195], v[72:75], v[104:107], v[192:195]
    ds_read_b64_tr_b16 v[72:73], v34 offset:49152
    ds_read_b64_tr_b16 v[74:75], v34 offset:51200
    v_mfma_f32_16x16x32_bf16 v[196:199], v[76:79], v[96:99], v[196:199]
    v_mfma_f32_16x16x32_bf16 v[200:203], v[76:79], v[100:103], v[200:203]
    v_mfma_f32_16x16x32_bf16 v[204:207], v[76:79], v[104:107], v[204:207]
    v_mfma_f32_16x16x32_bf16 v[208:211], v[80:83], v[96:99], v[208:211]
    v_mfma_f32_16x16x32_bf16 v[212:215], v[80:83], v[100:103], v[212:215]
    v_mfma_f32_16x16x32_bf16 v[216:219], v[80:83], v[104:107], v[216:219]
    s_waitcnt lgkmcnt(2)
    v_mfma_f32_16x16x32_bf16 v[220:223], v[84:87], v[96:99], v[220:223]
    ds_read_b64_tr_b16 v[76:77], v35 offset:49152
    ds_read_b64_tr_b16 v[78:79], v35 offset:51200
    v_mfma_f32_16x16x32_bf16 v[224:227], v[84:87], v[100:103], v[224:227]
    ds_read_b64_tr_b16 v[80:81], v36 offset:49152
    ds_read_b64_tr_b16 v[82:83], v36 offset:51200
    v_mfma_f32_16x16x32_bf16 v[228:231], v[84:87], v[104:107], v[228:231]
    ds_read_b64_tr_b16 v[84:85], v37 offset:49152
    ds_read_b64_tr_b16 v[86:87], v37 offset:51200
    v_mfma_f32_16x16x32_bf16 v[232:235], v[88:91], v[96:99], v[232:235]
    v_mfma_f32_16x16x32_bf16 v[236:239], v[88:91], v[100:103], v[236:239]
    v_mfma_f32_16x16x32_bf16 v[240:243], v[88:91], v[104:107], v[240:243]
    ds_read_b64_tr_b16 v[88:89], v38 offset:49152
    ds_read_b64_tr_b16 v[90:91], v38 offset:51200
    v_mfma_f32_16x16x32_bf16 v[244:247], v[92:95], v[96:99], v[244:247]
    v_mfma_f32_16x16x32_bf16 v[248:251], v[92:95], v[100:103], v[248:251]
    v_mfma_f32_16x16x32_bf16 v[252:255], v[92:95], v[104:107], v[252:255]
    ds_read_b64_tr_b16 v[92:93], v39 offset:49152
    ds_read_b64_tr_b16 v[94:95], v39 offset:51200
    v_mfma_f32_16x16x32_bf16 v[160:163], v[64:67], v[108:111], v[160:163]
    v_mfma_f32_16x16x32_bf16 v[164:167], v[64:67], v[112:115], v[164:167]
    v_mfma_f32_16x16x32_bf16 v[168:171], v[64:67], v[116:119], v[168:171]
    v_mfma_f32_16x16x32_bf16 v[172:175], v[68:71], v[108:111], v[172:175]
    v_mfma_f32_16x16x32_bf16 v[176:179], v[68:71], v[112:115], v[176:179]
    v_mfma_f32_16x16x32_bf16 v[180:183], v[68:71], v[116:119], v[180:183]
    s_waitcnt lgkmcnt(2)
    v_mfma_f32_16x16x32_bf16 v[184:187], v[72:75], v[108:111], v[184:187]
    v_mfma_f32_16x16x32_bf16 v[188:191], v[72:75], v[112:115], v[188:191]
    s_waitcnt lgkmcnt(0)
    s_barrier
    v_mfma_f32_16x16x32_bf16 v[192:195], v[72:75], v[116:119], v[192:195]
    v_mfma_f32_16x16x32_bf16 v[196:199], v[76:79], v[108:111], v[196:199]
    v_mfma_f32_16x16x32_bf16 v[200:203], v[76:79], v[112:115], v[200:203]
    v_mfma_f32_16x16x32_bf16 v[204:207], v[76:79], v[116:119], v[204:207]
    v_mfma_f32_16x16x32_bf16 v[208:211], v[80:83], v[108:111], v[208:211]
    v_mfma_f32_16x16x32_bf16 v[212:215], v[80:83], v[112:115], v[212:215]
    v_mfma_f32_16x16x32_bf16 v[216:219], v[80:83], v[116:119], v[216:219]
    v_mfma_f32_16x16x32_bf16 v[220:223], v[84:87], v[108:111], v[220:223]
    v_mfma_f32_16x16x32_bf16 v[224:227], v[84:87], v[112:115], v[224:227]
    v_mfma_f32_16x16x32_bf16 v[228:231], v[84:87], v[116:119], v[228:231]
    v_mfma_f32_16x16x32_bf16 v[232:235], v[88:91], v[108:111], v[232:235]
    v_mfma_f32_16x16x32_bf16 v[236:239], v[88:91], v[112:115], v[236:239]
    v_mfma_f32_16x16x32_bf16 v[240:243], v[88:91], v[116:119], v[240:243]
    v_mfma_f32_16x16x32_bf16 v[244:247], v[92:95], v[108:111], v[244:247]
    v_mfma_f32_16x16x32_bf16 v[248:251], v[92:95], v[112:115], v[248:251]
    v_mfma_f32_16x16x32_bf16 v[252:255], v[92:95], v[116:119], v[252:255]
    s_add_u32 s9, s9, 1
    s_cmp_lt_u32 s9, 2
    s_cbranch_scc1 .Lq_loop1
    s_waitcnt vmcnt(0)
    v_cvt_pk_bf16_f32 v112, v160, v161
    v_cvt_pk_bf16_f32 v113, v162, v163
    v_cvt_pk_bf16_f32 v114, v172, v173
    v_cvt_pk_bf16_f32 v115, v174, v175
    v_cvt_pk_bf16_f32 v128, v164, v165
    v_cvt_pk_bf16_f32 v129, v166, v167
    v_cvt_pk_bf16_f32 v130, v176, v177
    v_cvt_pk_bf16_f32 v131, v178, v179
    v_cvt_pk_bf16_f32 v144, v168, v169
    v_cvt_pk_bf16_f32 v145, v170, v171
    v_cvt_pk_bf16_f32 v146, v180, v181
    v_cvt_pk_bf16_f32 v147, v182, v183
    v_cvt_pk_bf16_f32 v116, v184, v185
    v_cvt_pk_bf16_f32 v117, v186, v187
    v_cvt_pk_bf16_f32 v118, v196, v197
    v_cvt_pk_bf16_f32 v119, v198, v199
    v_cvt_pk_bf16_f32 v132, v188, v189
    v_cvt_pk_bf16_f32 v133, v190, v191
    v_cvt_pk_bf16_f32 v134, v200, v201
    v_cvt_pk_bf16_f32 v135, v202, v203
    v_cvt_pk_bf16_f32 v148, v192, v193
    v_cvt_pk_bf16_f32 v149, v194, v195
    v_cvt_pk_bf16_f32 v150, v204, v205
    v_cvt_pk_bf16_f32 v151, v206, v207
    v_cvt_pk_bf16_f32 v120, v208, v209
    v_cvt_pk_bf16_f32 v121, v210, v211
    v_cvt_pk_bf16_f32 v122, v220, v221
    v_cvt_pk_bf16_f32 v123, v222, v223
    v_cvt_pk_bf16_f32 v136, v212, v213
    v_cvt_pk_bf16_f32 v137, v214, v215
    v_cvt_pk_bf16_f32 v138, v224, v225
    v_cvt_pk_bf16_f32 v139, v226, v227
    v_cvt_pk_bf16_f32 v152, v216, v217
    v_cvt_pk_bf16_f32 v153, v218, v219
    v_cvt_pk_bf16_f32 v154, v228, v229
    v_cvt_pk_bf16_f32 v155, v230, v231
    v_cvt_pk_bf16_f32 v124, v232, v233
    v_cvt_pk_bf16_f32 v125, v234, v235
    v_cvt_pk_bf16_f32 v126, v244, v245
    v_cvt_pk_bf16_f32 v127, v246, v247
    v_cvt_pk_bf16_f32 v140, v236, v237
    v_cvt_pk_bf16_f32 v141, v238, v239
    v_cvt_pk_bf16_f32 v142, v248, v249
    v_cvt_pk_bf16_f32 v143, v250, v251
    v_cvt_pk_bf16_f32 v156, v240, v241
    v_cvt_pk_bf16_f32 v157, v242, v243
    v_cvt_pk_bf16_f32 v158, v252, v253
    v_cvt_pk_bf16_f32 v159, v254, v255
    v_permlane32_swap_b32 v112, v114
    v_permlane32_swap_b32 v113, v115
    v_permlane32_swap_b32 v116, v118
    v_permlane32_swap_b32 v117, v119
    v_permlane32_swap_b32 v120, v122
    v_permlane32_swap_b32 v121, v123
    v_permlane32_swap_b32 v124, v126
    v_permlane32_swap_b32 v125, v127
    v_permlane32_swap_b32 v128, v130
    v_permlane32_swap_b32 v129, v131
    v_permlane32_swap_b32 v132, v134
    v_permlane32_swap_b32 v133, v135
    v_permlane32_swap_b32 v136, v138
    v_permlane32_swap_b32 v137, v139
    v_permlane32_swap_b32 v140, v142
    v_permlane32_swap_b32 v141, v143
    v_permlane32_swap_b32 v144, v146
    v_permlane32_swap_b32 v145, v147
    v_permlane32_swap_b32 v148, v150
    v_permlane32_swap_b32 v149, v151
    v_permlane32_swap_b32 v152, v154
    v_permlane32_swap_b32 v153, v155
    v_permlane32_swap_b32 v156, v158
    v_permlane32_swap_b32 v157, v159
    v_permlane16_swap_b32 v112, v114
    v_permlane16_swap_b32 v113, v115
    v_permlane16_swap_b32 v116, v118
    v_permlane16_swap_b32 v117, v119
    v_permlane16_swap_b32 v120, v122
    v_permlane16_swap_b32 v121, v123
    v_permlane16_swap_b32 v124, v126
    v_permlane16_swap_b32 v125, v127
    v_permlane16_swap_b32 v128, v130
    v_permlane16_swap_b32 v129, v131
    v_permlane16_swap_b32 v132, v134
    v_permlane16_swap_b32 v133, v135
    v_permlane16_swap_b32 v136, v138
    v_permlane16_swap_b32 v137, v139
    v_permlane16_swap_b32 v140, v142
    v_permlane16_swap_b32 v141, v143
    v_permlane16_swap_b32 v144, v146
    v_permlane16_swap_b32 v145, v147
    v_permlane16_swap_b32 v148, v150
    v_permlane16_swap_b32 v149, v151
    v_permlane16_swap_b32 v152, v154
    v_permlane16_swap_b32 v153, v155
    v_permlane16_swap_b32 v156, v158
    v_permlane16_swap_b32 v157, v159
    v_mov_b32 v20, v6
    v_xor_b32 v21, 64, v6
    v_xor_b32 v22, 128, v6
    v_xor_b32 v23, 192, v6
    v_add_u32 v56, 0x10000, v4
    v_xor_b32 v57, 32, v56
    v_xor_b32 v58, 64, v56
    v_xor_b32 v59, 96, v56
    v_xor_b32 v60, 128, v56
    v_xor_b32 v61, 160, v56
    v_xor_b32 v62, 192, v56
    v_xor_b32 v63, 224, v56
    v_mov_b32 v3, 0xff7fffff
    v_mov_b32 v4, 0xff7fffff
    v_mov_b32 v6, 0xff7fffff
    v_mov_b32 v14, 0
    v_mov_b32 v15, 0
    v_mov_b32 v16, 0
    v_mov_b32 v17, 0
    v_mov_b32 v18, 0
    v_mov_b32 v19, 0
    v_mov_b32 v160, 0
    v_mov_b32 v161, 0
    v_mov_b32 v162, 0
    v_mov_b32 v163, 0
    v_mov_b32 v164, 0
    v_mov_b32 v165, 0
    v_mov_b32 v166, 0
    v_mov_b32 v167, 0
    v_mov_b32 v168, 0
    v_mov_b32 v169, 0
    v_mov_b32 v170, 0
    v_mov_b32 v171, 0
    v_mov_b32 v172, 0
    v_mov_b32 v173, 0
    v_mov_b32 v174, 0
    v_mov_b32 v175, 0
    v_mov_b32 v176, 0
    v_mov_b32 v177, 0
    v_mov_b32 v178, 0
    v_mov_b32 v179, 0
    v_mov_b32 v180, 0
    v_mov_b32 v181, 0
    v_mov_b32 v182, 0
    v_mov_b32 v183, 0
    v_mov_b32 v184, 0
    v_mov_b32 v185, 0
    v_mov_b32 v186, 0
    v_mov_b32 v187, 0
    v_mov_b32 v188, 0
    v_mov_b32 v189, 0
    v_mov_b32 v190, 0
    v_mov_b32 v191, 0
    v_mov_b32 v192, 0
    v_mov_b32 v193, 0
    v_mov_b32 v194, 0
    v_mov_b32 v195, 0
    v_mov_b32 v196, 0
    v_mov_b32 v197, 0
    v_mov_b32 v198, 0
    v_mov_b32 v199, 0
    v_mov_b32 v200, 0
    v_mov_b32 v201, 0
    v_mov_b32 v202, 0
    v_mov_b32 v203, 0
    v_mov_b32 v204, 0
    v_mov_b32 v205, 0
    v_mov_b32 v206, 0
    v_mov_b32 v207, 0
    v_mov_b32 v208, 0
    v_mov_b32 v209, 0
    v_mov_b32 v210, 0
    v_mov_b32 v211, 0
    v_mov_b32 v212, 0
    v_mov_b32 v213, 0
    v_mov_b32 v214, 0
    v_mov_b32 v215, 0
    v_mov_b32 v216, 0
    v_mov_b32 v217, 0
    v_mov_b32 v218, 0
    v_mov_b32 v219, 0
    v_mov_b32 v220, 0
    v_mov_b32 v221, 0
    v_mov_b32 v222, 0
    v_mov_b32 v223, 0
    v_mov_b32 v224, 0
    v_mov_b32 v225, 0
    v_mov_b32 v226, 0
    v_mov_b32 v227, 0
    v_mov_b32 v228, 0
    v_mov_b32 v229, 0
    v_mov_b32 v230, 0
    v_mov_b32 v231, 0
    v_mov_b32 v232, 0
    v_mov_b32 v233, 0
    v_mov_b32 v234, 0
    v_mov_b32 v235, 0
    v_mov_b32 v236, 0
    v_mov_b32 v237, 0
    v_mov_b32 v238, 0
    v_mov_b32 v239, 0
    v_mov_b32 v240, 0
    v_mov_b32 v241, 0
    v_mov_b32 v242, 0
    v_mov_b32 v243, 0
    v_mov_b32 v244, 0
    v_mov_b32 v245, 0
    v_mov_b32 v246, 0
    v_mov_b32 v247, 0
    v_mov_b32 v248, 0
    v_mov_b32 v249, 0
    v_mov_b32 v250, 0
    v_mov_b32 v251, 0
    v_mov_b32 v252, 0
    v_mov_b32 v253, 0
    v_mov_b32 v254, 0
    v_mov_b32 v255, 0
    s_lshr_b32 s3, s4, 1
    s_add_u32 s85, s3, 7
    s_add_u32 s85, s85, 2
    s_cmp_ge_u32 s86, s85
    s_cbranch_scc0 .Lck_15_s
.Lck_15:
    ds_read_b128 v[24:27], v20 offset:0
    ds_read_b128 v[28:31], v20 offset:4096
    ds_read_b128 v[32:35], v21 offset:0
    ds_read_b128 v[36:39], v21 offset:4096
    ds_read_b128 v[40:43], v22 offset:0
    ds_read_b128 v[44:47], v22 offset:4096
    ds_read_b128 v[48:51], v23 offset:0
    ds_read_b128 v[52:55], v23 offset:4096
    s_mov_b32 s9, 0
.Lchunk_b:
    s_waitcnt lgkmcnt(2)
    v_mfma_f32_16x16x32_bf16 v[64:67], v[24:27], v[112:115], 0
    v_mfma_f32_16x16x32_bf16 v[72:75], v[24:27], v[128:131], 0
    v_mfma_f32_16x16x32_bf16 v[80:83], v[24:27], v[144:147], 0
    ds_read_b128 v[24:27], v20 offset:8192
    v_mfma_f32_16x16x32_bf16 v[68:71], v[28:31], v[112:115], 0
    v_mfma_f32_16x16x32_bf16 v[76:79], v[28:31], v[128:131], 0
    v_mfma_f32_16x16x32_bf16 v[84:87], v[28:31], v[144:147], 0
    ds_read_b128 v[28:31], v20 offset:12288
    v_mfma_f32_16x16x32_bf16 v[64:67], v[32:35], v[116:119], v[64:67]
    v_mfma_f32_16x16x32_bf16 v[72:75], v[32:35], v[132:135], v[72:75]
    v_mfma_f32_16x16x32_bf16 v[80:83], v[32:35], v[148:151], v[80:83]
    ds_read_b128 v[32:35], v21 offset:8192
    v_mfma_f32_16x16x32_bf16 v[68:71], v[36:39], v[116:119], v[68:71]
    v_mfma_f32_16x16x32_bf16 v[76:79], v[36:39], v[132:135], v[76:79]
    v_mfma_f32_16x16x32_bf16 v[84:87], v[36:39], v[148:151], v[84:87]
    ds_read_b128 v[36:39], v21 offset:12288
    v_mfma_f32_16x16x32_bf16 v[64:67], v[40:43], v[120:123], v[64:67]
    v_mfma_f32_16x16x32_bf16 v[72:75], v[40:43], v[136:139], v[72:75]
    v_mfma_f32_16x16x32_bf16 v[80:83], v[40:43], v[152:155], v[80:83]
    ds_read_b128 v[40:43], v22 offset:8192
    v_mfma_f32_16x16x32_bf16 v[68:71], v[44:47], v[120:123], v[68:71]
    v_mfma_f32_16x16x32_bf16 v[76:79], v[44:47], v[136:139], v[76:79]
    v_mfma_f32_16x16x32_bf16 v[84:87], v[44:47], v[152:155], v[84:87]
    ds_read_b128 v[44:47], v22 offset:12288
    s_waitcnt lgkmcnt(3)
    v_mfma_f32_16x16x32_bf16 v[64:67], v[48:51], v[124:127], v[64:67]
    v_mfma_f32_16x16x32_bf16 v[72:75], v[48:51], v[140:143], v[72:75]
    v_mfma_f32_16x16x32_bf16 v[80:83], v[48:51], v[156:159], v[80:83]
    ds_read_b128 v[48:51], v23 offset:8192
    v_mfma_f32_16x16x32_bf16 v[68:71], v[52:55], v[124:127], v[68:71]
    v_mfma_f32_16x16x32_bf16 v[76:79], v[52:55], v[140:143], v[76:79]
    v_mfma_f32_16x16x32_bf16 v[84:87], v[52:55], v[156:159], v[84:87]
    ds_read_b128 v[52:55], v23 offset:12288
    v_mfma_f32_16x16x32_bf16 v[88:91], v[24:27], v[112:115], 0
    v_max_f32 v7, v64, v65
    v_max_f32 v8, v72, v73
    v_mfma_f32_16x16x32_bf16 v[96:99], v[24:27], v[128:131], 0
    v_mfma_f32_16x16x32_bf16 v[104:107], v[24:27], v[144:147], 0
    v_max_f32 v9, v80, v81
    v_mfma_f32_16x16x32_bf16 v[92:95], v[28:31], v[112:115], 0
    v_mfma_f32_16x16x32_bf16 v[100:103], v[28:31], v[128:131], 0
    v_max3_f32 v7, v7, v66, v67
    v_mfma_f32_16x16x32_bf16 v[108:111], v[28:31], v[144:147], 0
    v_mfma_f32_16x16x32_bf16 v[88:91], v[32:35], v[116:119], v[88:91]
    v_max3_f32 v8, v8, v74, v75
    v_mfma_f32_16x16x32_bf16 v[96:99], v[32:35], v[132:135], v[96:99]
    s_waitcnt lgkmcnt(0)
    s_barrier
    v_mfma_f32_16x16x32_bf16 v[104:107], v[32:35], v[148:151], v[104:107]
    v_max3_f32 v9, v9, v82, v83
    v_mfma_f32_16x16x32_bf16 v[92:95], v[36:39], v[116:119], v[92:95]
    v_mfma_f32_16x16x32_bf16 v[100:103], v[36:39], v[132:135], v[100:103]
    v_max3_f32 v7, v7, v68, v69
    v_mfma_f32_16x16x32_bf16 v[108:111], v[36:39], v[148:151], v[108:111]
    v_mfma_f32_16x16x32_bf16 v[88:91], v[40:43], v[120:123], v[88:91]
    v_max3_f32 v8, v8, v76, v77
    v_mfma_f32_16x16x32_bf16 v[96:99], v[40:43], v[136:139], v[96:99]
    v_mfma_f32_16x16x32_bf16 v[104:107], v[40:43], v[152:155], v[104:107]
    v_max3_f32 v9, v9, v84, v85
    v_mfma_f32_16x16x32_bf16 v[92:95], v[44:47], v[120:123], v[92:95]
    v_mfma_f32_16x16x32_bf16 v[100:103], v[44:47], v[136:139], v[100:103]
    v_max3_f32 v7, v7, v70, v71
    v_mfma_f32_16x16x32_bf16 v[108:111], v[44:47], v[152:155], v[108:111]
    v_mfma_f32_16x16x32_bf16 v[88:91], v[48:51], v[124:127], v[88:91]
    v_max3_f32 v8, v8, v78, v79
    v_mfma_f32_16x16x32_bf16 v[96:99], v[48:51], v[140:143], v[96:99]
    v_mfma_f32_16x16x32_bf16 v[104:107], v[48:51], v[156:159], v[104:107]
    v_max3_f32 v9, v9, v86, v87
    v_mfma_f32_16x16x32_bf16 v[92:95], v[52:55], v[124:127], v[92:95]
    v_mfma_f32_16x16x32_bf16 v[100:103], v[52:55], v[140:143], v[100:103]
    v_mfma_f32_16x16x32_bf16 v[108:111], v[52:55], v[156:159], v[108:111]
    s_nop 0
    v_max3_f32 v7, v7, v88, v89
    s_nop 0
    v_max3_f32 v8, v8, v96, v97
    v_max3_f32 v9, v9, v104, v105
    v_max3_f32 v7, v7, v90, v91
    v_max3_f32 v8, v8, v98, v99
    v_max3_f32 v9, v9, v106, v107
    v_max3_f32 v7, v7, v92, v93
    v_max3_f32 v8, v8, v100, v101
    v_max3_f32 v9, v9, v108, v109
    v_max3_f32 v7, v7, v94, v95
    v_max3_f32 v8, v8, v102, v103
    v_max3_f32 v9, v9, v110, v111
    v_fma_f32 v10, v7, s36, -v3
    v_fma_f32 v12, v8, s36, -v4
    v_fma_f32 v13, v9, s36, -v6
    v_max3_f32 v10, v10, v12, v13
    v_cmp_nge_f32 vcc, 0x41000000, v10
    s_nop 4
    s_cbranch_vccnz .Lrs_16_s
.Lrs_16:
    v_pk_fma_f32 v[64:65], v[64:65], s[36:37], v[2:3] op_sel:[0,0,1] op_sel_hi:[1,1,1] neg_lo:[0,0,1] neg_hi:[0,0,1]
    v_pk_fma_f32 v[66:67], v[66:67], s[36:37], v[2:3] op_sel:[0,0,1] op_sel_hi:[1,1,1] neg_lo:[0,0,1] neg_hi:[0,0,1]
    v_pk_fma_f32 v[68:69], v[68:69], s[36:37], v[2:3] op_sel:[0,0,1] op_sel_hi:[1,1,1] neg_lo:[0,0,1] neg_hi:[0,0,1]
    v_pk_fma_f32 v[70:71], v[70:71], s[36:37], v[2:3] op_sel:[0,0,1] op_sel_hi:[1,1,1] neg_lo:[0,0,1] neg_hi:[0,0,1]
    v_pk_fma_f32 v[72:73], v[72:73], s[36:37], v[4:5] op_sel:[0,0,0] op_sel_hi:[1,1,0] neg_lo:[0,0,1] neg_hi:[0,0,1]
    v_pk_fma_f32 v[74:75], v[74:75], s[36:37], v[4:5] op_sel:[0,0,0] op_sel_hi:[1,1,0] neg_lo:[0,0,1] neg_hi:[0,0,1]
    v_pk_fma_f32 v[76:77], v[76:77], s[36:37], v[4:5] op_sel:[0,0,0] op_sel_hi:[1,1,0] neg_lo:[0,0,1] neg_hi:[0,0,1]
    v_pk_fma_f32 v[78:79], v[78:79], s[36:37], v[4:5] op_sel:[0,0,0] op_sel_hi:[1,1,0] neg_lo:[0,0,1] neg_hi:[0,0,1]
    v_exp_f32 v64, v64
    v_exp_f32 v65, v65
    v_exp_f32 v66, v66
    v_exp_f32 v67, v67
    v_exp_f32 v68, v68
    v_exp_f32 v69, v69
    v_exp_f32 v70, v70
    v_exp_f32 v71, v71
    v_pk_add_f32 v[14:15], v[14:15], v[64:65]
    v_pk_add_f32 v[14:15], v[14:15], v[66:67]
    v_pk_add_f32 v[14:15], v[14:15], v[68:69]
    v_pk_add_f32 v[14:15], v[14:15], v[70:71]
    v_cvt_pk_bf16_f32 v64, v64, v65
    v_cvt_pk_bf16_f32 v65, v66, v67
    v_cvt_pk_bf16_f32 v66, v68, v69
    v_cvt_pk_bf16_f32 v67, v70, v71
    v_pk_fma_f32 v[80:81], v[80:81], s[36:37], v[6:7] op_sel:[0,0,0] op_sel_hi:[1,1,0] neg_lo:[0,0,1] neg_hi:[0,0,1]
    v_pk_fma_f32 v[82:83], v[82:83], s[36:37], v[6:7] op_sel:[0,0,0] op_sel_hi:[1,1,0] neg_lo:[0,0,1] neg_hi:[0,0,1]
    v_pk_fma_f32 v[84:85], v[84:85], s[36:37], v[6:7] op_sel:[0,0,0] op_sel_hi:[1,1,0] neg_lo:[0,0,1] neg_hi:[0,0,1]
    v_pk_fma_f32 v[86:87], v[86:87], s[36:37], v[6:7] op_sel:[0,0,0] op_sel_hi:[1,1,0] neg_lo:[0,0,1] neg_hi:[0,0,1]
    v_exp_f32 v72, v72
    v_exp_f32 v73, v73
    v_exp_f32 v74, v74
    v_exp_f32 v75, v75
    ds_read_b32 v0, v1
    v_exp_f32 v76, v76
    v_exp_f32 v77, v77
    v_exp_f32 v78, v78
    v_exp_f32 v79, v79
    v_pk_add_f32 v[16:17], v[16:17], v[72:73]
    v_pk_add_f32 v[16:17], v[16:17], v[74:75]
    v_pk_add_f32 v[16:17], v[16:17], v[76:77]
    v_pk_add_f32 v[16:17], v[16:17], v[78:79]
    v_cvt_pk_bf16_f32 v72, v72, v73
    v_cvt_pk_bf16_f32 v73, v74, v75
    v_cvt_pk_bf16_f32 v74, v76, v77
    v_cvt_pk_bf16_f32 v75, v78, v79
    v_pk_fma_f32 v[88:89], v[88:89], s[36:37], v[2:3] op_sel:[0,0,1] op_sel_hi:[1,1,1] neg_lo:[0,0,1] neg_hi:[0,0,1]
    v_pk_fma_f32 v[90:91], v[90:91], s[36:37], v[2:3] op_sel:[0,0,1] op_sel_hi:[1,1,1] neg_lo:[0,0,1] neg_hi:[0,0,1]
    v_pk_fma_f32 v[92:93], v[92:93], s[36:37], v[2:3] op_sel:[0,0,1] op_sel_hi:[1,1,1] neg_lo:[0,0,1] neg_hi:[0,0,1]
    v_pk_fma_f32 v[94:95], v[94:95], s[36:37], v[2:3] op_sel:[0,0,1] op_sel_hi:[1,1,1] neg_lo:[0,0,1] neg_hi:[0,0,1]
    v_exp_f32 v80, v80
    v_exp_f32 v81, v81
    v_exp_f32 v82, v82
    v_exp_f32 v83, v83
    v_exp_f32 v84, v84
    v_exp_f32 v85, v85
    s_waitcnt lgkmcnt(0)
    v_min_u32_dpp v0, v0, v0 quad_perm:[1,0,3,2] row_mask:0xf bank_mask:0xf
    v_exp_f32 v86, v86
    v_exp_f32 v87, v87
    v_min_u32_dpp v0, v0, v0 quad_perm:[2,3,0,1] row_mask:0xf bank_mask:0xf
    v_pk_add_f32 v[18:19], v[18:19], v[80:81]
    v_readfirstlane_b32 s86, v0
    v_pk_add_f32 v[18:19], v[18:19], v[82:83]
    v_pk_add_f32 v[18:19], v[18:19], v[84:85]
    v_pk_add_f32 v[18:19], v[18:19], v[86:87]
    s_add_u32 s85, s85, 2
    s_cmp_ge_u32 s86, s85
    s_cbranch_scc0 .Lck_17_s
.Lck_17:
    ds_read_b64_tr_b16 v[24:25], v56 offset:0
    v_cvt_pk_bf16_f32 v80, v80, v81
    v_cvt_pk_bf16_f32 v81, v82, v83
    ds_read_b64_tr_b16 v[26:27], v56 offset:4096
    v_cvt_pk_bf16_f32 v82, v84, v85
    v_cvt_pk_bf16_f32 v83, v86, v87
    ds_read_b64_tr_b16 v[28:29], v57 offset:0
    v_pk_fma_f32 v[96:97], v[96:97], s[36:37], v[4:5] op_sel:[0,0,0] op_sel_hi:[1,1,0] neg_lo:[0,0,1] neg_hi:[0,0,1]
    v_pk_fma_f32 v[98:99], v[98:99], s[36:37], v[4:5] op_sel:[0,0,0] op_sel_hi:[1,1,0] neg_lo:[0,0,1] neg_hi:[0,0,1]
    ds_read_b64_tr_b16 v[30:31], v57 offset:4096
    v_pk_fma_f32 v[100:101], v[100:101], s[36:37], v[4:5] op_sel:[0,0,0] op_sel_hi:[1,1,0] neg_lo:[0,0,1] neg_hi:[0,0,1]
    v_pk_fma_f32 v[102:103], v[102:103], s[36:37], v[4:5] op_sel:[0,0,0] op_sel_hi:[1,1,0] neg_lo:[0,0,1] neg_hi:[0,0,1]
    ds_read_b64_tr_b16 v[32:33], v58 offset:0
    v_exp_f32 v88, v88
    v_exp_f32 v89, v89
    ds_read_b64_tr_b16 v[34:35], v58 offset:4096
    v_exp_f32 v90, v90
    v_exp_f32 v91, v91
    ds_read_b64_tr_b16 v[36:37], v59 offset:0
    v_exp_f32 v92, v92
    v_exp_f32 v93, v93
    ds_read_b64_tr_b16 v[38:39], v59 offset:4096
    v_exp_f32 v94, v94
    v_exp_f32 v95, v95
    ds_read_b64_tr_b16 v[40:41], v60 offset:0
    v_pk_add_f32 v[14:15], v[14:15], v[88:89]
    v_pk_add_f32 v[14:15], v[14:15], v[90:91]
    ds_read_b64_tr_b16 v[42:43], v60 offset:4096
    v_pk_add_f32 v[14:15], v[14:15], v[92:93]
    v_pk_add_f32 v[14:15], v[14:15], v[94:95]
    ds_read_b64_tr_b16 v[44:45], v61 offset:0
    v_cvt_pk_bf16_f32 v88, v88, v89
    v_cvt_pk_bf16_f32 v89, v90, v91
    ds_read_b64_tr_b16 v[46:47], v61 offset:4096
    v_cvt_pk_bf16_f32 v90, v92, v93
    v_cvt_pk_bf16_f32 v91, v94, v95
    ds_read_b64_tr_b16 v[48:49], v62 offset:0
    v_pk_fma_f32 v[104:105], v[104:105], s[36:37], v[6:7] op_sel:[0,0,0] op_sel_hi:[1,1,0] neg_lo:[0,0,1] neg_hi:[0,0,1]
    v_pk_fma_f32 v[106:107], v[106:107], s[36:37], v[6:7] op_sel:[0,0,0] op_sel_hi:[1,1,0] neg_lo:[0,0,1] neg_hi:[0,0,1]
    ds_read_b64_tr_b16 v[50:51], v62 offset:4096
    v_pk_fma_f32 v[108:109], v[108:109], s[36:37], v[6:7] op_sel:[0,0,0] op_sel_hi:[1,1,0] neg_lo:[0,0,1] neg_hi:[0,0,1]
    v_pk_fma_f32 v[110:111], v[110:111], s[36:37], v[6:7] op_sel:[0,0,0] op_sel_hi:[1,1,0] neg_lo:[0,0,1] neg_hi:[0,0,1]
    ds_read_b64_tr_b16 v[52:53], v63 offset:0
    v_exp_f32 v96, v96
    v_exp_f32 v97, v97
    v_exp_f32 v98, v98
    v_exp_f32 v99, v99
    v_exp_f32 v100, v100
    v_exp_f32 v101, v101
    v_exp_f32 v102, v102
    v_exp_f32 v103, v103
    v_pk_add_f32 v[16:17], v[16:17], v[96:97]
    v_pk_add_f32 v[16:17], v[16:17], v[98:99]
    v_pk_add_f32 v[16:17], v[16:17], v[100:101]
    v_pk_add_f32 v[16:17], v[16:17], v[102:103]
    v_cvt_pk_bf16_f32 v96, v96, v97
    v_cvt_pk_bf16_f32 v97, v98, v99
    v_cvt_pk_bf16_f32 v98, v100, v101
    v_cvt_pk_bf16_f32 v99, v102, v103
    v_exp_f32 v104, v104
    v_exp_f32 v105, v105
    v_exp_f32 v106, v106
    v_exp_f32 v107, v107
    v_exp_f32 v108, v108
    v_exp_f32 v109, v109
    v_exp_f32 v110, v110
    v_exp_f32 v111, v111
    v_pk_add_f32 v[18:19], v[18:19], v[104:105]
    v_pk_add_f32 v[18:19], v[18:19], v[106:107]
    v_pk_add_f32 v[18:19], v[18:19], v[108:109]
    v_pk_add_f32 v[18:19], v[18:19], v[110:111]
    v_cvt_pk_bf16_f32 v104, v104, v105
    v_cvt_pk_bf16_f32 v105, v106, v107
    v_cvt_pk_bf16_f32 v106, v108, v109
    v_cvt_pk_bf16_f32 v107, v110, v111
    s_waitcnt lgkmcnt(0)
    v_mfma_f32_16x16x32_bf16 v[160:163], v[24:27], v[64:67], v[160:163]
    ds_read_b64_tr_b16 v[54:55], v63 offset:4096
    v_mfma_f32_16x16x32_bf16 v[164:167], v[24:27], v[72:75], v[164:167]
    v_mfma_f32_16x16x32_bf16 v[168:171], v[24:27], v[80:83], v[168:171]
    ds_read_b64_tr_b16 v[24:25], v56 offset:8192
    ds_read_b64_tr_b16 v[26:27], v56 offset:12288
    v_mfma_f32_16x16x32_bf16 v[172:175], v[28:31], v[64:67], v[172:175]
    v_mfma_f32_16x16x32_bf16 v[176:179], v[28:31], v[72:75], v[176:179]
    v_mfma_f32_16x16x32_bf16 v[180:183], v[28:31], v[80:83], v[180:183]
    ds_read_b64_tr_b16 v[28:29], v57 offset:8192
    ds_read_b64_tr_b16 v[30:31], v57 offset:12288
    v_mfma_f32_16x16x32_bf16 v[184:187], v[32:35], v[64:67], v[184:187]
    v_mfma_f32_16x16x32_bf16 v[188:191], v[32:35], v[72:75], v[188:191]
    v_mfma_f32_16x16x32_bf16 v[192:195], v[32:35], v[80:83], v[192:195]
    ds_read_b64_tr_b16 v[32:33], v58 offset:8192
    ds_read_b64_tr_b16 v[34:35], v58 offset:12288
    v_mfma_f32_16x16x32_bf16 v[196:199], v[36:39], v[64:67], v[196:199]
    v_mfma_f32_16x16x32_bf16 v[200:203], v[36:39], v[72:75], v[200:203]
    v_mfma_f32_16x16x32_bf16 v[204:207], v[36:39], v[80:83], v[204:207]
    ds_read_b64_tr_b16 v[36:37], v59 offset:8192
    ds_read_b64_tr_b16 v[38:39], v59 offset:12288
    v_mfma_f32_16x16x32_bf16 v[208:211], v[40:43], v[64:67], v[208:211]
    v_mfma_f32_16x16x32_bf16 v[212:215], v[40:43], v[72:75], v[212:215]
    v_mfma_f32_16x16x32_bf16 v[216:219], v[40:43], v[80:83], v[216:219]
    ds_read_b64_tr_b16 v[40:41], v60 offset:8192
    ds_read_b64_tr_b16 v[42:43], v60 offset:12288
    v_mfma_f32_16x16x32_bf16 v[220:223], v[44:47], v[64:67], v[220:223]
    v_mfma_f32_16x16x32_bf16 v[224:227], v[44:47], v[72:75], v[224:227]
    v_mfma_f32_16x16x32_bf16 v[228:231], v[44:47], v[80:83], v[228:231]
    ds_read_b64_tr_b16 v[44:45], v61 offset:8192
    ds_read_b64_tr_b16 v[46:47], v61 offset:12288
    v_mfma_f32_16x16x32_bf16 v[232:235], v[48:51], v[64:67], v[232:235]
    ds_read_b32 v0, v1
    v_mfma_f32_16x16x32_bf16 v[236:239], v[48:51], v[72:75], v[236:239]
    v_mfma_f32_16x16x32_bf16 v[240:243], v[48:51], v[80:83], v[240:243]
    ds_read_b64_tr_b16 v[48:49], v62 offset:8192
    s_waitcnt lgkmcnt(6)
    v_mfma_f32_16x16x32_bf16 v[244:247], v[52:55], v[64:67], v[244:247]
    ds_read_b64_tr_b16 v[50:51], v62 offset:12288
    v_mfma_f32_16x16x32_bf16 v[248:251], v[52:55], v[72:75], v[248:251]
    v_mfma_f32_16x16x32_bf16 v[252:255], v[52:55], v[80:83], v[252:255]
    ds_read_b64_tr_b16 v[52:53], v63 offset:8192
    ds_read_b64_tr_b16 v[54:55], v63 offset:12288
    v_mfma_f32_16x16x32_bf16 v[160:163], v[24:27], v[88:91], v[160:163]
    v_mfma_f32_16x16x32_bf16 v[164:167], v[24:27], v[96:99], v[164:167]
    v_mfma_f32_16x16x32_bf16 v[168:171], v[24:27], v[104:107], v[168:171]
    s_waitcnt lgkmcnt(4)
    v_min_u32_dpp v0, v0, v0 quad_perm:[1,0,3,2] row_mask:0xf bank_mask:0xf
    v_mfma_f32_16x16x32_bf16 v[172:175], v[28:31], v[88:91], v[172:175]
    v_mfma_f32_16x16x32_bf16 v[176:179], v[28:31], v[96:99], v[176:179]
    v_min_u32_dpp v0, v0, v0 quad_perm:[2,3,0,1] row_mask:0xf bank_mask:0xf
    v_mfma_f32_16x16x32_bf16 v[180:183], v[28:31], v[104:107], v[180:183]
    v_readfirstlane_b32 s86, v0
    v_mfma_f32_16x16x32_bf16 v[184:187], v[32:35], v[88:91], v[184:187]
    v_mfma_f32_16x16x32_bf16 v[188:191], v[32:35], v[96:99], v[188:191]
    s_waitcnt lgkmcnt(0)
    s_barrier
    v_mfma_f32_16x16x32_bf16 v[192:195], v[32:35], v[104:107], v[192:195]
    s_add_u32 s85, s85, 2
    s_cmp_ge_u32 s86, s85
    s_cbranch_scc0 .Lck_18_s
.Lck_18:
    ds_read_b128 v[24:27], v20 offset:0
    v_mfma_f32_16x16x32_bf16 v[196:199], v[36:39], v[88:91], v[196:199]
    ds_read_b128 v[28:31], v20 offset:4096
    ds_read_b128 v[32:35], v21 offset:0
    v_mfma_f32_16x16x32_bf16 v[200:203], v[36:39], v[96:99], v[200:203]
    v_mfma_f32_16x16x32_bf16 v[204:207], v[36:39], v[104:107], v[204:207]
    ds_read_b128 v[36:39], v21 offset:4096
    v_mfma_f32_16x16x32_bf16 v[208:211], v[40:43], v[88:91], v[208:211]
    v_mfma_f32_16x16x32_bf16 v[212:215], v[40:43], v[96:99], v[212:215]
    v_mfma_f32_16x16x32_bf16 v[216:219], v[40:43], v[104:107], v[216:219]
    ds_read_b128 v[40:43], v22 offset:0
    v_mfma_f32_16x16x32_bf16 v[220:223], v[44:47], v[88:91], v[220:223]
    v_mfma_f32_16x16x32_bf16 v[224:227], v[44:47], v[96:99], v[224:227]
    v_mfma_f32_16x16x32_bf16 v[228:231], v[44:47], v[104:107], v[228:231]
    ds_read_b128 v[44:47], v22 offset:4096
    v_mfma_f32_16x16x32_bf16 v[232:235], v[48:51], v[88:91], v[232:235]
    v_mfma_f32_16x16x32_bf16 v[236:239], v[48:51], v[96:99], v[236:239]
    v_mfma_f32_16x16x32_bf16 v[240:243], v[48:51], v[104:107], v[240:243]
    ds_read_b128 v[48:51], v23 offset:0
    v_mfma_f32_16x16x32_bf16 v[244:247], v[52:55], v[88:91], v[244:247]
    v_mfma_f32_16x16x32_bf16 v[248:251], v[52:55], v[96:99], v[248:251]
    v_mfma_f32_16x16x32_bf16 v[252:255], v[52:55], v[104:107], v[252:255]
    ds_read_b128 v[52:55], v23 offset:4096
    s_add_u32 s9, s9, 1
    s_cmp_lt_u32 s9, 7
    s_cbranch_scc1 .Lchunk_b
    s_waitcnt lgkmcnt(2)
    v_mfma_f32_16x16x32_bf16 v[64:67], v[24:27], v[112:115], 0
    v_mfma_f32_16x16x32_bf16 v[72:75], v[24:27], v[128:131], 0
    v_mfma_f32_16x16x32_bf16 v[80:83], v[24:27], v[144:147], 0
    ds_read_b128 v[24:27], v20 offset:8192
    v_mfma_f32_16x16x32_bf16 v[68:71], v[28:31], v[112:115], 0
    v_mfma_f32_16x16x32_bf16 v[76:79], v[28:31], v[128:131], 0
    v_mfma_f32_16x16x32_bf16 v[84:87], v[28:31], v[144:147], 0
    ds_read_b128 v[28:31], v20 offset:12288
    v_mfma_f32_16x16x32_bf16 v[64:67], v[32:35], v[116:119], v[64:67]
    v_mfma_f32_16x16x32_bf16 v[72:75], v[32:35], v[132:135], v[72:75]
    v_mfma_f32_16x16x32_bf16 v[80:83], v[32:35], v[148:151], v[80:83]
    ds_read_b128 v[32:35], v21 offset:8192
    v_mfma_f32_16x16x32_bf16 v[68:71], v[36:39], v[116:119], v[68:71]
    v_mfma_f32_16x16x32_bf16 v[76:79], v[36:39], v[132:135], v[76:79]
    v_mfma_f32_16x16x32_bf16 v[84:87], v[36:39], v[148:151], v[84:87]
    ds_read_b128 v[36:39], v21 offset:12288
    v_mfma_f32_16x16x32_bf16 v[64:67], v[40:43], v[120:123], v[64:67]
    v_mfma_f32_16x16x32_bf16 v[72:75], v[40:43], v[136:139], v[72:75]
    v_mfma_f32_16x16x32_bf16 v[80:83], v[40:43], v[152:155], v[80:83]
    ds_read_b128 v[40:43], v22 offset:8192
    v_mfma_f32_16x16x32_bf16 v[68:71], v[44:47], v[120:123], v[68:71]
    v_mfma_f32_16x16x32_bf16 v[76:79], v[44:47], v[136:139], v[76:79]
    v_mfma_f32_16x16x32_bf16 v[84:87], v[44:47], v[152:155], v[84:87]
    ds_read_b128 v[44:47], v22 offset:12288
    s_waitcnt lgkmcnt(3)
    v_mfma_f32_16x16x32_bf16 v[64:67], v[48:51], v[124:127], v[64:67]
    v_mfma_f32_16x16x32_bf16 v[72:75], v[48:51], v[140:143], v[72:75]
    v_mfma_f32_16x16x32_bf16 v[80:83], v[48:51], v[156:159], v[80:83]
    ds_read_b128 v[48:51], v23 offset:8192
    v_mfma_f32_16x16x32_bf16 v[68:71], v[52:55], v[124:127], v[68:71]
    v_mfma_f32_16x16x32_bf16 v[76:79], v[52:55], v[140:143], v[76:79]
    v_mfma_f32_16x16x32_bf16 v[84:87], v[52:55], v[156:159], v[84:87]
    ds_read_b128 v[52:55], v23 offset:12288
    v_mfma_f32_16x16x32_bf16 v[88:91], v[24:27], v[112:115], 0
    v_max_f32 v7, v64, v65
    v_max_f32 v8, v72, v73
    v_mfma_f32_16x16x32_bf16 v[96:99], v[24:27], v[128:131], 0
    v_mfma_f32_16x16x32_bf16 v[104:107], v[24:27], v[144:147], 0
    v_max_f32 v9, v80, v81
    v_mfma_f32_16x16x32_bf16 v[92:95], v[28:31], v[112:115], 0
    v_mfma_f32_16x16x32_bf16 v[100:103], v[28:31], v[128:131], 0
    v_max3_f32 v7, v7, v66, v67
    v_mfma_f32_16x16x32_bf16 v[108:111], v[28:31], v[144:147], 0
    v_mfma_f32_16x16x32_bf16 v[88:91], v[32:35], v[116:119], v[88:91]
    v_max3_f32 v8, v8, v74, v75
    v_mfma_f32_16x16x32_bf16 v[96:99], v[32:35], v[132:135], v[96:99]
    s_waitcnt lgkmcnt(0)
    s_barrier
    v_mfma_f32_16x16x32_bf16 v[104:107], v[32:35], v[148:151], v[104:107]
    v_max3_f32 v9, v9, v82, v83
    v_mfma_f32_16x16x32_bf16 v[92:95], v[36:39], v[116:119], v[92:95]
    v_mfma_f32_16x16x32_bf16 v[100:103], v[36:39], v[132:135], v[100:103]
    v_max3_f32 v7, v7, v68, v69
    v_mfma_f32_16x16x32_bf16 v[108:111], v[36:39], v[148:151], v[108:111]
    v_mfma_f32_16x16x32_bf16 v[88:91], v[40:43], v[120:123], v[88:91]
    v_max3_f32 v8, v8, v76, v77
    v_mfma_f32_16x16x32_bf16 v[96:99], v[40:43], v[136:139], v[96:99]
    v_mfma_f32_16x16x32_bf16 v[104:107], v[40:43], v[152:155], v[104:107]
    v_max3_f32 v9, v9, v84, v85
    v_mfma_f32_16x16x32_bf16 v[92:95], v[44:47], v[120:123], v[92:95]
    v_mfma_f32_16x16x32_bf16 v[100:103], v[44:47], v[136:139], v[100:103]
    v_max3_f32 v7, v7, v70, v71
    v_mfma_f32_16x16x32_bf16 v[108:111], v[44:47], v[152:155], v[108:111]
    v_mfma_f32_16x16x32_bf16 v[88:91], v[48:51], v[124:127], v[88:91]
    v_max3_f32 v8, v8, v78, v79
    v_mfma_f32_16x16x32_bf16 v[96:99], v[48:51], v[140:143], v[96:99]
    v_mfma_f32_16x16x32_bf16 v[104:107], v[48:51], v[156:159], v[104:107]
    v_max3_f32 v9, v9, v86, v87
    v_mfma_f32_16x16x32_bf16 v[92:95], v[52:55], v[124:127], v[92:95]
    v_mfma_f32_16x16x32_bf16 v[100:103], v[52:55], v[140:143], v[100:103]
    v_mfma_f32_16x16x32_bf16 v[108:111], v[52:55], v[156:159], v[108:111]
    s_nop 0
    v_max3_f32 v7, v7, v88, v89
    s_nop 0
    v_max3_f32 v8, v8, v96, v97
    v_max3_f32 v9, v9, v104, v105
    v_max3_f32 v7, v7, v90, v91
    v_max3_f32 v8, v8, v98, v99
    v_max3_f32 v9, v9, v106, v107
    v_max3_f32 v7, v7, v92, v93
    v_max3_f32 v8, v8, v100, v101
    v_max3_f32 v9, v9, v108, v109
    v_max3_f32 v7, v7, v94, v95
    v_max3_f32 v8, v8, v102, v103
    v_max3_f32 v9, v9, v110, v111
    v_fma_f32 v10, v7, s36, -v3
    v_fma_f32 v12, v8, s36, -v4
    v_fma_f32 v13, v9, s36, -v6
    v_max3_f32 v10, v10, v12, v13
    v_cmp_nge_f32 vcc, 0x41000000, v10
    s_nop 4
    s_cbranch_vccnz .Lrs_19_s
.Lrs_19:
    v_pk_fma_f32 v[64:65], v[64:65], s[36:37], v[2:3] op_sel:[0,0,1] op_sel_hi:[1,1,1] neg_lo:[0,0,1] neg_hi:[0,0,1]
    v_pk_fma_f32 v[66:67], v[66:67], s[36:37], v[2:3] op_sel:[0,0,1] op_sel_hi:[1,1,1] neg_lo:[0,0,1] neg_hi:[0,0,1]
    v_pk_fma_f32 v[68:69], v[68:69], s[36:37], v[2:3] op_sel:[0,0,1] op_sel_hi:[1,1,1] neg_lo:[0,0,1] neg_hi:[0,0,1]
    v_pk_fma_f32 v[70:71], v[70:71], s[36:37], v[2:3] op_sel:[0,0,1] op_sel_hi:[1,1,1] neg_lo:[0,0,1] neg_hi:[0,0,1]
    v_pk_fma_f32 v[72:73], v[72:73], s[36:37], v[4:5] op_sel:[0,0,0] op_sel_hi:[1,1,0] neg_lo:[0,0,1] neg_hi:[0,0,1]
    v_pk_fma_f32 v[74:75], v[74:75], s[36:37], v[4:5] op_sel:[0,0,0] op_sel_hi:[1,1,0] neg_lo:[0,0,1] neg_hi:[0,0,1]
    v_pk_fma_f32 v[76:77], v[76:77], s[36:37], v[4:5] op_sel:[0,0,0] op_sel_hi:[1,1,0] neg_lo:[0,0,1] neg_hi:[0,0,1]
    v_pk_fma_f32 v[78:79], v[78:79], s[36:37], v[4:5] op_sel:[0,0,0] op_sel_hi:[1,1,0] neg_lo:[0,0,1] neg_hi:[0,0,1]
    v_exp_f32 v64, v64
    v_exp_f32 v65, v65
    v_exp_f32 v66, v66
    v_exp_f32 v67, v67
    v_exp_f32 v68, v68
    v_exp_f32 v69, v69
    v_exp_f32 v70, v70
    v_exp_f32 v71, v71
    v_pk_add_f32 v[14:15], v[14:15], v[64:65]
    v_pk_add_f32 v[14:15], v[14:15], v[66:67]
    v_pk_add_f32 v[14:15], v[14:15], v[68:69]
    v_pk_add_f32 v[14:15], v[14:15], v[70:71]
    v_cvt_pk_bf16_f32 v64, v64, v65
    v_cvt_pk_bf16_f32 v65, v66, v67
    v_cvt_pk_bf16_f32 v66, v68, v69
    v_cvt_pk_bf16_f32 v67, v70, v71
    v_pk_fma_f32 v[80:81], v[80:81], s[36:37], v[6:7] op_sel:[0,0,0] op_sel_hi:[1,1,0] neg_lo:[0,0,1] neg_hi:[0,0,1]
    v_pk_fma_f32 v[82:83], v[82:83], s[36:37], v[6:7] op_sel:[0,0,0] op_sel_hi:[1,1,0] neg_lo:[0,0,1] neg_hi:[0,0,1]
    v_pk_fma_f32 v[84:85], v[84:85], s[36:37], v[6:7] op_sel:[0,0,0] op_sel_hi:[1,1,0] neg_lo:[0,0,1] neg_hi:[0,0,1]
    v_pk_fma_f32 v[86:87], v[86:87], s[36:37], v[6:7] op_sel:[0,0,0] op_sel_hi:[1,1,0] neg_lo:[0,0,1] neg_hi:[0,0,1]
    v_exp_f32 v72, v72
    v_exp_f32 v73, v73
    v_exp_f32 v74, v74
    v_exp_f32 v75, v75
    ds_read_b32 v0, v1
    v_exp_f32 v76, v76
    v_exp_f32 v77, v77
    v_exp_f32 v78, v78
    v_exp_f32 v79, v79
    v_pk_add_f32 v[16:17], v[16:17], v[72:73]
    v_pk_add_f32 v[16:17], v[16:17], v[74:75]
    v_pk_add_f32 v[16:17], v[16:17], v[76:77]
    v_pk_add_f32 v[16:17], v[16:17], v[78:79]
    v_cvt_pk_bf16_f32 v72, v72, v73
    v_cvt_pk_bf16_f32 v73, v74, v75
    v_cvt_pk_bf16_f32 v74, v76, v77
    v_cvt_pk_bf16_f32 v75, v78, v79
    v_pk_fma_f32 v[88:89], v[88:89], s[36:37], v[2:3] op_sel:[0,0,1] op_sel_hi:[1,1,1] neg_lo:[0,0,1] neg_hi:[0,0,1]
    v_pk_fma_f32 v[90:91], v[90:91], s[36:37], v[2:3] op_sel:[0,0,1] op_sel_hi:[1,1,1] neg_lo:[0,0,1] neg_hi:[0,0,1]
    v_pk_fma_f32 v[92:93], v[92:93], s[36:37], v[2:3] op_sel:[0,0,1] op_sel_hi:[1,1,1] neg_lo:[0,0,1] neg_hi:[0,0,1]
    v_pk_fma_f32 v[94:95], v[94:95], s[36:37], v[2:3] op_sel:[0,0,1] op_sel_hi:[1,1,1] neg_lo:[0,0,1] neg_hi:[0,0,1]
    v_exp_f32 v80, v80
    v_exp_f32 v81, v81
    v_exp_f32 v82, v82
    v_exp_f32 v83, v83
    v_exp_f32 v84, v84
    v_exp_f32 v85, v85
    s_waitcnt lgkmcnt(0)
    v_min_u32_dpp v0, v0, v0 quad_perm:[1,0,3,2] row_mask:0xf bank_mask:0xf
    v_exp_f32 v86, v86
    v_exp_f32 v87, v87
    v_min_u32_dpp v0, v0, v0 quad_perm:[2,3,0,1] row_mask:0xf bank_mask:0xf
    v_pk_add_f32 v[18:19], v[18:19], v[80:81]
    v_readfirstlane_b32 s86, v0
    v_pk_add_f32 v[18:19], v[18:19], v[82:83]
    v_pk_add_f32 v[18:19], v[18:19], v[84:85]
    v_pk_add_f32 v[18:19], v[18:19], v[86:87]
    s_add_u32 s85, s85, 2
    s_cmp_ge_u32 s86, s85
    s_cbranch_scc0 .Lck_20_s
.Lck_20:
    ds_read_b64_tr_b16 v[24:25], v56 offset:0
    v_cvt_pk_bf16_f32 v80, v80, v81
    v_cvt_pk_bf16_f32 v81, v82, v83
    ds_read_b64_tr_b16 v[26:27], v56 offset:4096
    v_cvt_pk_bf16_f32 v82, v84, v85
    v_cvt_pk_bf16_f32 v83, v86, v87
    ds_read_b64_tr_b16 v[28:29], v57 offset:0
    v_pk_fma_f32 v[96:97], v[96:97], s[36:37], v[4:5] op_sel:[0,0,0] op_sel_hi:[1,1,0] neg_lo:[0,0,1] neg_hi:[0,0,1]
    v_pk_fma_f32 v[98:99], v[98:99], s[36:37], v[4:5] op_sel:[0,0,0] op_sel_hi:[1,1,0] neg_lo:[0,0,1] neg_hi:[0,0,1]
    ds_read_b64_tr_b16 v[30:31], v57 offset:4096
    v_pk_fma_f32 v[100:101], v[100:101], s[36:37], v[4:5] op_sel:[0,0,0] op_sel_hi:[1,1,0] neg_lo:[0,0,1] neg_hi:[0,0,1]
    v_pk_fma_f32 v[102:103], v[102:103], s[36:37], v[4:5] op_sel:[0,0,0] op_sel_hi:[1,1,0] neg_lo:[0,0,1] neg_hi:[0,0,1]
    ds_read_b64_tr_b16 v[32:33], v58 offset:0
    v_exp_f32 v88, v88
    v_exp_f32 v89, v89
    ds_read_b64_tr_b16 v[34:35], v58 offset:4096
    v_exp_f32 v90, v90
    v_exp_f32 v91, v91
    ds_read_b64_tr_b16 v[36:37], v59 offset:0
    v_exp_f32 v92, v92
    v_exp_f32 v93, v93
    ds_read_b64_tr_b16 v[38:39], v59 offset:4096
    v_exp_f32 v94, v94
    v_exp_f32 v95, v95
    ds_read_b64_tr_b16 v[40:41], v60 offset:0
    v_pk_add_f32 v[14:15], v[14:15], v[88:89]
    v_pk_add_f32 v[14:15], v[14:15], v[90:91]
    ds_read_b64_tr_b16 v[42:43], v60 offset:4096
    v_pk_add_f32 v[14:15], v[14:15], v[92:93]
    v_pk_add_f32 v[14:15], v[14:15], v[94:95]
    ds_read_b64_tr_b16 v[44:45], v61 offset:0
    v_cvt_pk_bf16_f32 v88, v88, v89
    v_cvt_pk_bf16_f32 v89, v90, v91
    ds_read_b64_tr_b16 v[46:47], v61 offset:4096
    v_cvt_pk_bf16_f32 v90, v92, v93
    v_cvt_pk_bf16_f32 v91, v94, v95
    ds_read_b64_tr_b16 v[48:49], v62 offset:0
    v_pk_fma_f32 v[104:105], v[104:105], s[36:37], v[6:7] op_sel:[0,0,0] op_sel_hi:[1,1,0] neg_lo:[0,0,1] neg_hi:[0,0,1]
    v_pk_fma_f32 v[106:107], v[106:107], s[36:37], v[6:7] op_sel:[0,0,0] op_sel_hi:[1,1,0] neg_lo:[0,0,1] neg_hi:[0,0,1]
    ds_read_b64_tr_b16 v[50:51], v62 offset:4096
    v_pk_fma_f32 v[108:109], v[108:109], s[36:37], v[6:7] op_sel:[0,0,0] op_sel_hi:[1,1,0] neg_lo:[0,0,1] neg_hi:[0,0,1]
    v_pk_fma_f32 v[110:111], v[110:111], s[36:37], v[6:7] op_sel:[0,0,0] op_sel_hi:[1,1,0] neg_lo:[0,0,1] neg_hi:[0,0,1]
    ds_read_b64_tr_b16 v[52:53], v63 offset:0
    v_exp_f32 v96, v96
    v_exp_f32 v97, v97
    v_exp_f32 v98, v98
    v_exp_f32 v99, v99
    v_exp_f32 v100, v100
    v_exp_f32 v101, v101
    v_exp_f32 v102, v102
    v_exp_f32 v103, v103
    v_pk_add_f32 v[16:17], v[16:17], v[96:97]
    v_pk_add_f32 v[16:17], v[16:17], v[98:99]
    v_pk_add_f32 v[16:17], v[16:17], v[100:101]
    v_pk_add_f32 v[16:17], v[16:17], v[102:103]
    v_cvt_pk_bf16_f32 v96, v96, v97
    v_cvt_pk_bf16_f32 v97, v98, v99
    v_cvt_pk_bf16_f32 v98, v100, v101
    v_cvt_pk_bf16_f32 v99, v102, v103
    v_exp_f32 v104, v104
    v_exp_f32 v105, v105
    v_exp_f32 v106, v106
    v_exp_f32 v107, v107
    v_exp_f32 v108, v108
    v_exp_f32 v109, v109
    v_exp_f32 v110, v110
    v_exp_f32 v111, v111
    v_pk_add_f32 v[18:19], v[18:19], v[104:105]
    v_pk_add_f32 v[18:19], v[18:19], v[106:107]
    v_pk_add_f32 v[18:19], v[18:19], v[108:109]
    v_pk_add_f32 v[18:19], v[18:19], v[110:111]
    v_cvt_pk_bf16_f32 v104, v104, v105
    v_cvt_pk_bf16_f32 v105, v106, v107
    v_cvt_pk_bf16_f32 v106, v108, v109
    v_cvt_pk_bf16_f32 v107, v110, v111
    s_waitcnt lgkmcnt(0)
    v_mfma_f32_16x16x32_bf16 v[160:163], v[24:27], v[64:67], v[160:163]
    ds_read_b64_tr_b16 v[54:55], v63 offset:4096
    v_mfma_f32_16x16x32_bf16 v[164:167], v[24:27], v[72:75], v[164:167]
    v_mfma_f32_16x16x32_bf16 v[168:171], v[24:27], v[80:83], v[168:171]
    ds_read_b64_tr_b16 v[24:25], v56 offset:8192
    ds_read_b64_tr_b16 v[26:27], v56 offset:12288
    v_mfma_f32_16x16x32_bf16 v[172:175], v[28:31], v[64:67], v[172:175]
    v_mfma_f32_16x16x32_bf16 v[176:179], v[28:31], v[72:75], v[176:179]
    v_mfma_f32_16x16x32_bf16 v[180:183], v[28:31], v[80:83], v[180:183]
    ds_read_b64_tr_b16 v[28:29], v57 offset:8192
    ds_read_b64_tr_b16 v[30:31], v57 offset:12288
    v_mfma_f32_16x16x32_bf16 v[184:187], v[32:35], v[64:67], v[184:187]
    v_mfma_f32_16x16x32_bf16 v[188:191], v[32:35], v[72:75], v[188:191]
    v_mfma_f32_16x16x32_bf16 v[192:195], v[32:35], v[80:83], v[192:195]
    ds_read_b64_tr_b16 v[32:33], v58 offset:8192
    ds_read_b64_tr_b16 v[34:35], v58 offset:12288
    v_mfma_f32_16x16x32_bf16 v[196:199], v[36:39], v[64:67], v[196:199]
    v_mfma_f32_16x16x32_bf16 v[200:203], v[36:39], v[72:75], v[200:203]
    v_mfma_f32_16x16x32_bf16 v[204:207], v[36:39], v[80:83], v[204:207]
    ds_read_b64_tr_b16 v[36:37], v59 offset:8192
    ds_read_b64_tr_b16 v[38:39], v59 offset:12288
    v_mfma_f32_16x16x32_bf16 v[208:211], v[40:43], v[64:67], v[208:211]
    v_mfma_f32_16x16x32_bf16 v[212:215], v[40:43], v[72:75], v[212:215]
    v_mfma_f32_16x16x32_bf16 v[216:219], v[40:43], v[80:83], v[216:219]
    ds_read_b64_tr_b16 v[40:41], v60 offset:8192
    ds_read_b64_tr_b16 v[42:43], v60 offset:12288
    v_mfma_f32_16x16x32_bf16 v[220:223], v[44:47], v[64:67], v[220:223]
    v_mfma_f32_16x16x32_bf16 v[224:227], v[44:47], v[72:75], v[224:227]
    v_mfma_f32_16x16x32_bf16 v[228:231], v[44:47], v[80:83], v[228:231]
    ds_read_b64_tr_b16 v[44:45], v61 offset:8192
    ds_read_b64_tr_b16 v[46:47], v61 offset:12288
    v_mfma_f32_16x16x32_bf16 v[232:235], v[48:51], v[64:67], v[232:235]
    v_mfma_f32_16x16x32_bf16 v[236:239], v[48:51], v[72:75], v[236:239]
    v_mfma_f32_16x16x32_bf16 v[240:243], v[48:51], v[80:83], v[240:243]
    ds_read_b64_tr_b16 v[48:49], v62 offset:8192
    s_waitcnt lgkmcnt(5)
    v_mfma_f32_16x16x32_bf16 v[244:247], v[52:55], v[64:67], v[244:247]
    ds_read_b64_tr_b16 v[50:51], v62 offset:12288
    v_mfma_f32_16x16x32_bf16 v[248:251], v[52:55], v[72:75], v[248:251]
    v_mfma_f32_16x16x32_bf16 v[252:255], v[52:55], v[80:83], v[252:255]
    ds_read_b64_tr_b16 v[52:53], v63 offset:8192
    ds_read_b64_tr_b16 v[54:55], v63 offset:12288
    v_mfma_f32_16x16x32_bf16 v[160:163], v[24:27], v[88:91], v[160:163]
    v_mfma_f32_16x16x32_bf16 v[164:167], v[24:27], v[96:99], v[164:167]
    v_mfma_f32_16x16x32_bf16 v[168:171], v[24:27], v[104:107], v[168:171]
    v_mfma_f32_16x16x32_bf16 v[172:175], v[28:31], v[88:91], v[172:175]
    v_mfma_f32_16x16x32_bf16 v[176:179], v[28:31], v[96:99], v[176:179]
    v_mfma_f32_16x16x32_bf16 v[180:183], v[28:31], v[104:107], v[180:183]
    v_mfma_f32_16x16x32_bf16 v[184:187], v[32:35], v[88:91], v[184:187]
    v_mfma_f32_16x16x32_bf16 v[188:191], v[32:35], v[96:99], v[188:191]
    s_waitcnt lgkmcnt(0)
    s_barrier
    v_mfma_f32_16x16x32_bf16 v[192:195], v[32:35], v[104:107], v[192:195]
    v_mfma_f32_16x16x32_bf16 v[196:199], v[36:39], v[88:91], v[196:199]
    v_mfma_f32_16x16x32_bf16 v[200:203], v[36:39], v[96:99], v[200:203]
    v_mfma_f32_16x16x32_bf16 v[204:207], v[36:39], v[104:107], v[204:207]
    v_mfma_f32_16x16x32_bf16 v[208:211], v[40:43], v[88:91], v[208:211]
    v_mfma_f32_16x16x32_bf16 v[212:215], v[40:43], v[96:99], v[212:215]
    v_mfma_f32_16x16x32_bf16 v[216:219], v[40:43], v[104:107], v[216:219]
    v_mfma_f32_16x16x32_bf16 v[220:223], v[44:47], v[88:91], v[220:223]
    v_mfma_f32_16x16x32_bf16 v[224:227], v[44:47], v[96:99], v[224:227]
    v_mfma_f32_16x16x32_bf16 v[228:231], v[44:47], v[104:107], v[228:231]
    v_mfma_f32_16x16x32_bf16 v[232:235], v[48:51], v[88:91], v[232:235]
    v_mfma_f32_16x16x32_bf16 v[236:239], v[48:51], v[96:99], v[236:239]
    v_mfma_f32_16x16x32_bf16 v[240:243], v[48:51], v[104:107], v[240:243]
    v_mfma_f32_16x16x32_bf16 v[244:247], v[52:55], v[88:91], v[244:247]
    v_mfma_f32_16x16x32_bf16 v[248:251], v[52:55], v[96:99], v[248:251]
    v_mfma_f32_16x16x32_bf16 v[252:255], v[52:55], v[104:107], v[252:255]
    s_mov_b32 s85, 40
    v_add_f32 v14, v14, v15
    v_add_f32 v16, v16, v17
    v_add_f32 v18, v18, v19
    v_mov_b32 v10, v14
    v_mov_b32 v12, v16
    v_mov_b32 v13, v18
    v_permlane32_swap_b32 v10, v14
    v_permlane32_swap_b32 v12, v16
    v_permlane32_swap_b32 v13, v18
    v_add_f32 v14, v10, v14
    v_add_f32 v16, v12, v16
    v_add_f32 v18, v13, v18
    v_mov_b32 v10, v14
    v_mov_b32 v12, v16
    v_mov_b32 v13, v18
    v_permlane16_swap_b32 v10, v14
    v_permlane16_swap_b32 v12, v16
    v_permlane16_swap_b32 v13, v18
    v_add_f32 v14, v10, v14
    v_add_f32 v16, v12, v16
    v_add_f32 v18, v13, v18
    v_rcp_f32 v14, v14
    v_rcp_f32 v16, v16
    v_rcp_f32 v18, v18
    s_and_b32 s3, s4, 1
    s_lshl_b32 s3, s3, 14
    s_cmp_ge_u32 s4, 2
    s_cselect_b32 s11, 0, 32768
    s_add_u32 s3, s3, 98304
    s_add_u32 s3, s3, s11
    v_add_u32 v20, s3, v2
    v_add_u32 v8, 98304, v2
    v_pk_mul_f32 v[160:161], v[160:161], v[14:15] op_sel:[0,0] op_sel_hi:[1,0]
    v_pk_mul_f32 v[162:163], v[162:163], v[14:15] op_sel:[0,0] op_sel_hi:[1,0]
    v_pk_mul_f32 v[172:173], v[172:173], v[14:15] op_sel:[0,0] op_sel_hi:[1,0]
    v_pk_mul_f32 v[174:175], v[174:175], v[14:15] op_sel:[0,0] op_sel_hi:[1,0]
    v_cvt_pk_bf16_f32 v112, v160, v161
    v_cvt_pk_bf16_f32 v113, v162, v163
    v_cvt_pk_bf16_f32 v114, v172, v173
    v_cvt_pk_bf16_f32 v115, v174, v175
    ds_write_b128 v20, v[112:115] offset:0
    v_pk_mul_f32 v[164:165], v[164:165], v[16:17] op_sel:[0,0] op_sel_hi:[1,0]
    v_pk_mul_f32 v[166:167], v[166:167], v[16:17] op_sel:[0,0] op_sel_hi:[1,0]
    v_pk_mul_f32 v[176:177], v[176:177], v[16:17] op_sel:[0,0] op_sel_hi:[1,0]
    v_pk_mul_f32 v[178:179], v[178:179], v[16:17] op_sel:[0,0] op_sel_hi:[1,0]
    v_cvt_pk_bf16_f32 v128, v164, v165
    v_cvt_pk_bf16_f32 v129, v166, v167
    v_cvt_pk_bf16_f32 v130, v176, v177
    v_cvt_pk_bf16_f32 v131, v178, v179
    ds_write_b128 v20, v[128:131] offset:4096
    v_pk_mul_f32 v[168:169], v[168:169], v[18:19] op_sel:[0,0] op_sel_hi:[1,0]
    v_pk_mul_f32 v[170:171], v[170:171], v[18:19] op_sel:[0,0] op_sel_hi:[1,0]
    v_pk_mul_f32 v[180:181], v[180:181], v[18:19] op_sel:[0,0] op_sel_hi:[1,0]
    v_pk_mul_f32 v[182:183], v[182:183], v[18:19] op_sel:[0,0] op_sel_hi:[1,0]
    v_cvt_pk_bf16_f32 v144, v168, v169
    v_cvt_pk_bf16_f32 v145, v170, v171
    v_cvt_pk_bf16_f32 v146, v180, v181
    v_cvt_pk_bf16_f32 v147, v182, v183
    ds_write_b128 v20, v[144:147] offset:10240
    v_pk_mul_f32 v[184:185], v[184:185], v[14:15] op_sel:[0,0] op_sel_hi:[1,0]
    v_pk_mul_f32 v[186:187], v[186:187], v[14:15] op_sel:[0,0] op_sel_hi:[1,0]
    v_pk_mul_f32 v[196:197], v[196:197], v[14:15] op_sel:[0,0] op_sel_hi:[1,0]
    v_pk_mul_f32 v[198:199], v[198:199], v[14:15] op_sel:[0,0] op_sel_hi:[1,0]
    v_cvt_pk_bf16_f32 v116, v184, v185
    v_cvt_pk_bf16_f32 v117, v186, v187
    v_cvt_pk_bf16_f32 v118, v196, v197
    v_cvt_pk_bf16_f32 v119, v198, v199
    ds_write_b128 v20, v[116:119] offset:1024
    v_pk_mul_f32 v[188:189], v[188:189], v[16:17] op_sel:[0,0] op_sel_hi:[1,0]
    v_pk_mul_f32 v[190:191], v[190:191], v[16:17] op_sel:[0,0] op_sel_hi:[1,0]
    v_pk_mul_f32 v[200:201], v[200:201], v[16:17] op_sel:[0,0] op_sel_hi:[1,0]
    v_pk_mul_f32 v[202:203], v[202:203], v[16:17] op_sel:[0,0] op_sel_hi:[1,0]
    v_cvt_pk_bf16_f32 v132, v188, v189
    v_cvt_pk_bf16_f32 v133, v190, v191
    v_cvt_pk_bf16_f32 v134, v200, v201
    v_cvt_pk_bf16_f32 v135, v202, v203
    ds_write_b128 v20, v[132:135] offset:5120
    v_pk_mul_f32 v[192:193], v[192:193], v[18:19] op_sel:[0,0] op_sel_hi:[1,0]
    v_pk_mul_f32 v[194:195], v[194:195], v[18:19] op_sel:[0,0] op_sel_hi:[1,0]
    v_pk_mul_f32 v[204:205], v[204:205], v[18:19] op_sel:[0,0] op_sel_hi:[1,0]
    v_pk_mul_f32 v[206:207], v[206:207], v[18:19] op_sel:[0,0] op_sel_hi:[1,0]
    v_cvt_pk_bf16_f32 v148, v192, v193
    v_cvt_pk_bf16_f32 v149, v194, v195
    v_cvt_pk_bf16_f32 v150, v204, v205
    v_cvt_pk_bf16_f32 v151, v206, v207
    ds_write_b128 v20, v[148:151] offset:11264
    v_pk_mul_f32 v[208:209], v[208:209], v[14:15] op_sel:[0,0] op_sel_hi:[1,0]
    v_pk_mul_f32 v[210:211], v[210:211], v[14:15] op_sel:[0,0] op_sel_hi:[1,0]
    v_pk_mul_f32 v[220:221], v[220:221], v[14:15] op_sel:[0,0] op_sel_hi:[1,0]
    v_pk_mul_f32 v[222:223], v[222:223], v[14:15] op_sel:[0,0] op_sel_hi:[1,0]
    v_cvt_pk_bf16_f32 v120, v208, v209
    v_cvt_pk_bf16_f32 v121, v210, v211
    v_cvt_pk_bf16_f32 v122, v220, v221
    v_cvt_pk_bf16_f32 v123, v222, v223
    ds_write_b128 v20, v[120:123] offset:2048
    v_pk_mul_f32 v[212:213], v[212:213], v[16:17] op_sel:[0,0] op_sel_hi:[1,0]
    v_pk_mul_f32 v[214:215], v[214:215], v[16:17] op_sel:[0,0] op_sel_hi:[1,0]
    v_pk_mul_f32 v[224:225], v[224:225], v[16:17] op_sel:[0,0] op_sel_hi:[1,0]
    v_pk_mul_f32 v[226:227], v[226:227], v[16:17] op_sel:[0,0] op_sel_hi:[1,0]
    v_cvt_pk_bf16_f32 v136, v212, v213
    v_cvt_pk_bf16_f32 v137, v214, v215
    v_cvt_pk_bf16_f32 v138, v224, v225
    v_cvt_pk_bf16_f32 v139, v226, v227
    ds_write_b128 v20, v[136:139] offset:8192
    v_pk_mul_f32 v[216:217], v[216:217], v[18:19] op_sel:[0,0] op_sel_hi:[1,0]
    v_pk_mul_f32 v[218:219], v[218:219], v[18:19] op_sel:[0,0] op_sel_hi:[1,0]
    v_pk_mul_f32 v[228:229], v[228:229], v[18:19] op_sel:[0,0] op_sel_hi:[1,0]
    v_pk_mul_f32 v[230:231], v[230:231], v[18:19] op_sel:[0,0] op_sel_hi:[1,0]
    v_cvt_pk_bf16_f32 v152, v216, v217
    v_cvt_pk_bf16_f32 v153, v218, v219
    v_cvt_pk_bf16_f32 v154, v228, v229
    v_cvt_pk_bf16_f32 v155, v230, v231
    ds_write_b128 v20, v[152:155] offset:12288
    v_pk_mul_f32 v[232:233], v[232:233], v[14:15] op_sel:[0,0] op_sel_hi:[1,0]
    v_pk_mul_f32 v[234:235], v[234:235], v[14:15] op_sel:[0,0] op_sel_hi:[1,0]
    v_pk_mul_f32 v[244:245], v[244:245], v[14:15] op_sel:[0,0] op_sel_hi:[1,0]
    v_pk_mul_f32 v[246:247], v[246:247], v[14:15] op_sel:[0,0] op_sel_hi:[1,0]
    v_cvt_pk_bf16_f32 v124, v232, v233
    v_cvt_pk_bf16_f32 v125, v234, v235
    v_cvt_pk_bf16_f32 v126, v244, v245
    v_cvt_pk_bf16_f32 v127, v246, v247
    ds_write_b128 v20, v[124:127] offset:3072
    v_pk_mul_f32 v[236:237], v[236:237], v[16:17] op_sel:[0,0] op_sel_hi:[1,0]
    v_pk_mul_f32 v[238:239], v[238:239], v[16:17] op_sel:[0,0] op_sel_hi:[1,0]
    v_pk_mul_f32 v[248:249], v[248:249], v[16:17] op_sel:[0,0] op_sel_hi:[1,0]
    v_pk_mul_f32 v[250:251], v[250:251], v[16:17] op_sel:[0,0] op_sel_hi:[1,0]
    v_cvt_pk_bf16_f32 v140, v236, v237
    v_cvt_pk_bf16_f32 v141, v238, v239
    v_cvt_pk_bf16_f32 v142, v248, v249
    v_cvt_pk_bf16_f32 v143, v250, v251
    ds_write_b128 v20, v[140:143] offset:9216
    v_pk_mul_f32 v[240:241], v[240:241], v[18:19] op_sel:[0,0] op_sel_hi:[1,0]
    v_pk_mul_f32 v[242:243], v[242:243], v[18:19] op_sel:[0,0] op_sel_hi:[1,0]
    v_pk_mul_f32 v[252:253], v[252:253], v[18:19] op_sel:[0,0] op_sel_hi:[1,0]
    v_pk_mul_f32 v[254:255], v[254:255], v[18:19] op_sel:[0,0] op_sel_hi:[1,0]
    v_cvt_pk_bf16_f32 v156, v240, v241
    v_cvt_pk_bf16_f32 v157, v242, v243
    v_cvt_pk_bf16_f32 v158, v252, v253
    v_cvt_pk_bf16_f32 v159, v254, v255
    ds_write_b128 v20, v[156:159] offset:13312
    v_mov_b32 v24, v5
    v_xor_b32 v25, 32, v5
    v_xor_b32 v26, 64, v5
    v_xor_b32 v27, 96, v5
    v_xor_b32 v28, 128, v5
    v_xor_b32 v29, 160, v5
    v_xor_b32 v30, 192, v5
    v_xor_b32 v31, 224, v5
    v_xor_b32 v32, 0x10000, v24
    v_xor_b32 v33, 0x10000, v25
    v_xor_b32 v34, 0x10000, v26
    v_xor_b32 v35, 0x10000, v27
    v_xor_b32 v36, 0x10000, v28
    v_xor_b32 v37, 0x10000, v29
    v_xor_b32 v38, 0x10000, v30
    v_xor_b32 v39, 0x10000, v31
    s_and_b32 s74, s6, s7
    s_lshl_b32 s11, s5, s7
    s_add_u32 s11, s11, s74
    s_and_b32 s3, s6, 14
    s_lshl_b32 s3, s3, 4
    s_add_u32 s3, s3, 128
    s_add_u32 s3, s3, s11
    s_mul_i32 s3, s3, 49152
    s_mul_i32 s11, s4, 12288
    s_add_u32 s16, s3, s11
    s_add_u32 s17, s16, 4096
    s_add_u32 s18, s16, 8192
    s_add_u32 s19, s16, 786432
    s_add_u32 s20, s16, 790528
    s_add_u32 s21, s16, 794624
    s_waitcnt lgkmcnt(0)
    s_barrier
    s_add_u32 s85, s85, 1
    s_cmp_ge_u32 s86, s85
    s_cbranch_scc0 .Lck_21_s
.Lck_21:
    ds_read_b128 v[48:51], v8 offset:32768
    ds_read_b64_tr_b16 v[32:33], v24 offset:0
    ds_read_b64_tr_b16 v[34:35], v24 offset:16384
    ds_read_b64_tr_b16 v[36:37], v25 offset:0
    ds_read_b64_tr_b16 v[38:39], v25 offset:16384
    ds_read_b128 v[52:55], v8 offset:36864
    ds_read_b128 v[56:59], v8 offset:43008
    ds_read_b128 v[60:63], v8 offset:0
    ds_read_b128 v[12:15], v8 offset:4096
    ds_read_b128 v[16:19], v8 offset:10240
    ds_read_b64_tr_b16 v[40:41], v26 offset:0
    ds_read_b64_tr_b16 v[42:43], v26 offset:16384
    ds_read_b64_tr_b16 v[44:45], v27 offset:0
    ds_read_b64_tr_b16 v[46:47], v27 offset:16384
    s_waitcnt lgkmcnt(11)
    v_mfma_f32_16x16x32_bf16 v[64:67], v[32:35], v[48:51], 0
    s_waitcnt lgkmcnt(9)
    v_mfma_f32_16x16x32_bf16 v[76:79], v[36:39], v[48:51], 0
    s_waitcnt lgkmcnt(8)
    v_mfma_f32_16x16x32_bf16 v[68:71], v[32:35], v[52:55], 0
    v_mfma_f32_16x16x32_bf16 v[80:83], v[36:39], v[52:55], 0
    s_waitcnt lgkmcnt(7)
    v_mfma_f32_16x16x32_bf16 v[72:75], v[32:35], v[56:59], 0
    v_mfma_f32_16x16x32_bf16 v[84:87], v[36:39], v[56:59], 0
    s_waitcnt lgkmcnt(6)
    v_mfma_f32_16x16x32_bf16 v[160:163], v[32:35], v[60:63], 0
    v_mfma_f32_16x16x32_bf16 v[172:175], v[36:39], v[60:63], 0
    s_waitcnt lgkmcnt(0)
    v_mfma_f32_16x16x32_bf16 v[164:167], v[32:35], v[12:15], 0
    v_mfma_f32_16x16x32_bf16 v[176:179], v[36:39], v[12:15], 0
    v_mfma_f32_16x16x32_bf16 v[168:171], v[32:35], v[16:19], 0
    ds_read_b64_tr_b16 v[32:33], v28 offset:0
    ds_read_b64_tr_b16 v[34:35], v28 offset:16384
    v_mfma_f32_16x16x32_bf16 v[180:183], v[36:39], v[16:19], 0
    ds_read_b64_tr_b16 v[36:37], v29 offset:0
    ds_read_b64_tr_b16 v[38:39], v29 offset:16384
    v_mfma_f32_16x16x32_bf16 v[88:91], v[40:43], v[48:51], 0
    ds_read_b32 v0, v1
    v_mfma_f32_16x16x32_bf16 v[92:95], v[40:43], v[52:55], 0
    v_mfma_f32_16x16x32_bf16 v[96:99], v[40:43], v[56:59], 0
    v_mfma_f32_16x16x32_bf16 v[184:187], v[40:43], v[60:63], 0
    v_mfma_f32_16x16x32_bf16 v[188:191], v[40:43], v[12:15], 0
    v_mfma_f32_16x16x32_bf16 v[192:195], v[40:43], v[16:19], 0
    ds_read_b64_tr_b16 v[40:41], v30 offset:0
    ds_read_b64_tr_b16 v[42:43], v30 offset:16384
    v_mfma_f32_16x16x32_bf16 v[100:103], v[44:47], v[48:51], 0
    v_mfma_f32_16x16x32_bf16 v[104:107], v[44:47], v[52:55], 0
    v_mfma_f32_16x16x32_bf16 v[108:111], v[44:47], v[56:59], 0
    s_waitcnt lgkmcnt(2)
    v_min_u32_dpp v0, v0, v0 quad_perm:[1,0,3,2] row_mask:0xf bank_mask:0xf
    v_mfma_f32_16x16x32_bf16 v[196:199], v[44:47], v[60:63], 0
    v_mfma_f32_16x16x32_bf16 v[200:203], v[44:47], v[12:15], 0
    v_min_u32_dpp v0, v0, v0 quad_perm:[2,3,0,1] row_mask:0xf bank_mask:0xf
    v_mfma_f32_16x16x32_bf16 v[204:207], v[44:47], v[16:19], 0
    v_readfirstlane_b32 s86, v0
    ds_read_b64_tr_b16 v[44:45], v31 offset:0
    v_mfma_f32_16x16x32_bf16 v[112:115], v[32:35], v[48:51], 0
    ds_read_b64_tr_b16 v[46:47], v31 offset:16384
    v_mfma_f32_16x16x32_bf16 v[116:119], v[32:35], v[52:55], 0
    v_mfma_f32_16x16x32_bf16 v[120:123], v[32:35], v[56:59], 0
    v_mfma_f32_16x16x32_bf16 v[208:211], v[32:35], v[60:63], 0
    v_mfma_f32_16x16x32_bf16 v[212:215], v[32:35], v[12:15], 0
    v_mfma_f32_16x16x32_bf16 v[216:219], v[32:35], v[16:19], 0
    v_mfma_f32_16x16x32_bf16 v[124:127], v[36:39], v[48:51], 0
    v_mfma_f32_16x16x32_bf16 v[128:131], v[36:39], v[52:55], 0
    v_mfma_f32_16x16x32_bf16 v[132:135], v[36:39], v[56:59], 0
    s_waitcnt lgkmcnt(0)
    s_barrier
    v_mfma_f32_16x16x32_bf16 v[220:223], v[36:39], v[60:63], 0
    s_add_u32 s85, s85, 1
    s_cmp_ge_u32 s86, s85
    s_cbranch_scc0 .Lck_22_s
.Lck_22:
    ds_read_b128 v[20:23], v8 offset:33792
    v_mfma_f32_16x16x32_bf16 v[224:227], v[36:39], v[12:15], 0
    ds_read_b64_tr_b16 v[32:33], v24 offset:32768
    ds_read_b64_tr_b16 v[34:35], v24 offset:49152
    v_mfma_f32_16x16x32_bf16 v[228:231], v[36:39], v[16:19], 0
    ds_read_b64_tr_b16 v[36:37], v25 offset:32768
    ds_read_b64_tr_b16 v[38:39], v25 offset:49152
    v_mfma_f32_16x16x32_bf16 v[136:139], v[40:43], v[48:51], 0
    ds_read_b128 v[4:7], v8 offset:37888
    v_mfma_f32_16x16x32_bf16 v[148:151], v[44:47], v[48:51], 0
    ds_read_b128 v[48:51], v8 offset:44032
    v_mfma_f32_16x16x32_bf16 v[140:143], v[40:43], v[52:55], 0
    v_mfma_f32_16x16x32_bf16 v[152:155], v[44:47], v[52:55], 0
    ds_read_b128 v[52:55], v8 offset:1024
    v_mfma_f32_16x16x32_bf16 v[144:147], v[40:43], v[56:59], 0
    v_mfma_f32_16x16x32_bf16 v[156:159], v[44:47], v[56:59], 0
    ds_read_b128 v[56:59], v8 offset:5120
    v_mfma_f32_16x16x32_bf16 v[232:235], v[40:43], v[60:63], 0
    v_mfma_f32_16x16x32_bf16 v[244:247], v[44:47], v[60:63], 0
    ds_read_b128 v[60:63], v8 offset:11264
    v_mfma_f32_16x16x32_bf16 v[236:239], v[40:43], v[12:15], 0
    v_mfma_f32_16x16x32_bf16 v[248:251], v[44:47], v[12:15], 0
    v_mfma_f32_16x16x32_bf16 v[240:243], v[40:43], v[16:19], 0
    ds_read_b64_tr_b16 v[40:41], v26 offset:32768
    ds_read_b64_tr_b16 v[42:43], v26 offset:49152
    v_mfma_f32_16x16x32_bf16 v[252:255], v[44:47], v[16:19], 0
    ds_read_b64_tr_b16 v[44:45], v27 offset:32768
    s_waitcnt lgkmcnt(5)
    v_mfma_f32_16x16x32_bf16 v[64:67], v[32:35], v[20:23], v[64:67]
    ds_read_b64_tr_b16 v[46:47], v27 offset:49152
    v_mfma_f32_16x16x32_bf16 v[76:79], v[36:39], v[20:23], v[76:79]
    v_mfma_f32_16x16x32_bf16 v[68:71], v[32:35], v[4:7], v[68:71]
    v_mfma_f32_16x16x32_bf16 v[80:83], v[36:39], v[4:7], v[80:83]
    v_mfma_f32_16x16x32_bf16 v[72:75], v[32:35], v[48:51], v[72:75]
    v_mfma_f32_16x16x32_bf16 v[84:87], v[36:39], v[48:51], v[84:87]
    v_mfma_f32_16x16x32_bf16 v[160:163], v[32:35], v[52:55], v[160:163]
    v_mfma_f32_16x16x32_bf16 v[172:175], v[36:39], v[52:55], v[172:175]
    s_waitcnt lgkmcnt(1)
    v_mfma_f32_16x16x32_bf16 v[164:167], v[32:35], v[56:59], v[164:167]
    v_mfma_f32_16x16x32_bf16 v[176:179], v[36:39], v[56:59], v[176:179]
    v_mfma_f32_16x16x32_bf16 v[168:171], v[32:35], v[60:63], v[168:171]
    ds_read_b64_tr_b16 v[32:33], v28 offset:32768
    ds_read_b64_tr_b16 v[34:35], v28 offset:49152
    v_mfma_f32_16x16x32_bf16 v[180:183], v[36:39], v[60:63], v[180:183]
    ds_read_b64_tr_b16 v[36:37], v29 offset:32768
    ds_read_b64_tr_b16 v[38:39], v29 offset:49152
    v_mfma_f32_16x16x32_bf16 v[88:91], v[40:43], v[20:23], v[88:91]
    ds_read_b32 v0, v1
    v_mfma_f32_16x16x32_bf16 v[92:95], v[40:43], v[4:7], v[92:95]
    v_mfma_f32_16x16x32_bf16 v[96:99], v[40:43], v[48:51], v[96:99]
    v_mfma_f32_16x16x32_bf16 v[184:187], v[40:43], v[52:55], v[184:187]
    v_mfma_f32_16x16x32_bf16 v[188:191], v[40:43], v[56:59], v[188:191]
    v_mfma_f32_16x16x32_bf16 v[192:195], v[40:43], v[60:63], v[192:195]
    ds_read_b64_tr_b16 v[40:41], v30 offset:32768
    s_waitcnt lgkmcnt(6)
    v_mfma_f32_16x16x32_bf16 v[100:103], v[44:47], v[20:23], v[100:103]
    ds_read_b64_tr_b16 v[42:43], v30 offset:49152
    v_mfma_f32_16x16x32_bf16 v[104:107], v[44:47], v[4:7], v[104:107]
    v_mfma_f32_16x16x32_bf16 v[108:111], v[44:47], v[48:51], v[108:111]
    s_waitcnt lgkmcnt(2)
    v_min_u32_dpp v0, v0, v0 quad_perm:[1,0,3,2] row_mask:0xf bank_mask:0xf
    v_mfma_f32_16x16x32_bf16 v[196:199], v[44:47], v[52:55], v[196:199]
    v_mfma_f32_16x16x32_bf16 v[200:203], v[44:47], v[56:59], v[200:203]
    v_min_u32_dpp v0, v0, v0 quad_perm:[2,3,0,1] row_mask:0xf bank_mask:0xf
    v_mfma_f32_16x16x32_bf16 v[204:207], v[44:47], v[60:63], v[204:207]
    v_readfirstlane_b32 s86, v0
    ds_read_b64_tr_b16 v[44:45], v31 offset:32768
    v_mfma_f32_16x16x32_bf16 v[112:115], v[32:35], v[20:23], v[112:115]
    ds_read_b64_tr_b16 v[46:47], v31 offset:49152
    v_mfma_f32_16x16x32_bf16 v[116:119], v[32:35], v[4:7], v[116:119]
    v_mfma_f32_16x16x32_bf16 v[120:123], v[32:35], v[48:51], v[120:123]
    v_mfma_f32_16x16x32_bf16 v[208:211], v[32:35], v[52:55], v[208:211]
    v_mfma_f32_16x16x32_bf16 v[212:215], v[32:35], v[56:59], v[212:215]
    v_mfma_f32_16x16x32_bf16 v[216:219], v[32:35], v[60:63], v[216:219]
    v_mfma_f32_16x16x32_bf16 v[124:127], v[36:39], v[20:23], v[124:127]
    v_mfma_f32_16x16x32_bf16 v[128:131], v[36:39], v[4:7], v[128:131]
    v_mfma_f32_16x16x32_bf16 v[132:135], v[36:39], v[48:51], v[132:135]
    s_waitcnt lgkmcnt(0)
    s_barrier
    v_mfma_f32_16x16x32_bf16 v[220:223], v[36:39], v[52:55], v[220:223]
    s_add_u32 s85, s85, 1
    s_cmp_ge_u32 s86, s85
    s_cbranch_scc0 .Lck_23_s
.Lck_23:
    ds_read_b128 v[12:15], v8 offset:34816
    v_mfma_f32_16x16x32_bf16 v[224:227], v[36:39], v[56:59], v[224:227]
    v_xor_b32 v24, 0x10000, v24
    ds_read_b64_tr_b16 v[32:33], v24 offset:0
    v_mfma_f32_16x16x32_bf16 v[228:231], v[36:39], v[60:63], v[228:231]
    ds_read_b64_tr_b16 v[34:35], v24 offset:16384
    v_xor_b32 v25, 0x10000, v25
    ds_read_b64_tr_b16 v[36:37], v25 offset:0
    v_mfma_f32_16x16x32_bf16 v[136:139], v[40:43], v[20:23], v[136:139]
    ds_read_b64_tr_b16 v[38:39], v25 offset:16384
    ds_read_b128 v[16:19], v8 offset:40960
    v_mfma_f32_16x16x32_bf16 v[148:151], v[44:47], v[20:23], v[148:151]
    ds_read_b128 v[20:23], v8 offset:45056
    v_mfma_f32_16x16x32_bf16 v[140:143], v[40:43], v[4:7], v[140:143]
    v_mfma_f32_16x16x32_bf16 v[152:155], v[44:47], v[4:7], v[152:155]
    ds_read_b128 v[4:7], v8 offset:2048
    v_mfma_f32_16x16x32_bf16 v[144:147], v[40:43], v[48:51], v[144:147]
    v_mfma_f32_16x16x32_bf16 v[156:159], v[44:47], v[48:51], v[156:159]
    ds_read_b128 v[48:51], v8 offset:8192
    v_mfma_f32_16x16x32_bf16 v[232:235], v[40:43], v[52:55], v[232:235]
    v_mfma_f32_16x16x32_bf16 v[244:247], v[44:47], v[52:55], v[244:247]
    ds_read_b128 v[52:55], v8 offset:12288
    v_mfma_f32_16x16x32_bf16 v[236:239], v[40:43], v[56:59], v[236:239]
    v_mfma_f32_16x16x32_bf16 v[248:251], v[44:47], v[56:59], v[248:251]
    v_mfma_f32_16x16x32_bf16 v[240:243], v[40:43], v[60:63], v[240:243]
    v_xor_b32 v26, 0x10000, v26
    ds_read_b64_tr_b16 v[40:41], v26 offset:0
    v_mfma_f32_16x16x32_bf16 v[252:255], v[44:47], v[60:63], v[252:255]
    ds_read_b64_tr_b16 v[42:43], v26 offset:16384
    s_waitcnt lgkmcnt(4)
    v_mfma_f32_16x16x32_bf16 v[64:67], v[32:35], v[12:15], v[64:67]
    v_xor_b32 v27, 0x10000, v27
    ds_read_b64_tr_b16 v[44:45], v27 offset:0
    v_mfma_f32_16x16x32_bf16 v[76:79], v[36:39], v[12:15], v[76:79]
    ds_read_b64_tr_b16 v[46:47], v27 offset:16384
    v_mfma_f32_16x16x32_bf16 v[68:71], v[32:35], v[16:19], v[68:71]
    v_mfma_f32_16x16x32_bf16 v[80:83], v[36:39], v[16:19], v[80:83]
    v_mfma_f32_16x16x32_bf16 v[72:75], v[32:35], v[20:23], v[72:75]
    v_mfma_f32_16x16x32_bf16 v[84:87], v[36:39], v[20:23], v[84:87]
    v_mfma_f32_16x16x32_bf16 v[160:163], v[32:35], v[4:7], v[160:163]
    v_mfma_f32_16x16x32_bf16 v[172:175], v[36:39], v[4:7], v[172:175]
    s_waitcnt lgkmcnt(2)
    v_mfma_f32_16x16x32_bf16 v[164:167], v[32:35], v[48:51], v[164:167]
    v_mfma_f32_16x16x32_bf16 v[176:179], v[36:39], v[48:51], v[176:179]
    v_mfma_f32_16x16x32_bf16 v[168:171], v[32:35], v[52:55], v[168:171]
    v_xor_b32 v28, 0x10000, v28
    ds_read_b64_tr_b16 v[32:33], v28 offset:0
    v_mfma_f32_16x16x32_bf16 v[180:183], v[36:39], v[52:55], v[180:183]
    ds_read_b64_tr_b16 v[34:35], v28 offset:16384
    v_xor_b32 v29, 0x10000, v29
    ds_read_b64_tr_b16 v[36:37], v29 offset:0
    v_mfma_f32_16x16x32_bf16 v[88:91], v[40:43], v[12:15], v[88:91]
    ds_read_b64_tr_b16 v[38:39], v29 offset:16384
    ds_read_b32 v0, v1
    v_mfma_f32_16x16x32_bf16 v[92:95], v[40:43], v[16:19], v[92:95]
    v_mfma_f32_16x16x32_bf16 v[96:99], v[40:43], v[20:23], v[96:99]
    v_mfma_f32_16x16x32_bf16 v[184:187], v[40:43], v[4:7], v[184:187]
    v_mfma_f32_16x16x32_bf16 v[188:191], v[40:43], v[48:51], v[188:191]
    v_mfma_f32_16x16x32_bf16 v[192:195], v[40:43], v[52:55], v[192:195]
    v_xor_b32 v30, 0x10000, v30
    ds_read_b64_tr_b16 v[40:41], v30 offset:0
    s_waitcnt lgkmcnt(6)
    v_mfma_f32_16x16x32_bf16 v[100:103], v[44:47], v[12:15], v[100:103]
    ds_read_b64_tr_b16 v[42:43], v30 offset:16384
    v_mfma_f32_16x16x32_bf16 v[104:107], v[44:47], v[16:19], v[104:107]
    v_mfma_f32_16x16x32_bf16 v[108:111], v[44:47], v[20:23], v[108:111]
    s_waitcnt lgkmcnt(2)
    v_min_u32_dpp v0, v0, v0 quad_perm:[1,0,3,2] row_mask:0xf bank_mask:0xf
    v_mfma_f32_16x16x32_bf16 v[196:199], v[44:47], v[4:7], v[196:199]
    v_mfma_f32_16x16x32_bf16 v[200:203], v[44:47], v[48:51], v[200:203]
    v_min_u32_dpp v0, v0, v0 quad_perm:[2,3,0,1] row_mask:0xf bank_mask:0xf
    v_mfma_f32_16x16x32_bf16 v[204:207], v[44:47], v[52:55], v[204:207]
    v_readfirstlane_b32 s86, v0
    v_xor_b32 v31, 0x10000, v31
    ds_read_b64_tr_b16 v[44:45], v31 offset:0
    v_mfma_f32_16x16x32_bf16 v[112:115], v[32:35], v[12:15], v[112:115]
    ds_read_b64_tr_b16 v[46:47], v31 offset:16384
    v_mfma_f32_16x16x32_bf16 v[116:119], v[32:35], v[16:19], v[116:119]
    v_mfma_f32_16x16x32_bf16 v[120:123], v[32:35], v[20:23], v[120:123]
    v_mfma_f32_16x16x32_bf16 v[208:211], v[32:35], v[4:7], v[208:211]
    v_mfma_f32_16x16x32_bf16 v[212:215], v[32:35], v[48:51], v[212:215]
    v_mfma_f32_16x16x32_bf16 v[216:219], v[32:35], v[52:55], v[216:219]
    v_mfma_f32_16x16x32_bf16 v[124:127], v[36:39], v[12:15], v[124:127]
    v_mfma_f32_16x16x32_bf16 v[128:131], v[36:39], v[16:19], v[128:131]
    v_mfma_f32_16x16x32_bf16 v[132:135], v[36:39], v[20:23], v[132:135]
    s_waitcnt lgkmcnt(0)
    s_barrier
    v_mfma_f32_16x16x32_bf16 v[220:223], v[36:39], v[4:7], v[220:223]
    s_add_u32 s85, s85, 1
    s_cmp_ge_u32 s86, s85
    s_cbranch_scc0 .Lck_24_s
.Lck_24:
    ds_read_b128 v[56:59], v8 offset:35840
    v_mfma_f32_16x16x32_bf16 v[224:227], v[36:39], v[48:51], v[224:227]
    v_xor_b32 v24, 0x10000, v24
    ds_read_b64_tr_b16 v[32:33], v24 offset:0
    v_mfma_f32_16x16x32_bf16 v[228:231], v[36:39], v[52:55], v[228:231]
    ds_read_b64_tr_b16 v[34:35], v24 offset:16384
    v_xor_b32 v25, 0x10000, v25
    ds_read_b64_tr_b16 v[36:37], v25 offset:0
    v_mfma_f32_16x16x32_bf16 v[136:139], v[40:43], v[12:15], v[136:139]
    ds_read_b64_tr_b16 v[38:39], v25 offset:16384
    ds_read_b128 v[60:63], v8 offset:41984
    v_mfma_f32_16x16x32_bf16 v[148:151], v[44:47], v[12:15], v[148:151]
    ds_read_b128 v[12:15], v8 offset:46080
    v_mfma_f32_16x16x32_bf16 v[140:143], v[40:43], v[16:19], v[140:143]
    v_mfma_f32_16x16x32_bf16 v[152:155], v[44:47], v[16:19], v[152:155]
    ds_read_b128 v[16:19], v8 offset:3072
    v_mfma_f32_16x16x32_bf16 v[144:147], v[40:43], v[20:23], v[144:147]
    v_mfma_f32_16x16x32_bf16 v[156:159], v[44:47], v[20:23], v[156:159]
    ds_read_b128 v[20:23], v8 offset:9216
    v_mfma_f32_16x16x32_bf16 v[232:235], v[40:43], v[4:7], v[232:235]
    v_mfma_f32_16x16x32_bf16 v[244:247], v[44:47], v[4:7], v[244:247]
    ds_read_b128 v[4:7], v8 offset:13312
    v_mfma_f32_16x16x32_bf16 v[236:239], v[40:43], v[48:51], v[236:239]
    v_mfma_f32_16x16x32_bf16 v[248:251], v[44:47], v[48:51], v[248:251]
    v_mfma_f32_16x16x32_bf16 v[240:243], v[40:43], v[52:55], v[240:243]
    v_xor_b32 v26, 0x10000, v26
    ds_read_b64_tr_b16 v[40:41], v26 offset:0
    v_mfma_f32_16x16x32_bf16 v[252:255], v[44:47], v[52:55], v[252:255]
    ds_read_b64_tr_b16 v[42:43], v26 offset:16384
    s_waitcnt lgkmcnt(4)
    v_mfma_f32_16x16x32_bf16 v[64:67], v[32:35], v[56:59], v[64:67]
    v_xor_b32 v27, 0x10000, v27
    ds_read_b64_tr_b16 v[44:45], v27 offset:0
    v_mfma_f32_16x16x32_bf16 v[76:79], v[36:39], v[56:59], v[76:79]
    ds_read_b64_tr_b16 v[46:47], v27 offset:16384
    v_mfma_f32_16x16x32_bf16 v[68:71], v[32:35], v[60:63], v[68:71]
    v_mfma_f32_16x16x32_bf16 v[80:83], v[36:39], v[60:63], v[80:83]
    v_mfma_f32_16x16x32_bf16 v[72:75], v[32:35], v[12:15], v[72:75]
    v_mfma_f32_16x16x32_bf16 v[84:87], v[36:39], v[12:15], v[84:87]
    v_mfma_f32_16x16x32_bf16 v[160:163], v[32:35], v[16:19], v[160:163]
    v_mfma_f32_16x16x32_bf16 v[172:175], v[36:39], v[16:19], v[172:175]
    s_waitcnt lgkmcnt(2)
    v_mfma_f32_16x16x32_bf16 v[164:167], v[32:35], v[20:23], v[164:167]
    v_mfma_f32_16x16x32_bf16 v[176:179], v[36:39], v[20:23], v[176:179]
    v_mfma_f32_16x16x32_bf16 v[168:171], v[32:35], v[4:7], v[168:171]
    v_xor_b32 v28, 0x10000, v28
    ds_read_b64_tr_b16 v[32:33], v28 offset:0
    v_mfma_f32_16x16x32_bf16 v[180:183], v[36:39], v[4:7], v[180:183]
    ds_read_b64_tr_b16 v[34:35], v28 offset:16384
    v_xor_b32 v29, 0x10000, v29
    ds_read_b64_tr_b16 v[36:37], v29 offset:0
    v_mfma_f32_16x16x32_bf16 v[88:91], v[40:43], v[56:59], v[88:91]
    ds_read_b64_tr_b16 v[38:39], v29 offset:16384
    ds_read_b32 v0, v1
    v_mfma_f32_16x16x32_bf16 v[92:95], v[40:43], v[60:63], v[92:95]
    v_mfma_f32_16x16x32_bf16 v[96:99], v[40:43], v[12:15], v[96:99]
    v_mfma_f32_16x16x32_bf16 v[184:187], v[40:43], v[16:19], v[184:187]
    v_mfma_f32_16x16x32_bf16 v[188:191], v[40:43], v[20:23], v[188:191]
    v_mfma_f32_16x16x32_bf16 v[192:195], v[40:43], v[4:7], v[192:195]
    v_xor_b32 v30, 0x10000, v30
    ds_read_b64_tr_b16 v[40:41], v30 offset:0
    s_waitcnt lgkmcnt(6)
    v_mfma_f32_16x16x32_bf16 v[100:103], v[44:47], v[56:59], v[100:103]
    ds_read_b64_tr_b16 v[42:43], v30 offset:16384
    v_mfma_f32_16x16x32_bf16 v[104:107], v[44:47], v[60:63], v[104:107]
    v_mfma_f32_16x16x32_bf16 v[108:111], v[44:47], v[12:15], v[108:111]
    s_waitcnt lgkmcnt(2)
    v_min_u32_dpp v0, v0, v0 quad_perm:[1,0,3,2] row_mask:0xf bank_mask:0xf
    v_mfma_f32_16x16x32_bf16 v[196:199], v[44:47], v[16:19], v[196:199]
    v_mfma_f32_16x16x32_bf16 v[200:203], v[44:47], v[20:23], v[200:203]
    v_min_u32_dpp v0, v0, v0 quad_perm:[2,3,0,1] row_mask:0xf bank_mask:0xf
    v_mfma_f32_16x16x32_bf16 v[204:207], v[44:47], v[4:7], v[204:207]
    v_readfirstlane_b32 s86, v0
    v_xor_b32 v31, 0x10000, v31
    ds_read_b64_tr_b16 v[44:45], v31 offset:0
    v_mfma_f32_16x16x32_bf16 v[112:115], v[32:35], v[56:59], v[112:115]
    ds_read_b64_tr_b16 v[46:47], v31 offset:16384
    v_mfma_f32_16x16x32_bf16 v[116:119], v[32:35], v[60:63], v[116:119]
    v_mfma_f32_16x16x32_bf16 v[120:123], v[32:35], v[12:15], v[120:123]
    v_mfma_f32_16x16x32_bf16 v[208:211], v[32:35], v[16:19], v[208:211]
    v_mfma_f32_16x16x32_bf16 v[212:215], v[32:35], v[20:23], v[212:215]
    v_mfma_f32_16x16x32_bf16 v[216:219], v[32:35], v[4:7], v[216:219]
    v_mfma_f32_16x16x32_bf16 v[124:127], v[36:39], v[56:59], v[124:127]
    v_mfma_f32_16x16x32_bf16 v[128:131], v[36:39], v[60:63], v[128:131]
    v_mfma_f32_16x16x32_bf16 v[132:135], v[36:39], v[12:15], v[132:135]
    s_waitcnt lgkmcnt(0)
    s_barrier
    v_mfma_f32_16x16x32_bf16 v[220:223], v[36:39], v[16:19], v[220:223]
    s_add_u32 s85, s85, 1
    s_cmp_ge_u32 s86, s85
    s_cbranch_scc0 .Lck_25_s
.Lck_25:
    ds_read_b128 v[48:51], v8 offset:49152
    v_mfma_f32_16x16x32_bf16 v[224:227], v[36:39], v[20:23], v[224:227]
    ds_read_b64_tr_b16 v[32:33], v24 offset:32768
    ds_read_b64_tr_b16 v[34:35], v24 offset:49152
    v_mfma_f32_16x16x32_bf16 v[228:231], v[36:39], v[4:7], v[228:231]
    ds_read_b64_tr_b16 v[36:37], v25 offset:32768
    ds_read_b64_tr_b16 v[38:39], v25 offset:49152
    v_mfma_f32_16x16x32_bf16 v[136:139], v[40:43], v[56:59], v[136:139]
    ds_read_b128 v[52:55], v8 offset:53248
    v_mfma_f32_16x16x32_bf16 v[148:151], v[44:47], v[56:59], v[148:151]
    ds_read_b128 v[56:59], v8 offset:59392
    v_mfma_f32_16x16x32_bf16 v[140:143], v[40:43], v[60:63], v[140:143]
    v_mfma_f32_16x16x32_bf16 v[152:155], v[44:47], v[60:63], v[152:155]
    ds_read_b128 v[60:63], v8 offset:16384
    v_mfma_f32_16x16x32_bf16 v[144:147], v[40:43], v[12:15], v[144:147]
    v_mfma_f32_16x16x32_bf16 v[156:159], v[44:47], v[12:15], v[156:159]
    ds_read_b128 v[12:15], v8 offset:20480
    v_mfma_f32_16x16x32_bf16 v[232:235], v[40:43], v[16:19], v[232:235]
    v_mfma_f32_16x16x32_bf16 v[244:247], v[44:47], v[16:19], v[244:247]
    ds_read_b128 v[16:19], v8 offset:26624
    v_mfma_f32_16x16x32_bf16 v[236:239], v[40:43], v[20:23], v[236:239]
    v_mfma_f32_16x16x32_bf16 v[248:251], v[44:47], v[20:23], v[248:251]
    v_mfma_f32_16x16x32_bf16 v[240:243], v[40:43], v[4:7], v[240:243]
    ds_read_b64_tr_b16 v[40:41], v26 offset:32768
    ds_read_b64_tr_b16 v[42:43], v26 offset:49152
    v_mfma_f32_16x16x32_bf16 v[252:255], v[44:47], v[4:7], v[252:255]
    ds_read_b64_tr_b16 v[44:45], v27 offset:32768
    s_waitcnt lgkmcnt(5)
    v_mfma_f32_16x16x32_bf16 v[64:67], v[32:35], v[48:51], v[64:67]
    ds_read_b64_tr_b16 v[46:47], v27 offset:49152
    v_mfma_f32_16x16x32_bf16 v[76:79], v[36:39], v[48:51], v[76:79]
    v_mfma_f32_16x16x32_bf16 v[68:71], v[32:35], v[52:55], v[68:71]
    v_mfma_f32_16x16x32_bf16 v[80:83], v[36:39], v[52:55], v[80:83]
    v_mfma_f32_16x16x32_bf16 v[72:75], v[32:35], v[56:59], v[72:75]
    v_mfma_f32_16x16x32_bf16 v[84:87], v[36:39], v[56:59], v[84:87]
    v_mfma_f32_16x16x32_bf16 v[160:163], v[32:35], v[60:63], v[160:163]
    v_mfma_f32_16x16x32_bf16 v[172:175], v[36:39], v[60:63], v[172:175]
    s_waitcnt lgkmcnt(1)
    v_mfma_f32_16x16x32_bf16 v[164:167], v[32:35], v[12:15], v[164:167]
    v_mfma_f32_16x16x32_bf16 v[176:179], v[36:39], v[12:15], v[176:179]
    v_mfma_f32_16x16x32_bf16 v[168:171], v[32:35], v[16:19], v[168:171]
    ds_read_b64_tr_b16 v[32:33], v28 offset:32768
    ds_read_b64_tr_b16 v[34:35], v28 offset:49152
    v_mfma_f32_16x16x32_bf16 v[180:183], v[36:39], v[16:19], v[180:183]
    ds_read_b64_tr_b16 v[36:37], v29 offset:32768
    ds_read_b64_tr_b16 v[38:39], v29 offset:49152
    v_mfma_f32_16x16x32_bf16 v[88:91], v[40:43], v[48:51], v[88:91]
    ds_read_b32 v0, v1
    v_mfma_f32_16x16x32_bf16 v[92:95], v[40:43], v[52:55], v[92:95]
    v_mfma_f32_16x16x32_bf16 v[96:99], v[40:43], v[56:59], v[96:99]
    v_mfma_f32_16x16x32_bf16 v[184:187], v[40:43], v[60:63], v[184:187]
    v_mfma_f32_16x16x32_bf16 v[188:191], v[40:43], v[12:15], v[188:191]
    v_mfma_f32_16x16x32_bf16 v[192:195], v[40:43], v[16:19], v[192:195]
    ds_read_b64_tr_b16 v[40:41], v30 offset:32768
    s_waitcnt lgkmcnt(6)
    v_mfma_f32_16x16x32_bf16 v[100:103], v[44:47], v[48:51], v[100:103]
    ds_read_b64_tr_b16 v[42:43], v30 offset:49152
    v_mfma_f32_16x16x32_bf16 v[104:107], v[44:47], v[52:55], v[104:107]
    v_mfma_f32_16x16x32_bf16 v[108:111], v[44:47], v[56:59], v[108:111]
    s_waitcnt lgkmcnt(2)
    v_min_u32_dpp v0, v0, v0 quad_perm:[1,0,3,2] row_mask:0xf bank_mask:0xf
    v_mfma_f32_16x16x32_bf16 v[196:199], v[44:47], v[60:63], v[196:199]
    v_mfma_f32_16x16x32_bf16 v[200:203], v[44:47], v[12:15], v[200:203]
    v_min_u32_dpp v0, v0, v0 quad_perm:[2,3,0,1] row_mask:0xf bank_mask:0xf
    v_mfma_f32_16x16x32_bf16 v[204:207], v[44:47], v[16:19], v[204:207]
    v_readfirstlane_b32 s86, v0
    ds_read_b64_tr_b16 v[44:45], v31 offset:32768
    v_mfma_f32_16x16x32_bf16 v[112:115], v[32:35], v[48:51], v[112:115]
    ds_read_b64_tr_b16 v[46:47], v31 offset:49152
    v_mfma_f32_16x16x32_bf16 v[116:119], v[32:35], v[52:55], v[116:119]
    v_mfma_f32_16x16x32_bf16 v[120:123], v[32:35], v[56:59], v[120:123]
    v_mfma_f32_16x16x32_bf16 v[208:211], v[32:35], v[60:63], v[208:211]
    v_mfma_f32_16x16x32_bf16 v[212:215], v[32:35], v[12:15], v[212:215]
    v_mfma_f32_16x16x32_bf16 v[216:219], v[32:35], v[16:19], v[216:219]
    v_mfma_f32_16x16x32_bf16 v[124:127], v[36:39], v[48:51], v[124:127]
    v_mfma_f32_16x16x32_bf16 v[128:131], v[36:39], v[52:55], v[128:131]
    v_mfma_f32_16x16x32_bf16 v[132:135], v[36:39], v[56:59], v[132:135]
    s_waitcnt lgkmcnt(0)
    s_barrier
    v_mfma_f32_16x16x32_bf16 v[220:223], v[36:39], v[60:63], v[220:223]
    s_add_u32 s85, s85, 1
    s_cmp_ge_u32 s86, s85
    s_cbranch_scc0 .Lck_26_s
.Lck_26:
    ds_read_b128 v[20:23], v8 offset:50176
    v_mfma_f32_16x16x32_bf16 v[224:227], v[36:39], v[12:15], v[224:227]
    v_xor_b32 v24, 0x10000, v24
    ds_read_b64_tr_b16 v[32:33], v24 offset:0
    v_mfma_f32_16x16x32_bf16 v[228:231], v[36:39], v[16:19], v[228:231]
    ds_read_b64_tr_b16 v[34:35], v24 offset:16384
    v_xor_b32 v25, 0x10000, v25
    ds_read_b64_tr_b16 v[36:37], v25 offset:0
    v_mfma_f32_16x16x32_bf16 v[136:139], v[40:43], v[48:51], v[136:139]
    ds_read_b64_tr_b16 v[38:39], v25 offset:16384
    ds_read_b128 v[4:7], v8 offset:54272
    v_mfma_f32_16x16x32_bf16 v[148:151], v[44:47], v[48:51], v[148:151]
    ds_read_b128 v[48:51], v8 offset:60416
    v_mfma_f32_16x16x32_bf16 v[140:143], v[40:43], v[52:55], v[140:143]
    v_mfma_f32_16x16x32_bf16 v[152:155], v[44:47], v[52:55], v[152:155]
    ds_read_b128 v[52:55], v8 offset:17408
    v_mfma_f32_16x16x32_bf16 v[144:147], v[40:43], v[56:59], v[144:147]
    v_mfma_f32_16x16x32_bf16 v[156:159], v[44:47], v[56:59], v[156:159]
    ds_read_b128 v[56:59], v8 offset:21504
    v_mfma_f32_16x16x32_bf16 v[232:235], v[40:43], v[60:63], v[232:235]
    v_mfma_f32_16x16x32_bf16 v[244:247], v[44:47], v[60:63], v[244:247]
    ds_read_b128 v[60:63], v8 offset:27648
    v_mfma_f32_16x16x32_bf16 v[236:239], v[40:43], v[12:15], v[236:239]
    v_mfma_f32_16x16x32_bf16 v[248:251], v[44:47], v[12:15], v[248:251]
    v_mfma_f32_16x16x32_bf16 v[240:243], v[40:43], v[16:19], v[240:243]
    v_xor_b32 v26, 0x10000, v26
    ds_read_b64_tr_b16 v[40:41], v26 offset:0
    v_mfma_f32_16x16x32_bf16 v[252:255], v[44:47], v[16:19], v[252:255]
    ds_read_b64_tr_b16 v[42:43], v26 offset:16384
    s_waitcnt lgkmcnt(4)
    v_mfma_f32_16x16x32_bf16 v[64:67], v[32:35], v[20:23], v[64:67]
    v_xor_b32 v27, 0x10000, v27
    ds_read_b64_tr_b16 v[44:45], v27 offset:0
    v_mfma_f32_16x16x32_bf16 v[76:79], v[36:39], v[20:23], v[76:79]
    ds_read_b64_tr_b16 v[46:47], v27 offset:16384
    v_mfma_f32_16x16x32_bf16 v[68:71], v[32:35], v[4:7], v[68:71]
    v_mfma_f32_16x16x32_bf16 v[80:83], v[36:39], v[4:7], v[80:83]
    v_mfma_f32_16x16x32_bf16 v[72:75], v[32:35], v[48:51], v[72:75]
    v_mfma_f32_16x16x32_bf16 v[84:87], v[36:39], v[48:51], v[84:87]
    v_mfma_f32_16x16x32_bf16 v[160:163], v[32:35], v[52:55], v[160:163]
    v_mfma_f32_16x16x32_bf16 v[172:175], v[36:39], v[52:55], v[172:175]
    s_waitcnt lgkmcnt(2)
    v_mfma_f32_16x16x32_bf16 v[164:167], v[32:35], v[56:59], v[164:167]
    v_mfma_f32_16x16x32_bf16 v[176:179], v[36:39], v[56:59], v[176:179]
    v_mfma_f32_16x16x32_bf16 v[168:171], v[32:35], v[60:63], v[168:171]
    v_xor_b32 v28, 0x10000, v28
    ds_read_b64_tr_b16 v[32:33], v28 offset:0
    v_mfma_f32_16x16x32_bf16 v[180:183], v[36:39], v[60:63], v[180:183]
    ds_read_b64_tr_b16 v[34:35], v28 offset:16384
    v_xor_b32 v29, 0x10000, v29
    ds_read_b64_tr_b16 v[36:37], v29 offset:0
    v_mfma_f32_16x16x32_bf16 v[88:91], v[40:43], v[20:23], v[88:91]
    ds_read_b64_tr_b16 v[38:39], v29 offset:16384
    ds_read_b32 v0, v1
    v_mfma_f32_16x16x32_bf16 v[92:95], v[40:43], v[4:7], v[92:95]
    v_mfma_f32_16x16x32_bf16 v[96:99], v[40:43], v[48:51], v[96:99]
    v_mfma_f32_16x16x32_bf16 v[184:187], v[40:43], v[52:55], v[184:187]
    v_mfma_f32_16x16x32_bf16 v[188:191], v[40:43], v[56:59], v[188:191]
    v_mfma_f32_16x16x32_bf16 v[192:195], v[40:43], v[60:63], v[192:195]
    v_xor_b32 v30, 0x10000, v30
    ds_read_b64_tr_b16 v[40:41], v30 offset:0
    s_waitcnt lgkmcnt(6)
    v_mfma_f32_16x16x32_bf16 v[100:103], v[44:47], v[20:23], v[100:103]
    ds_read_b64_tr_b16 v[42:43], v30 offset:16384
    v_mfma_f32_16x16x32_bf16 v[104:107], v[44:47], v[4:7], v[104:107]
    v_mfma_f32_16x16x32_bf16 v[108:111], v[44:47], v[48:51], v[108:111]
    s_waitcnt lgkmcnt(2)
    v_min_u32_dpp v0, v0, v0 quad_perm:[1,0,3,2] row_mask:0xf bank_mask:0xf
    v_mfma_f32_16x16x32_bf16 v[196:199], v[44:47], v[52:55], v[196:199]
    v_mfma_f32_16x16x32_bf16 v[200:203], v[44:47], v[56:59], v[200:203]
    v_min_u32_dpp v0, v0, v0 quad_perm:[2,3,0,1] row_mask:0xf bank_mask:0xf
    v_mfma_f32_16x16x32_bf16 v[204:207], v[44:47], v[60:63], v[204:207]
    v_readfirstlane_b32 s86, v0
    v_xor_b32 v31, 0x10000, v31
    ds_read_b64_tr_b16 v[44:45], v31 offset:0
    v_mfma_f32_16x16x32_bf16 v[112:115], v[32:35], v[20:23], v[112:115]
    ds_read_b64_tr_b16 v[46:47], v31 offset:16384
    v_mfma_f32_16x16x32_bf16 v[116:119], v[32:35], v[4:7], v[116:119]
    v_mfma_f32_16x16x32_bf16 v[120:123], v[32:35], v[48:51], v[120:123]
    v_mfma_f32_16x16x32_bf16 v[208:211], v[32:35], v[52:55], v[208:211]
    v_mfma_f32_16x16x32_bf16 v[212:215], v[32:35], v[56:59], v[212:215]
    v_mfma_f32_16x16x32_bf16 v[216:219], v[32:35], v[60:63], v[216:219]
    v_mfma_f32_16x16x32_bf16 v[124:127], v[36:39], v[20:23], v[124:127]
    v_mfma_f32_16x16x32_bf16 v[128:131], v[36:39], v[4:7], v[128:131]
    v_mfma_f32_16x16x32_bf16 v[132:135], v[36:39], v[48:51], v[132:135]
    s_waitcnt lgkmcnt(0)
    v_mfma_f32_16x16x32_bf16 v[220:223], v[36:39], v[52:55], v[220:223]
    s_add_u32 s85, s85, 1
    s_cmp_ge_u32 s86, s85
    s_cbranch_scc0 .Lck_27_s
.Lck_27:
    ds_read_b128 v[12:15], v8 offset:51200
    v_mfma_f32_16x16x32_bf16 v[224:227], v[36:39], v[56:59], v[224:227]
    v_xor_b32 v24, 0x10000, v24
    ds_read_b64_tr_b16 v[32:33], v24 offset:0
    v_mfma_f32_16x16x32_bf16 v[228:231], v[36:39], v[60:63], v[228:231]
    ds_read_b64_tr_b16 v[34:35], v24 offset:16384
    v_xor_b32 v25, 0x10000, v25
    ds_read_b64_tr_b16 v[36:37], v25 offset:0
    v_mfma_f32_16x16x32_bf16 v[136:139], v[40:43], v[20:23], v[136:139]
    ds_read_b64_tr_b16 v[38:39], v25 offset:16384
    ds_read_b128 v[16:19], v8 offset:57344
    v_mfma_f32_16x16x32_bf16 v[148:151], v[44:47], v[20:23], v[148:151]
    ds_read_b128 v[20:23], v8 offset:61440
    v_mfma_f32_16x16x32_bf16 v[140:143], v[40:43], v[4:7], v[140:143]
    v_mfma_f32_16x16x32_bf16 v[152:155], v[44:47], v[4:7], v[152:155]
    ds_read_b128 v[4:7], v8 offset:18432
    v_mfma_f32_16x16x32_bf16 v[144:147], v[40:43], v[48:51], v[144:147]
    v_mfma_f32_16x16x32_bf16 v[156:159], v[44:47], v[48:51], v[156:159]
    ds_read_b128 v[48:51], v8 offset:24576
    v_mfma_f32_16x16x32_bf16 v[232:235], v[40:43], v[52:55], v[232:235]
    v_mfma_f32_16x16x32_bf16 v[244:247], v[44:47], v[52:55], v[244:247]
    ds_read_b128 v[52:55], v8 offset:28672
    v_mfma_f32_16x16x32_bf16 v[236:239], v[40:43], v[56:59], v[236:239]
    v_mfma_f32_16x16x32_bf16 v[248:251], v[44:47], v[56:59], v[248:251]
    v_mfma_f32_16x16x32_bf16 v[240:243], v[40:43], v[60:63], v[240:243]
    v_xor_b32 v26, 0x10000, v26
    ds_read_b64_tr_b16 v[40:41], v26 offset:0
    v_mfma_f32_16x16x32_bf16 v[252:255], v[44:47], v[60:63], v[252:255]
    ds_read_b64_tr_b16 v[42:43], v26 offset:16384
    s_waitcnt lgkmcnt(4)
    v_mfma_f32_16x16x32_bf16 v[64:67], v[32:35], v[12:15], v[64:67]
    v_xor_b32 v27, 0x10000, v27
    ds_read_b64_tr_b16 v[44:45], v27 offset:0
    v_mfma_f32_16x16x32_bf16 v[76:79], v[36:39], v[12:15], v[76:79]
    ds_read_b64_tr_b16 v[46:47], v27 offset:16384
    v_mfma_f32_16x16x32_bf16 v[68:71], v[32:35], v[16:19], v[68:71]
    v_mfma_f32_16x16x32_bf16 v[80:83], v[36:39], v[16:19], v[80:83]
    v_mfma_f32_16x16x32_bf16 v[72:75], v[32:35], v[20:23], v[72:75]
    v_mfma_f32_16x16x32_bf16 v[84:87], v[36:39], v[20:23], v[84:87]
    v_mfma_f32_16x16x32_bf16 v[160:163], v[32:35], v[4:7], v[160:163]
    v_mfma_f32_16x16x32_bf16 v[172:175], v[36:39], v[4:7], v[172:175]
    s_waitcnt lgkmcnt(2)
    v_mfma_f32_16x16x32_bf16 v[164:167], v[32:35], v[48:51], v[164:167]
    v_mfma_f32_16x16x32_bf16 v[176:179], v[36:39], v[48:51], v[176:179]
    v_mfma_f32_16x16x32_bf16 v[168:171], v[32:35], v[52:55], v[168:171]
    v_xor_b32 v28, 0x10000, v28
    ds_read_b64_tr_b16 v[32:33], v28 offset:0
    v_mfma_f32_16x16x32_bf16 v[180:183], v[36:39], v[52:55], v[180:183]
    ds_read_b64_tr_b16 v[34:35], v28 offset:16384
    v_xor_b32 v29, 0x10000, v29
    ds_read_b64_tr_b16 v[36:37], v29 offset:0
    v_mfma_f32_16x16x32_bf16 v[88:91], v[40:43], v[12:15], v[88:91]
    ds_read_b64_tr_b16 v[38:39], v29 offset:16384
    ds_read_b32 v0, v1
    v_mfma_f32_16x16x32_bf16 v[92:95], v[40:43], v[16:19], v[92:95]
    v_mfma_f32_16x16x32_bf16 v[96:99], v[40:43], v[20:23], v[96:99]
    v_mfma_f32_16x16x32_bf16 v[184:187], v[40:43], v[4:7], v[184:187]
    v_mfma_f32_16x16x32_bf16 v[188:191], v[40:43], v[48:51], v[188:191]
    v_mfma_f32_16x16x32_bf16 v[192:195], v[40:43], v[52:55], v[192:195]
    v_xor_b32 v30, 0x10000, v30
    ds_read_b64_tr_b16 v[40:41], v30 offset:0
    s_waitcnt lgkmcnt(6)
    v_mfma_f32_16x16x32_bf16 v[100:103], v[44:47], v[12:15], v[100:103]
    ds_read_b64_tr_b16 v[42:43], v30 offset:16384
    v_mfma_f32_16x16x32_bf16 v[104:107], v[44:47], v[16:19], v[104:107]
    v_mfma_f32_16x16x32_bf16 v[108:111], v[44:47], v[20:23], v[108:111]
    s_waitcnt lgkmcnt(2)
    v_min_u32_dpp v0, v0, v0 quad_perm:[1,0,3,2] row_mask:0xf bank_mask:0xf
    v_mfma_f32_16x16x32_bf16 v[196:199], v[44:47], v[4:7], v[196:199]
    v_mfma_f32_16x16x32_bf16 v[200:203], v[44:47], v[48:51], v[200:203]
    v_min_u32_dpp v0, v0, v0 quad_perm:[2,3,0,1] row_mask:0xf bank_mask:0xf
    v_mfma_f32_16x16x32_bf16 v[204:207], v[44:47], v[52:55], v[204:207]
    v_readfirstlane_b32 s86, v0
    v_xor_b32 v31, 0x10000, v31
    ds_read_b64_tr_b16 v[44:45], v31 offset:0
    v_mfma_f32_16x16x32_bf16 v[112:115], v[32:35], v[12:15], v[112:115]
    ds_read_b64_tr_b16 v[46:47], v31 offset:16384
    v_mfma_f32_16x16x32_bf16 v[116:119], v[32:35], v[16:19], v[116:119]
    v_mfma_f32_16x16x32_bf16 v[120:123], v[32:35], v[20:23], v[120:123]
    v_mfma_f32_16x16x32_bf16 v[208:211], v[32:35], v[4:7], v[208:211]
    v_mfma_f32_16x16x32_bf16 v[212:215], v[32:35], v[48:51], v[212:215]
    v_mfma_f32_16x16x32_bf16 v[216:219], v[32:35], v[52:55], v[216:219]
    v_mfma_f32_16x16x32_bf16 v[124:127], v[36:39], v[12:15], v[124:127]
    v_mfma_f32_16x16x32_bf16 v[128:131], v[36:39], v[16:19], v[128:131]
    v_mfma_f32_16x16x32_bf16 v[132:135], v[36:39], v[20:23], v[132:135]
    s_waitcnt lgkmcnt(0)
    v_mfma_f32_16x16x32_bf16 v[220:223], v[36:39], v[4:7], v[220:223]
    s_add_u32 s85, s85, 1
    s_cmp_ge_u32 s86, s85
    s_cbranch_scc0 .Lck_28_s
.Lck_28:
    ds_read_b128 v[56:59], v8 offset:52224
    v_mfma_f32_16x16x32_bf16 v[224:227], v[36:39], v[48:51], v[224:227]
    ds_read_b64_tr_b16 v[32:33], v24 offset:32768
    ds_read_b64_tr_b16 v[34:35], v24 offset:49152
    v_mfma_f32_16x16x32_bf16 v[228:231], v[36:39], v[52:55], v[228:231]
    ds_read_b64_tr_b16 v[36:37], v25 offset:32768
    ds_read_b64_tr_b16 v[38:39], v25 offset:49152
    v_mfma_f32_16x16x32_bf16 v[136:139], v[40:43], v[12:15], v[136:139]
    ds_read_b128 v[60:63], v8 offset:58368
    v_mfma_f32_16x16x32_bf16 v[148:151], v[44:47], v[12:15], v[148:151]
    ds_read_b128 v[12:15], v8 offset:62464
    v_mfma_f32_16x16x32_bf16 v[140:143], v[40:43], v[16:19], v[140:143]
    v_mfma_f32_16x16x32_bf16 v[152:155], v[44:47], v[16:19], v[152:155]
    ds_read_b128 v[16:19], v8 offset:19456
    v_mfma_f32_16x16x32_bf16 v[144:147], v[40:43], v[20:23], v[144:147]
    v_mfma_f32_16x16x32_bf16 v[156:159], v[44:47], v[20:23], v[156:159]
    ds_read_b128 v[20:23], v8 offset:25600
    v_mfma_f32_16x16x32_bf16 v[232:235], v[40:43], v[4:7], v[232:235]
    v_mfma_f32_16x16x32_bf16 v[244:247], v[44:47], v[4:7], v[244:247]
    ds_read_b128 v[4:7], v8 offset:29696
    v_mfma_f32_16x16x32_bf16 v[236:239], v[40:43], v[48:51], v[236:239]
    v_mfma_f32_16x16x32_bf16 v[248:251], v[44:47], v[48:51], v[248:251]
    v_mfma_f32_16x16x32_bf16 v[240:243], v[40:43], v[52:55], v[240:243]
    ds_read_b64_tr_b16 v[40:41], v26 offset:32768
    ds_read_b64_tr_b16 v[42:43], v26 offset:49152
    v_mfma_f32_16x16x32_bf16 v[252:255], v[44:47], v[52:55], v[252:255]
    ds_read_b64_tr_b16 v[44:45], v27 offset:32768
    s_waitcnt lgkmcnt(5)
    v_mfma_f32_16x16x32_bf16 v[64:67], v[32:35], v[56:59], v[64:67]
    ds_read_b64_tr_b16 v[46:47], v27 offset:49152
    v_mfma_f32_16x16x32_bf16 v[76:79], v[36:39], v[56:59], v[76:79]
    v_mfma_f32_16x16x32_bf16 v[68:71], v[32:35], v[60:63], v[68:71]
    v_mfma_f32_16x16x32_bf16 v[80:83], v[36:39], v[60:63], v[80:83]
    v_mfma_f32_16x16x32_bf16 v[72:75], v[32:35], v[12:15], v[72:75]
    v_mfma_f32_16x16x32_bf16 v[84:87], v[36:39], v[12:15], v[84:87]
    v_mfma_f32_16x16x32_bf16 v[160:163], v[32:35], v[16:19], v[160:163]
    v_mfma_f32_16x16x32_bf16 v[172:175], v[36:39], v[16:19], v[172:175]
    s_waitcnt lgkmcnt(1)
    v_mfma_f32_16x16x32_bf16 v[164:167], v[32:35], v[20:23], v[164:167]
    v_mfma_f32_16x16x32_bf16 v[176:179], v[36:39], v[20:23], v[176:179]
    v_mfma_f32_16x16x32_bf16 v[168:171], v[32:35], v[4:7], v[168:171]
    ds_read_b64_tr_b16 v[32:33], v28 offset:32768
    ds_read_b64_tr_b16 v[34:35], v28 offset:49152
    v_mfma_f32_16x16x32_bf16 v[180:183], v[36:39], v[4:7], v[180:183]
    ds_read_b64_tr_b16 v[36:37], v29 offset:32768
    ds_read_b64_tr_b16 v[38:39], v29 offset:49152
    v_mfma_f32_16x16x32_bf16 v[88:91], v[40:43], v[56:59], v[88:91]
    v_mfma_f32_16x16x32_bf16 v[92:95], v[40:43], v[60:63], v[92:95]
    v_cvt_pk_bf16_f32 v64, v64, v65
    v_cvt_pk_bf16_f32 v65, v66, v67
    v_cvt_pk_bf16_f32 v66, v76, v77
    v_mfma_f32_16x16x32_bf16 v[96:99], v[40:43], v[12:15], v[96:99]
    v_cvt_pk_bf16_f32 v67, v78, v79
    buffer_store_dwordx4 v[64:67], v2, s[32:35], s16 offen offset:0 sc1
    v_cvt_pk_bf16_f32 v68, v68, v69
    v_mfma_f32_16x16x32_bf16 v[184:187], v[40:43], v[16:19], v[184:187]
    v_cvt_pk_bf16_f32 v69, v70, v71
    v_cvt_pk_bf16_f32 v70, v80, v81
    v_cvt_pk_bf16_f32 v71, v82, v83
    v_mfma_f32_16x16x32_bf16 v[188:191], v[40:43], v[20:23], v[188:191]
    buffer_store_dwordx4 v[68:71], v2, s[32:35], s17 offen offset:0 sc1
    v_cvt_pk_bf16_f32 v72, v72, v73
    v_cvt_pk_bf16_f32 v73, v74, v75
    v_mfma_f32_16x16x32_bf16 v[192:195], v[40:43], v[4:7], v[192:195]
    ds_read_b64_tr_b16 v[40:41], v30 offset:32768
    ds_read_b64_tr_b16 v[42:43], v30 offset:49152
    v_cvt_pk_bf16_f32 v74, v84, v85
    v_cvt_pk_bf16_f32 v75, v86, v87
    buffer_store_dwordx4 v[72:75], v2, s[32:35], s18 offen offset:0 sc1
    s_waitcnt lgkmcnt(2)
    v_mfma_f32_16x16x32_bf16 v[100:103], v[44:47], v[56:59], v[100:103]
    v_cvt_pk_bf16_f32 v160, v160, v161
    v_cvt_pk_bf16_f32 v161, v162, v163
    v_cvt_pk_bf16_f32 v162, v172, v173
    v_mfma_f32_16x16x32_bf16 v[104:107], v[44:47], v[60:63], v[104:107]
    v_cvt_pk_bf16_f32 v163, v174, v175
    buffer_store_dwordx4 v[160:163], v2, s[32:35], s19 offen offset:0 sc1
    v_cvt_pk_bf16_f32 v164, v164, v165
    v_mfma_f32_16x16x32_bf16 v[108:111], v[44:47], v[12:15], v[108:111]
    v_cvt_pk_bf16_f32 v165, v166, v167
    v_cvt_pk_bf16_f32 v166, v176, v177
    v_cvt_pk_bf16_f32 v167, v178, v179
    v_mfma_f32_16x16x32_bf16 v[196:199], v[44:47], v[16:19], v[196:199]
    buffer_store_dwordx4 v[164:167], v2, s[32:35], s20 offen offset:0 sc1
    v_cvt_pk_bf16_f32 v168, v168, v169
    v_cvt_pk_bf16_f32 v169, v170, v171
    v_mfma_f32_16x16x32_bf16 v[200:203], v[44:47], v[20:23], v[200:203]
    v_cvt_pk_bf16_f32 v170, v180, v181
    v_cvt_pk_bf16_f32 v171, v182, v183
    buffer_store_dwordx4 v[168:171], v2, s[32:35], s21 offen offset:0 sc1
    v_mfma_f32_16x16x32_bf16 v[204:207], v[44:47], v[4:7], v[204:207]
    ds_read_b64_tr_b16 v[44:45], v31 offset:32768
    ds_read_b64_tr_b16 v[46:47], v31 offset:49152
    v_mfma_f32_16x16x32_bf16 v[112:115], v[32:35], v[56:59], v[112:115]
    v_mfma_f32_16x16x32_bf16 v[116:119], v[32:35], v[60:63], v[116:119]
    v_cvt_pk_bf16_f32 v88, v88, v89
    v_cvt_pk_bf16_f32 v89, v90, v91
    v_cvt_pk_bf16_f32 v90, v100, v101
    v_mfma_f32_16x16x32_bf16 v[120:123], v[32:35], v[12:15], v[120:123]
    v_cvt_pk_bf16_f32 v91, v102, v103
    buffer_store_dwordx4 v[88:91], v2, s[32:35], s16 offen offset:1024 sc1
    v_cvt_pk_bf16_f32 v92, v92, v93
    v_mfma_f32_16x16x32_bf16 v[208:211], v[32:35], v[16:19], v[208:211]
    v_cvt_pk_bf16_f32 v93, v94, v95
    v_cvt_pk_bf16_f32 v94, v104, v105
    v_cvt_pk_bf16_f32 v95, v106, v107
    v_mfma_f32_16x16x32_bf16 v[212:215], v[32:35], v[20:23], v[212:215]
    buffer_store_dwordx4 v[92:95], v2, s[32:35], s17 offen offset:1024 sc1
    v_cvt_pk_bf16_f32 v96, v96, v97
    v_cvt_pk_bf16_f32 v97, v98, v99
    s_waitcnt lgkmcnt(0)
    v_mfma_f32_16x16x32_bf16 v[216:219], v[32:35], v[4:7], v[216:219]
    v_cvt_pk_bf16_f32 v98, v108, v109
    v_cvt_pk_bf16_f32 v99, v110, v111
    buffer_store_dwordx4 v[96:99], v2, s[32:35], s18 offen offset:1024 sc1
    v_mfma_f32_16x16x32_bf16 v[124:127], v[36:39], v[56:59], v[124:127]
    v_cvt_pk_bf16_f32 v184, v184, v185
    v_cvt_pk_bf16_f32 v185, v186, v187
    v_cvt_pk_bf16_f32 v186, v196, v197
    v_mfma_f32_16x16x32_bf16 v[128:131], v[36:39], v[60:63], v[128:131]
    v_cvt_pk_bf16_f32 v187, v198, v199
    buffer_store_dwordx4 v[184:187], v2, s[32:35], s19 offen offset:1024 sc1
    v_cvt_pk_bf16_f32 v188, v188, v189
    v_mfma_f32_16x16x32_bf16 v[132:135], v[36:39], v[12:15], v[132:135]
    v_cvt_pk_bf16_f32 v189, v190, v191
    v_cvt_pk_bf16_f32 v190, v200, v201
    v_cvt_pk_bf16_f32 v191, v202, v203
    v_mfma_f32_16x16x32_bf16 v[220:223], v[36:39], v[16:19], v[220:223]
    buffer_store_dwordx4 v[188:191], v2, s[32:35], s20 offen offset:1024 sc1
    v_cvt_pk_bf16_f32 v192, v192, v193
    v_cvt_pk_bf16_f32 v193, v194, v195
    v_mfma_f32_16x16x32_bf16 v[224:227], v[36:39], v[20:23], v[224:227]
    v_cvt_pk_bf16_f32 v194, v204, v205
    v_cvt_pk_bf16_f32 v195, v206, v207
    buffer_store_dwordx4 v[192:195], v2, s[32:35], s21 offen offset:1024 sc1
    v_mfma_f32_16x16x32_bf16 v[228:231], v[36:39], v[4:7], v[228:231]
    v_mfma_f32_16x16x32_bf16 v[136:139], v[40:43], v[56:59], v[136:139]
    v_mfma_f32_16x16x32_bf16 v[148:151], v[44:47], v[56:59], v[148:151]
    v_cvt_pk_bf16_f32 v112, v112, v113
    v_cvt_pk_bf16_f32 v113, v114, v115
    v_cvt_pk_bf16_f32 v114, v124, v125
    v_mfma_f32_16x16x32_bf16 v[140:143], v[40:43], v[60:63], v[140:143]
    v_cvt_pk_bf16_f32 v115, v126, v127
    buffer_store_dwordx4 v[112:115], v2, s[32:35], s16 offen offset:2048 sc1
    v_cvt_pk_bf16_f32 v116, v116, v117
    v_mfma_f32_16x16x32_bf16 v[152:155], v[44:47], v[60:63], v[152:155]
    v_cvt_pk_bf16_f32 v117, v118, v119
    v_cvt_pk_bf16_f32 v118, v128, v129
    v_cvt_pk_bf16_f32 v119, v130, v131
    v_mfma_f32_16x16x32_bf16 v[144:147], v[40:43], v[12:15], v[144:147]
    buffer_store_dwordx4 v[116:119], v2, s[32:35], s17 offen offset:2048 sc1
    v_cvt_pk_bf16_f32 v120, v120, v121
    v_cvt_pk_bf16_f32 v121, v122, v123
    v_mfma_f32_16x16x32_bf16 v[156:159], v[44:47], v[12:15], v[156:159]
    v_cvt_pk_bf16_f32 v122, v132, v133
    v_cvt_pk_bf16_f32 v123, v134, v135
    buffer_store_dwordx4 v[120:123], v2, s[32:35], s18 offen offset:2048 sc1
    v_mfma_f32_16x16x32_bf16 v[232:235], v[40:43], v[16:19], v[232:235]
    v_cvt_pk_bf16_f32 v208, v208, v209
    v_cvt_pk_bf16_f32 v209, v210, v211
    v_cvt_pk_bf16_f32 v210, v220, v221
    v_mfma_f32_16x16x32_bf16 v[244:247], v[44:47], v[16:19], v[244:247]
    v_cvt_pk_bf16_f32 v211, v222, v223
    buffer_store_dwordx4 v[208:211], v2, s[32:35], s19 offen offset:2048 sc1
    v_cvt_pk_bf16_f32 v212, v212, v213
    v_mfma_f32_16x16x32_bf16 v[236:239], v[40:43], v[20:23], v[236:239]
    v_cvt_pk_bf16_f32 v213, v214, v215
    v_cvt_pk_bf16_f32 v214, v224, v225
    v_cvt_pk_bf16_f32 v215, v226, v227
    v_mfma_f32_16x16x32_bf16 v[248:251], v[44:47], v[20:23], v[248:251]
    buffer_store_dwordx4 v[212:215], v2, s[32:35], s20 offen offset:2048 sc1
    v_cvt_pk_bf16_f32 v216, v216, v217
    v_cvt_pk_bf16_f32 v217, v218, v219
    v_mfma_f32_16x16x32_bf16 v[240:243], v[40:43], v[4:7], v[240:243]
    v_cvt_pk_bf16_f32 v218, v228, v229
    v_cvt_pk_bf16_f32 v219, v230, v231
    buffer_store_dwordx4 v[216:219], v2, s[32:35], s21 offen offset:2048 sc1
    v_mfma_f32_16x16x32_bf16 v[252:255], v[44:47], v[4:7], v[252:255]
    v_cvt_pk_bf16_f32 v136, v136, v137
    v_cvt_pk_bf16_f32 v137, v138, v139
    v_cvt_pk_bf16_f32 v138, v148, v149
    v_cvt_pk_bf16_f32 v139, v150, v151
    buffer_store_dwordx4 v[136:139], v2, s[32:35], s16 offen offset:3072 sc1
    v_cvt_pk_bf16_f32 v140, v140, v141
    v_cvt_pk_bf16_f32 v141, v142, v143
    v_cvt_pk_bf16_f32 v142, v152, v153
    v_cvt_pk_bf16_f32 v143, v154, v155
    buffer_store_dwordx4 v[140:143], v2, s[32:35], s17 offen offset:3072 sc1
    v_cvt_pk_bf16_f32 v144, v144, v145
    v_cvt_pk_bf16_f32 v145, v146, v147
    v_cvt_pk_bf16_f32 v146, v156, v157
    v_cvt_pk_bf16_f32 v147, v158, v159
    buffer_store_dwordx4 v[144:147], v2, s[32:35], s18 offen offset:3072 sc1
    v_cvt_pk_bf16_f32 v232, v232, v233
    v_cvt_pk_bf16_f32 v233, v234, v235
    v_cvt_pk_bf16_f32 v234, v244, v245
    v_cvt_pk_bf16_f32 v235, v246, v247
    buffer_store_dwordx4 v[232:235], v2, s[32:35], s19 offen offset:3072 sc1
    v_cvt_pk_bf16_f32 v236, v236, v237
    v_cvt_pk_bf16_f32 v237, v238, v239
    v_cvt_pk_bf16_f32 v238, v248, v249
    v_cvt_pk_bf16_f32 v239, v250, v251
    buffer_store_dwordx4 v[236:239], v2, s[32:35], s20 offen offset:3072 sc1
    v_cvt_pk_bf16_f32 v240, v240, v241
    v_cvt_pk_bf16_f32 v241, v242, v243
    v_cvt_pk_bf16_f32 v242, v252, v253
    v_cvt_pk_bf16_f32 v243, v254, v255
    buffer_store_dwordx4 v[240:243], v2, s[32:35], s21 offen offset:3072 sc1
    s_branch .Lreduce
.Lcons_a:
    s_lshl_b32 s3, s4, 8
    s_add_u32 s3, s3, 0x10000
    v_add_u32 v3, s3, v3
    v_mov_b32 v24, v3
    v_xor_b32 v25, 32, v3
    v_xor_b32 v26, 64, v3
    v_xor_b32 v27, 96, v3
    v_xor_b32 v28, 128, v3
    v_xor_b32 v29, 160, v3
    v_xor_b32 v30, 192, v3
    v_xor_b32 v31, 224, v3
    v_xor_b32 v32, 0, v24
    v_xor_b32 v33, 0, v25
    v_xor_b32 v34, 0, v26
    v_xor_b32 v35, 0, v27
    v_xor_b32 v36, 0, v28
    v_xor_b32 v37, 0, v29
    v_xor_b32 v38, 0, v30
    v_xor_b32 v39, 0, v31
    s_and_b32 s3, s6, 1
    s_lshl_b32 s3, s3, 6
    v_xor_b32 v40, s3, v7
    v_xor_b32 v41, 64, v40
    v_mov_b32 v160, 0
    v_mov_b32 v161, 0
    v_mov_b32 v162, 0
    v_mov_b32 v163, 0
    v_mov_b32 v164, 0
    v_mov_b32 v165, 0
    v_mov_b32 v166, 0
    v_mov_b32 v167, 0
    v_mov_b32 v168, 0
    v_mov_b32 v169, 0
    v_mov_b32 v170, 0
    v_mov_b32 v171, 0
    v_mov_b32 v172, 0
    v_mov_b32 v173, 0
    v_mov_b32 v174, 0
    v_mov_b32 v175, 0
    v_mov_b32 v176, 0
    v_mov_b32 v177, 0
    v_mov_b32 v178, 0
    v_mov_b32 v179, 0
    v_mov_b32 v180, 0
    v_mov_b32 v181, 0
    v_mov_b32 v182, 0
    v_mov_b32 v183, 0
    v_mov_b32 v184, 0
    v_mov_b32 v185, 0
    v_mov_b32 v186, 0
    v_mov_b32 v187, 0
    v_mov_b32 v188, 0
    v_mov_b32 v189, 0
    v_mov_b32 v190, 0
    v_mov_b32 v191, 0
    v_mov_b32 v192, 0
    v_mov_b32 v193, 0
    v_mov_b32 v194, 0
    v_mov_b32 v195, 0
    v_mov_b32 v196, 0
    v_mov_b32 v197, 0
    v_mov_b32 v198, 0
    v_mov_b32 v199, 0
    v_mov_b32 v200, 0
    v_mov_b32 v201, 0
    v_mov_b32 v202, 0
    v_mov_b32 v203, 0
    v_mov_b32 v204, 0
    v_mov_b32 v205, 0
    v_mov_b32 v206, 0
    v_mov_b32 v207, 0
    v_mov_b32 v208, 0
    v_mov_b32 v209, 0
    v_mov_b32 v210, 0
    v_mov_b32 v211, 0
    v_mov_b32 v212, 0
    v_mov_b32 v213, 0
    v_mov_b32 v214, 0
    v_mov_b32 v215, 0
    v_mov_b32 v216, 0
    v_mov_b32 v217, 0
    v_mov_b32 v218, 0
    v_mov_b32 v219, 0
    v_mov_b32 v220, 0
    v_mov_b32 v221, 0
    v_mov_b32 v222, 0
    v_mov_b32 v223, 0
    v_mov_b32 v224, 0
    v_mov_b32 v225, 0
    v_mov_b32 v226, 0
    v_mov_b32 v227, 0
    v_mov_b32 v228, 0
    v_mov_b32 v229, 0
    v_mov_b32 v230, 0
    v_mov_b32 v231, 0
    v_mov_b32 v232, 0
    v_mov_b32 v233, 0
    v_mov_b32 v234, 0
    v_mov_b32 v235, 0
    v_mov_b32 v236, 0
    v_mov_b32 v237, 0
    v_mov_b32 v238, 0
    v_mov_b32 v239, 0
    v_mov_b32 v240, 0
    v_mov_b32 v241, 0
    v_mov_b32 v242, 0
    v_mov_b32 v243, 0
    v_mov_b32 v244, 0
    v_mov_b32 v245, 0
    v_mov_b32 v246, 0
    v_mov_b32 v247, 0
    v_mov_b32 v248, 0
    v_mov_b32 v249, 0
    v_mov_b32 v250, 0
    v_mov_b32 v251, 0
    v_mov_b32 v252, 0
    v_mov_b32 v253, 0
    v_mov_b32 v254, 0
    v_mov_b32 v255, 0
    s_mov_b32 s9, 0
    s_waitcnt lgkmcnt(0)
    s_barrier
.Lq_loop0:
    s_add_u32 s85, s85, 1
    s_cmp_ge_u32 s86, s85
    s_cbranch_scc0 .Lck_29_s
.Lck_29:
    ds_read_b128 v[96:99], v40 offset:0
    ds_read_b64_tr_b16 v[64:65], v24 offset:0
    ds_read_b64_tr_b16 v[66:67], v24 offset:4096
    ds_read_b128 v[100:103], v40 offset:2048
    ds_read_b128 v[104:107], v40 offset:4096
    ds_read_b64_tr_b16 v[68:69], v25 offset:0
    ds_read_b64_tr_b16 v[70:71], v25 offset:4096
    ds_read_b64_tr_b16 v[72:73], v26 offset:0
    ds_read_b64_tr_b16 v[74:75], v26 offset:4096
    ds_read_b64_tr_b16 v[76:77], v27 offset:0
    ds_read_b64_tr_b16 v[78:79], v27 offset:4096
    ds_read_b64_tr_b16 v[80:81], v28 offset:0
    ds_read_b64_tr_b16 v[82:83], v28 offset:4096
    ds_read_b64_tr_b16 v[84:85], v29 offset:0
    ds_read_b64_tr_b16 v[86:87], v29 offset:4096
    s_waitcnt lgkmcnt(12)
    v_mfma_f32_16x16x32_bf16 v[160:163], v[64:67], v[96:99], v[160:163]
    ds_read_b32 v0, v1
    s_waitcnt lgkmcnt(12)
    v_mfma_f32_16x16x32_bf16 v[164:167], v[64:67], v[100:103], v[164:167]
    ds_read_b64_tr_b16 v[88:89], v30 offset:0
    s_waitcnt lgkmcnt(12)
    v_mfma_f32_16x16x32_bf16 v[168:171], v[64:67], v[104:107], v[168:171]
    ds_read_b64_tr_b16 v[90:91], v30 offset:4096
    s_waitcnt lgkmcnt(11)
    v_mfma_f32_16x16x32_bf16 v[172:175], v[68:71], v[96:99], v[172:175]
    ds_read_b64_tr_b16 v[92:93], v31 offset:0
    ds_read_b64_tr_b16 v[94:95], v31 offset:4096
    v_mfma_f32_16x16x32_bf16 v[176:179], v[68:71], v[100:103], v[176:179]
    v_mfma_f32_16x16x32_bf16 v[180:183], v[68:71], v[104:107], v[180:183]
    s_waitcnt lgkmcnt(11)
    v_mfma_f32_16x16x32_bf16 v[184:187], v[72:75], v[96:99], v[184:187]
    v_mfma_f32_16x16x32_bf16 v[188:191], v[72:75], v[100:103], v[188:191]
    v_mfma_f32_16x16x32_bf16 v[192:195], v[72:75], v[104:107], v[192:195]
    s_waitcnt lgkmcnt(4)
    v_min_u32_dpp v0, v0, v0 quad_perm:[1,0,3,2] row_mask:0xf bank_mask:0xf
    v_mfma_f32_16x16x32_bf16 v[196:199], v[76:79], v[96:99], v[196:199]
    v_mfma_f32_16x16x32_bf16 v[200:203], v[76:79], v[100:103], v[200:203]
    v_min_u32_dpp v0, v0, v0 quad_perm:[2,3,0,1] row_mask:0xf bank_mask:0xf
    v_mfma_f32_16x16x32_bf16 v[204:207], v[76:79], v[104:107], v[204:207]
    s_waitcnt lgkmcnt(0)
    v_readfirstlane_b32 s86, v0
    s_barrier
    v_mfma_f32_16x16x32_bf16 v[208:211], v[80:83], v[96:99], v[208:211]
    s_add_u32 s85, s85, 1
    s_nop 0
    s_cmp_ge_u32 s86, s85
    s_cbranch_scc0 .Lck_30_s
.Lck_30:
    ds_read_b128 v[108:111], v41 offset:0
    v_mfma_f32_16x16x32_bf16 v[212:215], v[80:83], v[100:103], v[212:215]
    ds_read_b64_tr_b16 v[64:65], v24 offset:32768
    ds_read_b64_tr_b16 v[66:67], v24 offset:36864
    v_mfma_f32_16x16x32_bf16 v[216:219], v[80:83], v[104:107], v[216:219]
    ds_read_b128 v[112:115], v41 offset:2048
    ds_read_b128 v[116:119], v41 offset:4096
    v_mfma_f32_16x16x32_bf16 v[220:223], v[84:87], v[96:99], v[220:223]
    ds_read_b64_tr_b16 v[68:69], v25 offset:32768
    ds_read_b64_tr_b16 v[70:71], v25 offset:36864
    v_mfma_f32_16x16x32_bf16 v[224:227], v[84:87], v[100:103], v[224:227]
    ds_read_b64_tr_b16 v[72:73], v26 offset:32768
    ds_read_b64_tr_b16 v[74:75], v26 offset:36864
    v_mfma_f32_16x16x32_bf16 v[228:231], v[84:87], v[104:107], v[228:231]
    ds_read_b64_tr_b16 v[76:77], v27 offset:32768
    ds_read_b64_tr_b16 v[78:79], v27 offset:36864
    v_mfma_f32_16x16x32_bf16 v[232:235], v[88:91], v[96:99], v[232:235]
    ds_read_b64_tr_b16 v[80:81], v28 offset:32768
    ds_read_b64_tr_b16 v[82:83], v28 offset:36864
    v_mfma_f32_16x16x32_bf16 v[236:239], v[88:91], v[100:103], v[236:239]
    ds_read_b64_tr_b16 v[84:85], v29 offset:32768
    ds_read_b64_tr_b16 v[86:87], v29 offset:36864
    v_mfma_f32_16x16x32_bf16 v[240:243], v[88:91], v[104:107], v[240:243]
    v_mfma_f32_16x16x32_bf16 v[244:247], v[92:95], v[96:99], v[244:247]
    v_mfma_f32_16x16x32_bf16 v[248:251], v[92:95], v[100:103], v[248:251]
    v_mfma_f32_16x16x32_bf16 v[252:255], v[92:95], v[104:107], v[252:255]
    s_waitcnt lgkmcnt(8)
    v_mfma_f32_16x16x32_bf16 v[160:163], v[64:67], v[108:111], v[160:163]
    ds_read_b32 v0, v1
    ds_read_b64_tr_b16 v[88:89], v30 offset:32768
    v_mfma_f32_16x16x32_bf16 v[164:167], v[64:67], v[112:115], v[164:167]
    ds_read_b64_tr_b16 v[90:91], v30 offset:36864
    ds_read_b64_tr_b16 v[92:93], v31 offset:32768
    v_mfma_f32_16x16x32_bf16 v[168:171], v[64:67], v[116:119], v[168:171]
    ds_read_b64_tr_b16 v[94:95], v31 offset:36864
    v_mfma_f32_16x16x32_bf16 v[172:175], v[68:71], v[108:111], v[172:175]
    v_mfma_f32_16x16x32_bf16 v[176:179], v[68:71], v[112:115], v[176:179]
    v_mfma_f32_16x16x32_bf16 v[180:183], v[68:71], v[116:119], v[180:183]
    s_waitcnt lgkmcnt(5)
    v_mfma_f32_16x16x32_bf16 v[184:187], v[72:75], v[108:111], v[184:187]
    v_mfma_f32_16x16x32_bf16 v[188:191], v[72:75], v[112:115], v[188:191]
    v_mfma_f32_16x16x32_bf16 v[192:195], v[72:75], v[116:119], v[192:195]
    s_waitcnt lgkmcnt(3)
    v_min_u32_dpp v0, v0, v0 quad_perm:[1,0,3,2] row_mask:0xf bank_mask:0xf
    v_mfma_f32_16x16x32_bf16 v[196:199], v[76:79], v[108:111], v[196:199]
    v_mfma_f32_16x16x32_bf16 v[200:203], v[76:79], v[112:115], v[200:203]
    s_waitcnt lgkmcnt(0)
    v_min_u32_dpp v0, v0, v0 quad_perm:[2,3,0,1] row_mask:0xf bank_mask:0xf
    s_barrier
    v_mfma_f32_16x16x32_bf16 v[204:207], v[76:79], v[116:119], v[204:207]
    v_readfirstlane_b32 s86, v0
    v_mfma_f32_16x16x32_bf16 v[208:211], v[80:83], v[108:111], v[208:211]
    s_add_u32 s85, s85, 1
    s_nop 1
    s_cmp_ge_u32 s86, s85
    s_cbranch_scc0 .Lck_31_s
.Lck_31:
    ds_read_b128 v[96:99], v40 offset:8192
    v_mfma_f32_16x16x32_bf16 v[212:215], v[80:83], v[112:115], v[212:215]
    ds_read_b64_tr_b16 v[64:65], v32 offset:0
    ds_read_b64_tr_b16 v[66:67], v32 offset:4096
    v_mfma_f32_16x16x32_bf16 v[216:219], v[80:83], v[116:119], v[216:219]
    ds_read_b128 v[100:103], v40 offset:10240
    ds_read_b128 v[104:107], v40 offset:12288
    v_mfma_f32_16x16x32_bf16 v[220:223], v[84:87], v[108:111], v[220:223]
    ds_read_b64_tr_b16 v[68:69], v33 offset:0
    ds_read_b64_tr_b16 v[70:71], v33 offset:4096
    v_mfma_f32_16x16x32_bf16 v[224:227], v[84:87], v[112:115], v[224:227]
    ds_read_b64_tr_b16 v[72:73], v34 offset:0
    ds_read_b64_tr_b16 v[74:75], v34 offset:4096
    v_mfma_f32_16x16x32_bf16 v[228:231], v[84:87], v[116:119], v[228:231]
    ds_read_b64_tr_b16 v[76:77], v35 offset:0
    ds_read_b64_tr_b16 v[78:79], v35 offset:4096
    v_mfma_f32_16x16x32_bf16 v[232:235], v[88:91], v[108:111], v[232:235]
    ds_read_b64_tr_b16 v[80:81], v36 offset:0
    ds_read_b64_tr_b16 v[82:83], v36 offset:4096
    v_mfma_f32_16x16x32_bf16 v[236:239], v[88:91], v[112:115], v[236:239]
    ds_read_b64_tr_b16 v[84:85], v37 offset:0
    ds_read_b64_tr_b16 v[86:87], v37 offset:4096
    v_mfma_f32_16x16x32_bf16 v[240:243], v[88:91], v[116:119], v[240:243]
    v_mfma_f32_16x16x32_bf16 v[244:247], v[92:95], v[108:111], v[244:247]
    v_mfma_f32_16x16x32_bf16 v[248:251], v[92:95], v[112:115], v[248:251]
    v_mfma_f32_16x16x32_bf16 v[252:255], v[92:95], v[116:119], v[252:255]
    s_waitcnt lgkmcnt(8)
    v_mfma_f32_16x16x32_bf16 v[160:163], v[64:67], v[96:99], v[160:163]
    ds_read_b32 v0, v1
    ds_read_b64_tr_b16 v[88:89], v38 offset:0
    v_mfma_f32_16x16x32_bf16 v[164:167], v[64:67], v[100:103], v[164:167]
    ds_read_b64_tr_b16 v[90:91], v38 offset:4096
    ds_read_b64_tr_b16 v[92:93], v39 offset:0
    v_mfma_f32_16x16x32_bf16 v[168:171], v[64:67], v[104:107], v[168:171]
    ds_read_b64_tr_b16 v[94:95], v39 offset:4096
    v_mfma_f32_16x16x32_bf16 v[172:175], v[68:71], v[96:99], v[172:175]
    v_mfma_f32_16x16x32_bf16 v[176:179], v[68:71], v[100:103], v[176:179]
    v_mfma_f32_16x16x32_bf16 v[180:183], v[68:71], v[104:107], v[180:183]
    s_waitcnt lgkmcnt(5)
    v_mfma_f32_16x16x32_bf16 v[184:187], v[72:75], v[96:99], v[184:187]
    v_mfma_f32_16x16x32_bf16 v[188:191], v[72:75], v[100:103], v[188:191]
    v_mfma_f32_16x16x32_bf16 v[192:195], v[72:75], v[104:107], v[192:195]
    s_waitcnt lgkmcnt(3)
    v_min_u32_dpp v0, v0, v0 quad_perm:[1,0,3,2] row_mask:0xf bank_mask:0xf
    v_mfma_f32_16x16x32_bf16 v[196:199], v[76:79], v[96:99], v[196:199]
    v_mfma_f32_16x16x32_bf16 v[200:203], v[76:79], v[100:103], v[200:203]
    s_waitcnt lgkmcnt(0)
    v_min_u32_dpp v0, v0, v0 quad_perm:[2,3,0,1] row_mask:0xf bank_mask:0xf
    s_barrier
    v_mfma_f32_16x16x32_bf16 v[204:207], v[76:79], v[104:107], v[204:207]
    v_readfirstlane_b32 s86, v0
    v_mfma_f32_16x16x32_bf16 v[208:211], v[80:83], v[96:99], v[208:211]
    s_add_u32 s85, s85, 1
    s_nop 1
    s_cmp_ge_u32 s86, s85
    s_cbranch_scc0 .Lck_32_s
.Lck_32:
    ds_read_b128 v[108:111], v41 offset:8192
    v_mfma_f32_16x16x32_bf16 v[212:215], v[80:83], v[100:103], v[212:215]
    ds_read_b64_tr_b16 v[64:65], v32 offset:32768
    ds_read_b64_tr_b16 v[66:67], v32 offset:36864
    v_mfma_f32_16x16x32_bf16 v[216:219], v[80:83], v[104:107], v[216:219]
    ds_read_b128 v[112:115], v41 offset:10240
    ds_read_b128 v[116:119], v41 offset:12288
    v_mfma_f32_16x16x32_bf16 v[220:223], v[84:87], v[96:99], v[220:223]
    ds_read_b64_tr_b16 v[68:69], v33 offset:32768
    ds_read_b64_tr_b16 v[70:71], v33 offset:36864
    v_mfma_f32_16x16x32_bf16 v[224:227], v[84:87], v[100:103], v[224:227]
    ds_read_b64_tr_b16 v[72:73], v34 offset:32768
    ds_read_b64_tr_b16 v[74:75], v34 offset:36864
    v_mfma_f32_16x16x32_bf16 v[228:231], v[84:87], v[104:107], v[228:231]
    ds_read_b64_tr_b16 v[76:77], v35 offset:32768
    ds_read_b64_tr_b16 v[78:79], v35 offset:36864
    v_mfma_f32_16x16x32_bf16 v[232:235], v[88:91], v[96:99], v[232:235]
    ds_read_b64_tr_b16 v[80:81], v36 offset:32768
    ds_read_b64_tr_b16 v[82:83], v36 offset:36864
    v_mfma_f32_16x16x32_bf16 v[236:239], v[88:91], v[100:103], v[236:239]
    ds_read_b64_tr_b16 v[84:85], v37 offset:32768
    ds_read_b64_tr_b16 v[86:87], v37 offset:36864
    v_mfma_f32_16x16x32_bf16 v[240:243], v[88:91], v[104:107], v[240:243]
    v_mfma_f32_16x16x32_bf16 v[244:247], v[92:95], v[96:99], v[244:247]
    v_mfma_f32_16x16x32_bf16 v[248:251], v[92:95], v[100:103], v[248:251]
    v_mfma_f32_16x16x32_bf16 v[252:255], v[92:95], v[104:107], v[252:255]
    s_waitcnt lgkmcnt(8)
    v_mfma_f32_16x16x32_bf16 v[160:163], v[64:67], v[108:111], v[160:163]
    ds_read_b64_tr_b16 v[88:89], v38 offset:32768
    ds_read_b64_tr_b16 v[90:91], v38 offset:36864
    v_mfma_f32_16x16x32_bf16 v[164:167], v[64:67], v[112:115], v[164:167]
    ds_read_b64_tr_b16 v[92:93], v39 offset:32768
    ds_read_b64_tr_b16 v[94:95], v39 offset:36864
    v_mfma_f32_16x16x32_bf16 v[168:171], v[64:67], v[116:119], v[168:171]
    v_mfma_f32_16x16x32_bf16 v[172:175], v[68:71], v[108:111], v[172:175]
    v_mfma_f32_16x16x32_bf16 v[176:179], v[68:71], v[112:115], v[176:179]
    v_mfma_f32_16x16x32_bf16 v[180:183], v[68:71], v[116:119], v[180:183]
    s_waitcnt lgkmcnt(4)
    v_mfma_f32_16x16x32_bf16 v[184:187], v[72:75], v[108:111], v[184:187]
    v_mfma_f32_16x16x32_bf16 v[188:191], v[72:75], v[112:115], v[188:191]
    v_mfma_f32_16x16x32_bf16 v[192:195], v[72:75], v[116:119], v[192:195]
    v_mfma_f32_16x16x32_bf16 v[196:199], v[76:79], v[108:111], v[196:199]
    s_waitcnt lgkmcnt(0)
    s_barrier
    v_mfma_f32_16x16x32_bf16 v[200:203], v[76:79], v[112:115], v[200:203]
    v_mfma_f32_16x16x32_bf16 v[204:207], v[76:79], v[116:119], v[204:207]
    v_mfma_f32_16x16x32_bf16 v[208:211], v[80:83], v[108:111], v[208:211]
    v_mfma_f32_16x16x32_bf16 v[212:215], v[80:83], v[112:115], v[212:215]
    v_mfma_f32_16x16x32_bf16 v[216:219], v[80:83], v[116:119], v[216:219]
    v_mfma_f32_16x16x32_bf16 v[220:223], v[84:87], v[108:111], v[220:223]
    v_mfma_f32_16x16x32_bf16 v[224:227], v[84:87], v[112:115], v[224:227]
    v_mfma_f32_16x16x32_bf16 v[228:231], v[84:87], v[116:119], v[228:231]
    v_mfma_f32_16x16x32_bf16 v[232:235], v[88:91], v[108:111], v[232:235]
    v_mfma_f32_16x16x32_bf16 v[236:239], v[88:91], v[112:115], v[236:239]
    v_mfma_f32_16x16x32_bf16 v[240:243], v[88:91], v[116:119], v[240:243]
    v_mfma_f32_16x16x32_bf16 v[244:247], v[92:95], v[108:111], v[244:247]
    v_mfma_f32_16x16x32_bf16 v[248:251], v[92:95], v[112:115], v[248:251]
    v_mfma_f32_16x16x32_bf16 v[252:255], v[92:95], v[116:119], v[252:255]
    v_xor_b32 v40, 0x4000, v40
    v_xor_b32 v41, 0x4000, v41
    s_add_u32 s9, s9, 1
    s_cmp_lt_u32 s9, 4
    s_cbranch_scc1 .Lq_loop0
    s_waitcnt vmcnt(0)
    v_cvt_pk_bf16_f32 v112, v160, v161
    v_cvt_pk_bf16_f32 v113, v162, v163
    v_cvt_pk_bf16_f32 v114, v172, v173
    v_cvt_pk_bf16_f32 v115, v174, v175
    v_cvt_pk_bf16_f32 v128, v164, v165
    v_cvt_pk_bf16_f32 v129, v166, v167
    v_cvt_pk_bf16_f32 v130, v176, v177
    v_cvt_pk_bf16_f32 v131, v178, v179
    v_cvt_pk_bf16_f32 v144, v168, v169
    v_cvt_pk_bf16_f32 v145, v170, v171
    v_cvt_pk_bf16_f32 v146, v180, v181
    v_cvt_pk_bf16_f32 v147, v182, v183
    v_cvt_pk_bf16_f32 v116, v184, v185
    v_cvt_pk_bf16_f32 v117, v186, v187
    v_cvt_pk_bf16_f32 v118, v196, v197
    v_cvt_pk_bf16_f32 v119, v198, v199
    v_cvt_pk_bf16_f32 v132, v188, v189
    v_cvt_pk_bf16_f32 v133, v190, v191
    v_cvt_pk_bf16_f32 v134, v200, v201
    v_cvt_pk_bf16_f32 v135, v202, v203
    v_cvt_pk_bf16_f32 v148, v192, v193
    v_cvt_pk_bf16_f32 v149, v194, v195
    v_cvt_pk_bf16_f32 v150, v204, v205
    v_cvt_pk_bf16_f32 v151, v206, v207
    v_cvt_pk_bf16_f32 v120, v208, v209
    v_cvt_pk_bf16_f32 v121, v210, v211
    v_cvt_pk_bf16_f32 v122, v220, v221
    v_cvt_pk_bf16_f32 v123, v222, v223
    v_cvt_pk_bf16_f32 v136, v212, v213
    v_cvt_pk_bf16_f32 v137, v214, v215
    v_cvt_pk_bf16_f32 v138, v224, v225
    v_cvt_pk_bf16_f32 v139, v226, v227
    v_cvt_pk_bf16_f32 v152, v216, v217
    v_cvt_pk_bf16_f32 v153, v218, v219
    v_cvt_pk_bf16_f32 v154, v228, v229
    v_cvt_pk_bf16_f32 v155, v230, v231
    v_cvt_pk_bf16_f32 v124, v232, v233
    v_cvt_pk_bf16_f32 v125, v234, v235
    v_cvt_pk_bf16_f32 v126, v244, v245
    v_cvt_pk_bf16_f32 v127, v246, v247
    v_cvt_pk_bf16_f32 v140, v236, v237
    v_cvt_pk_bf16_f32 v141, v238, v239
    v_cvt_pk_bf16_f32 v142, v248, v249
    v_cvt_pk_bf16_f32 v143, v250, v251
    v_cvt_pk_bf16_f32 v156, v240, v241
    v_cvt_pk_bf16_f32 v157, v242, v243
    v_cvt_pk_bf16_f32 v158, v252, v253
    v_cvt_pk_bf16_f32 v159, v254, v255
    v_permlane32_swap_b32 v112, v114
    v_permlane32_swap_b32 v113, v115
    v_permlane32_swap_b32 v116, v118
    v_permlane32_swap_b32 v117, v119
    v_permlane32_swap_b32 v120, v122
    v_permlane32_swap_b32 v121, v123
    v_permlane32_swap_b32 v124, v126
    v_permlane32_swap_b32 v125, v127
    v_permlane32_swap_b32 v128, v130
    v_permlane32_swap_b32 v129, v131
    v_permlane32_swap_b32 v132, v134
    v_permlane32_swap_b32 v133, v135
    v_permlane32_swap_b32 v136, v138
    v_permlane32_swap_b32 v137, v139
    v_permlane32_swap_b32 v140, v142
    v_permlane32_swap_b32 v141, v143
    v_permlane32_swap_b32 v144, v146
    v_permlane32_swap_b32 v145, v147
    v_permlane32_swap_b32 v148, v150
    v_permlane32_swap_b32 v149, v151
    v_permlane32_swap_b32 v152, v154
    v_permlane32_swap_b32 v153, v155
    v_permlane32_swap_b32 v156, v158
    v_permlane32_swap_b32 v157, v159
    v_permlane16_swap_b32 v112, v114
    v_permlane16_swap_b32 v113, v115
    v_permlane16_swap_b32 v116, v118
    v_permlane16_swap_b32 v117, v119
    v_permlane16_swap_b32 v120, v122
    v_permlane16_swap_b32 v121, v123
    v_permlane16_swap_b32 v124, v126
    v_permlane16_swap_b32 v125, v127
    v_permlane16_swap_b32 v128, v130
    v_permlane16_swap_b32 v129, v131
    v_permlane16_swap_b32 v132, v134
    v_permlane16_swap_b32 v133, v135
    v_permlane16_swap_b32 v136, v138
    v_permlane16_swap_b32 v137, v139
    v_permlane16_swap_b32 v140, v142
    v_permlane16_swap_b32 v141, v143
    v_permlane16_swap_b32 v144, v146
    v_permlane16_swap_b32 v145, v147
    v_permlane16_swap_b32 v148, v150
    v_permlane16_swap_b32 v149, v151
    v_permlane16_swap_b32 v152, v154
    v_permlane16_swap_b32 v153, v155
    v_permlane16_swap_b32 v156, v158
    v_permlane16_swap_b32 v157, v159
    v_mov_b32 v20, v6
    v_xor_b32 v21, 64, v6
    v_xor_b32 v22, 128, v6
    v_xor_b32 v23, 192, v6
    v_add_u32 v56, 0x1c000, v4
    v_xor_b32 v57, 32, v56
    v_xor_b32 v58, 64, v56
    v_xor_b32 v59, 96, v56
    v_xor_b32 v60, 128, v56
    v_xor_b32 v61, 160, v56
    v_xor_b32 v62, 192, v56
    v_xor_b32 v63, 224, v56
    v_mov_b32 v3, 0xff7fffff
    v_mov_b32 v4, 0xff7fffff
    v_mov_b32 v6, 0xff7fffff
    v_mov_b32 v14, 0
    v_mov_b32 v15, 0
    v_mov_b32 v16, 0
    v_mov_b32 v17, 0
    v_mov_b32 v18, 0
    v_mov_b32 v19, 0
    v_mov_b32 v160, 0
    v_mov_b32 v161, 0
    v_mov_b32 v162, 0
    v_mov_b32 v163, 0
    v_mov_b32 v164, 0
    v_mov_b32 v165, 0
    v_mov_b32 v166, 0
    v_mov_b32 v167, 0
    v_mov_b32 v168, 0
    v_mov_b32 v169, 0
    v_mov_b32 v170, 0
    v_mov_b32 v171, 0
    v_mov_b32 v172, 0
    v_mov_b32 v173, 0
    v_mov_b32 v174, 0
    v_mov_b32 v175, 0
    v_mov_b32 v176, 0
    v_mov_b32 v177, 0
    v_mov_b32 v178, 0
    v_mov_b32 v179, 0
    v_mov_b32 v180, 0
    v_mov_b32 v181, 0
    v_mov_b32 v182, 0
    v_mov_b32 v183, 0
    v_mov_b32 v184, 0
    v_mov_b32 v185, 0
    v_mov_b32 v186, 0
    v_mov_b32 v187, 0
    v_mov_b32 v188, 0
    v_mov_b32 v189, 0
    v_mov_b32 v190, 0
    v_mov_b32 v191, 0
    v_mov_b32 v192, 0
    v_mov_b32 v193, 0
    v_mov_b32 v194, 0
    v_mov_b32 v195, 0
    v_mov_b32 v196, 0
    v_mov_b32 v197, 0
    v_mov_b32 v198, 0
    v_mov_b32 v199, 0
    v_mov_b32 v200, 0
    v_mov_b32 v201, 0
    v_mov_b32 v202, 0
    v_mov_b32 v203, 0
    v_mov_b32 v204, 0
    v_mov_b32 v205, 0
    v_mov_b32 v206, 0
    v_mov_b32 v207, 0
    v_mov_b32 v208, 0
    v_mov_b32 v209, 0
    v_mov_b32 v210, 0
    v_mov_b32 v211, 0
    v_mov_b32 v212, 0
    v_mov_b32 v213, 0
    v_mov_b32 v214, 0
    v_mov_b32 v215, 0
    v_mov_b32 v216, 0
    v_mov_b32 v217, 0
    v_mov_b32 v218, 0
    v_mov_b32 v219, 0
    v_mov_b32 v220, 0
    v_mov_b32 v221, 0
    v_mov_b32 v222, 0
    v_mov_b32 v223, 0
    v_mov_b32 v224, 0
    v_mov_b32 v225, 0
    v_mov_b32 v226, 0
    v_mov_b32 v227, 0
    v_mov_b32 v228, 0
    v_mov_b32 v229, 0
    v_mov_b32 v230, 0
    v_mov_b32 v231, 0
    v_mov_b32 v232, 0
    v_mov_b32 v233, 0
    v_mov_b32 v234, 0
    v_mov_b32 v235, 0
    v_mov_b32 v236, 0
    v_mov_b32 v237, 0
    v_mov_b32 v238, 0
    v_mov_b32 v239, 0
    v_mov_b32 v240, 0
    v_mov_b32 v241, 0
    v_mov_b32 v242, 0
    v_mov_b32 v243, 0
    v_mov_b32 v244, 0
    v_mov_b32 v245, 0
    v_mov_b32 v246, 0
    v_mov_b32 v247, 0
    v_mov_b32 v248, 0
    v_mov_b32 v249, 0
    v_mov_b32 v250, 0
    v_mov_b32 v251, 0
    v_mov_b32 v252, 0
    v_mov_b32 v253, 0
    v_mov_b32 v254, 0
    v_mov_b32 v255, 0
    s_add_u32 s85, s85, 1
    s_cmp_ge_u32 s86, s85
    s_cbranch_scc0 .Lck_33_s
.Lck_33:
    ds_read_b128 v[24:27], v20 offset:0
    ds_read_b128 v[28:31], v20 offset:4096
    ds_read_b128 v[32:35], v21 offset:0
    ds_read_b128 v[36:39], v21 offset:4096
    ds_read_b128 v[40:43], v22 offset:0
    ds_read_b128 v[44:47], v22 offset:4096
    ds_read_b128 v[48:51], v23 offset:0
    ds_read_b128 v[52:55], v23 offset:4096
    s_mov_b32 s9, 0
.Lchunk_a:
    s_waitcnt lgkmcnt(2)
    v_mfma_f32_16x16x32_bf16 v[64:67], v[24:27], v[112:115], 0
    ds_read_b32 v0, v1
    v_mfma_f32_16x16x32_bf16 v[72:75], v[24:27], v[128:131], 0
    v_mfma_f32_16x16x32_bf16 v[80:83], v[24:27], v[144:147], 0
    v_mfma_f32_16x16x32_bf16 v[68:71], v[28:31], v[112:115], 0
    v_mfma_f32_16x16x32_bf16 v[76:79], v[28:31], v[128:131], 0
    v_mfma_f32_16x16x32_bf16 v[84:87], v[28:31], v[144:147], 0
    v_mfma_f32_16x16x32_bf16 v[64:67], v[32:35], v[116:119], v[64:67]
    v_mfma_f32_16x16x32_bf16 v[72:75], v[32:35], v[132:135], v[72:75]
    v_mfma_f32_16x16x32_bf16 v[80:83], v[32:35], v[148:151], v[80:83]
    s_waitcnt lgkmcnt(0)
    v_min_u32_dpp v0, v0, v0 quad_perm:[1,0,3,2] row_mask:0xf bank_mask:0xf
    v_mfma_f32_16x16x32_bf16 v[68:71], v[36:39], v[116:119], v[68:71]
    v_mfma_f32_16x16x32_bf16 v[76:79], v[36:39], v[132:135], v[76:79]
    v_min_u32_dpp v0, v0, v0 quad_perm:[2,3,0,1] row_mask:0xf bank_mask:0xf
    v_mfma_f32_16x16x32_bf16 v[84:87], v[36:39], v[148:151], v[84:87]
    v_readfirstlane_b32 s86, v0
    v_mfma_f32_16x16x32_bf16 v[64:67], v[40:43], v[120:123], v[64:67]
    s_add_u32 s85, s85, 1
    s_nop 1
    s_cmp_ge_u32 s86, s85
    s_cbranch_scc0 .Lck_35_s
.Lck_35:
    ds_read_b128 v[24:27], v20 offset:8192
    v_mfma_f32_16x16x32_bf16 v[72:75], v[40:43], v[136:139], v[72:75]
    ds_read_b128 v[28:31], v20 offset:12288
    ds_read_b128 v[32:35], v21 offset:8192
    v_mfma_f32_16x16x32_bf16 v[80:83], v[40:43], v[152:155], v[80:83]
    ds_read_b128 v[36:39], v21 offset:12288
    ds_read_b32 v0, v1
    v_mfma_f32_16x16x32_bf16 v[68:71], v[44:47], v[120:123], v[68:71]
    ds_read_b128 v[40:43], v22 offset:8192
    v_mfma_f32_16x16x32_bf16 v[76:79], v[44:47], v[136:139], v[76:79]
    v_mfma_f32_16x16x32_bf16 v[84:87], v[44:47], v[152:155], v[84:87]
    ds_read_b128 v[44:47], v22 offset:12288
    v_mfma_f32_16x16x32_bf16 v[64:67], v[48:51], v[124:127], v[64:67]
    v_mfma_f32_16x16x32_bf16 v[72:75], v[48:51], v[140:143], v[72:75]
    v_mfma_f32_16x16x32_bf16 v[80:83], v[48:51], v[156:159], v[80:83]
    ds_read_b128 v[48:51], v23 offset:8192
    v_mfma_f32_16x16x32_bf16 v[68:71], v[52:55], v[124:127], v[68:71]
    v_mfma_f32_16x16x32_bf16 v[76:79], v[52:55], v[140:143], v[76:79]
    s_waitcnt lgkmcnt(3)
    v_min_u32_dpp v0, v0, v0 quad_perm:[1,0,3,2] row_mask:0xf bank_mask:0xf
    v_mfma_f32_16x16x32_bf16 v[84:87], v[52:55], v[156:159], v[84:87]
    ds_read_b128 v[52:55], v23 offset:12288
    v_mfma_f32_16x16x32_bf16 v[88:91], v[24:27], v[112:115], 0
    v_min_u32_dpp v0, v0, v0 quad_perm:[2,3,0,1] row_mask:0xf bank_mask:0xf
    v_max_f32 v7, v64, v65
    v_mfma_f32_16x16x32_bf16 v[96:99], v[24:27], v[128:131], 0
    v_readfirstlane_b32 s86, v0
    v_max_f32 v8, v72, v73
    v_mfma_f32_16x16x32_bf16 v[104:107], v[24:27], v[144:147], 0
    v_max_f32 v9, v80, v81
    v_mfma_f32_16x16x32_bf16 v[92:95], v[28:31], v[112:115], 0
    v_mfma_f32_16x16x32_bf16 v[100:103], v[28:31], v[128:131], 0
    v_max3_f32 v7, v7, v66, v67
    v_mfma_f32_16x16x32_bf16 v[108:111], v[28:31], v[144:147], 0
    v_mfma_f32_16x16x32_bf16 v[88:91], v[32:35], v[116:119], v[88:91]
    v_max3_f32 v8, v8, v74, v75
    v_mfma_f32_16x16x32_bf16 v[96:99], v[32:35], v[132:135], v[96:99]
    s_waitcnt lgkmcnt(0)
    v_mfma_f32_16x16x32_bf16 v[104:107], v[32:35], v[148:151], v[104:107]
    s_add_u32 s85, s85, 1
    s_cmp_ge_u32 s86, s85
    s_cbranch_scc0 .Lck_36_s
.Lck_36:
    v_add_u32 v56, 0x8000, v56
    v_and_b32 v56, 0x1ffff, v56
    ds_read_b64_tr_b16 v[24:25], v56 offset:0
    v_mfma_f32_16x16x32_bf16 v[92:95], v[36:39], v[116:119], v[92:95]
    ds_read_b64_tr_b16 v[26:27], v56 offset:4096
    v_max3_f32 v9, v9, v82, v83
    v_mfma_f32_16x16x32_bf16 v[100:103], v[36:39], v[132:135], v[100:103]
    v_add_u32 v57, 0x8000, v57
    v_and_b32 v57, 0x1ffff, v57
    ds_read_b64_tr_b16 v[28:29], v57 offset:0
    v_mfma_f32_16x16x32_bf16 v[108:111], v[36:39], v[148:151], v[108:111]
    ds_read_b64_tr_b16 v[30:31], v57 offset:4096
    v_max3_f32 v7, v7, v68, v69
    v_mfma_f32_16x16x32_bf16 v[88:91], v[40:43], v[120:123], v[88:91]
    v_add_u32 v58, 0x8000, v58
    v_and_b32 v58, 0x1ffff, v58
    ds_read_b64_tr_b16 v[32:33], v58 offset:0
    v_mfma_f32_16x16x32_bf16 v[96:99], v[40:43], v[136:139], v[96:99]
    ds_read_b64_tr_b16 v[34:35], v58 offset:4096
    v_max3_f32 v8, v8, v76, v77
    v_mfma_f32_16x16x32_bf16 v[104:107], v[40:43], v[152:155], v[104:107]
    v_add_u32 v59, 0x8000, v59
    v_and_b32 v59, 0x1ffff, v59
    ds_read_b64_tr_b16 v[36:37], v59 offset:0
    v_mfma_f32_16x16x32_bf16 v[92:95], v[44:47], v[120:123], v[92:95]
    ds_read_b64_tr_b16 v[38:39], v59 offset:4096
    v_max3_f32 v9, v9, v84, v85
    v_mfma_f32_16x16x32_bf16 v[100:103], v[44:47], v[136:139], v[100:103]
    v_add_u32 v60, 0x8000, v60
    v_and_b32 v60, 0x1ffff, v60
    ds_read_b64_tr_b16 v[40:41], v60 offset:0
    v_mfma_f32_16x16x32_bf16 v[108:111], v[44:47], v[152:155], v[108:111]
    ds_read_b64_tr_b16 v[42:43], v60 offset:4096
    v_max3_f32 v7, v7, v70, v71
    v_mfma_f32_16x16x32_bf16 v[88:91], v[48:51], v[124:127], v[88:91]
    v_add_u32 v61, 0x8000, v61
    v_and_b32 v61, 0x1ffff, v61
    ds_read_b64_tr_b16 v[44:45], v61 offset:0
    v_mfma_f32_16x16x32_bf16 v[96:99], v[48:51], v[140:143], v[96:99]
    ds_read_b64_tr_b16 v[46:47], v61 offset:4096
    v_max3_f32 v8, v8, v78, v79
    v_mfma_f32_16x16x32_bf16 v[104:107], v[48:51], v[156:159], v[104:107]
    ds_read_b32 v0, v1
    v_max3_f32 v9, v9, v86, v87
    v_mfma_f32_16x16x32_bf16 v[92:95], v[52:55], v[124:127], v[92:95]
    v_add_u32 v62, 0x8000, v62
    v_and_b32 v62, 0x1ffff, v62
    ds_read_b64_tr_b16 v[48:49], v62 offset:0
    v_mfma_f32_16x16x32_bf16 v[100:103], v[52:55], v[140:143], v[100:103]
    ds_read_b64_tr_b16 v[50:51], v62 offset:4096
    v_mfma_f32_16x16x32_bf16 v[108:111], v[52:55], v[156:159], v[108:111]
    v_max3_f32 v7, v7, v88, v89
    v_max3_f32 v8, v8, v96, v97
    v_max3_f32 v9, v9, v104, v105
    v_max3_f32 v7, v7, v90, v91
    v_max3_f32 v8, v8, v98, v99
    v_max3_f32 v9, v9, v106, v107
    v_max3_f32 v7, v7, v92, v93
    v_max3_f32 v8, v8, v100, v101
    v_max3_f32 v9, v9, v108, v109
    v_max3_f32 v7, v7, v94, v95
    v_max3_f32 v8, v8, v102, v103
    v_max3_f32 v9, v9, v110, v111
    v_fma_f32 v10, v7, s36, -v3
    v_fma_f32 v12, v8, s36, -v4
    v_fma_f32 v13, v9, s36, -v6
    v_max3_f32 v10, v10, v12, v13
    v_cmp_nge_f32 vcc, 0x41000000, v10
    s_nop 4
    s_cbranch_vccnz .Lrs_34_s
.Lrs_34:
    v_pk_fma_f32 v[64:65], v[64:65], s[36:37], v[2:3] op_sel:[0,0,1] op_sel_hi:[1,1,1] neg_lo:[0,0,1] neg_hi:[0,0,1]
    v_pk_fma_f32 v[66:67], v[66:67], s[36:37], v[2:3] op_sel:[0,0,1] op_sel_hi:[1,1,1] neg_lo:[0,0,1] neg_hi:[0,0,1]
    s_waitcnt lgkmcnt(2)
    v_min_u32_dpp v0, v0, v0 quad_perm:[1,0,3,2] row_mask:0xf bank_mask:0xf
    v_pk_fma_f32 v[68:69], v[68:69], s[36:37], v[2:3] op_sel:[0,0,1] op_sel_hi:[1,1,1] neg_lo:[0,0,1] neg_hi:[0,0,1]
    v_pk_fma_f32 v[70:71], v[70:71], s[36:37], v[2:3] op_sel:[0,0,1] op_sel_hi:[1,1,1] neg_lo:[0,0,1] neg_hi:[0,0,1]
    v_min_u32_dpp v0, v0, v0 quad_perm:[2,3,0,1] row_mask:0xf bank_mask:0xf
    v_pk_fma_f32 v[72:73], v[72:73], s[36:37], v[4:5] op_sel:[0,0,0] op_sel_hi:[1,1,0] neg_lo:[0,0,1] neg_hi:[0,0,1]
    v_readfirstlane_b32 s86, v0
    v_pk_fma_f32 v[74:75], v[74:75], s[36:37], v[4:5] op_sel:[0,0,0] op_sel_hi:[1,1,0] neg_lo:[0,0,1] neg_hi:[0,0,1]
    v_add_u32 v63, 0x8000, v63
    v_and_b32 v63, 0x1ffff, v63
    ds_read_b64_tr_b16 v[52:53], v63 offset:0
    v_pk_fma_f32 v[76:77], v[76:77], s[36:37], v[4:5] op_sel:[0,0,0] op_sel_hi:[1,1,0] neg_lo:[0,0,1] neg_hi:[0,0,1]
    v_pk_fma_f32 v[78:79], v[78:79], s[36:37], v[4:5] op_sel:[0,0,0] op_sel_hi:[1,1,0] neg_lo:[0,0,1] neg_hi:[0,0,1]
    ds_read_b64_tr_b16 v[54:55], v63 offset:4096
    v_exp_f32 v64, v64
    v_exp_f32 v65, v65
    v_exp_f32 v66, v66
    v_exp_f32 v67, v67
    v_exp_f32 v68, v68
    v_exp_f32 v69, v69
    v_exp_f32 v70, v70
    v_exp_f32 v71, v71
    v_pk_add_f32 v[14:15], v[14:15], v[64:65]
    v_pk_add_f32 v[14:15], v[14:15], v[66:67]
    v_pk_add_f32 v[14:15], v[14:15], v[68:69]
    v_pk_add_f32 v[14:15], v[14:15], v[70:71]
    v_cvt_pk_bf16_f32 v64, v64, v65
    v_cvt_pk_bf16_f32 v65, v66, v67
    v_cvt_pk_bf16_f32 v66, v68, v69
    v_cvt_pk_bf16_f32 v67, v70, v71
    v_pk_fma_f32 v[80:81], v[80:81], s[36:37], v[6:7] op_sel:[0,0,0] op_sel_hi:[1,1,0] neg_lo:[0,0,1] neg_hi:[0,0,1]
    v_pk_fma_f32 v[82:83], v[82:83], s[36:37], v[6:7] op_sel:[0,0,0] op_sel_hi:[1,1,0] neg_lo:[0,0,1] neg_hi:[0,0,1]
    v_pk_fma_f32 v[84:85], v[84:85], s[36:37], v[6:7] op_sel:[0,0,0] op_sel_hi:[1,1,0] neg_lo:[0,0,1] neg_hi:[0,0,1]
    v_pk_fma_f32 v[86:87], v[86:87], s[36:37], v[6:7] op_sel:[0,0,0] op_sel_hi:[1,1,0] neg_lo:[0,0,1] neg_hi:[0,0,1]
    v_exp_f32 v72, v72
    v_exp_f32 v73, v73
    s_waitcnt lgkmcnt(0)
    v_exp_f32 v74, v74
    v_exp_f32 v75, v75
    v_exp_f32 v76, v76
    v_exp_f32 v77, v77
    v_exp_f32 v78, v78
    v_exp_f32 v79, v79
    v_pk_add_f32 v[16:17], v[16:17], v[72:73]
    v_pk_add_f32 v[16:17], v[16:17], v[74:75]
    v_pk_add_f32 v[16:17], v[16:17], v[76:77]
    v_pk_add_f32 v[16:17], v[16:17], v[78:79]
    v_cvt_pk_bf16_f32 v72, v72, v73
    v_cvt_pk_bf16_f32 v73, v74, v75
    v_cvt_pk_bf16_f32 v74, v76, v77
    v_cvt_pk_bf16_f32 v75, v78, v79
    v_pk_fma_f32 v[88:89], v[88:89], s[36:37], v[2:3] op_sel:[0,0,1] op_sel_hi:[1,1,1] neg_lo:[0,0,1] neg_hi:[0,0,1]
    v_pk_fma_f32 v[90:91], v[90:91], s[36:37], v[2:3] op_sel:[0,0,1] op_sel_hi:[1,1,1] neg_lo:[0,0,1] neg_hi:[0,0,1]
    v_pk_fma_f32 v[92:93], v[92:93], s[36:37], v[2:3] op_sel:[0,0,1] op_sel_hi:[1,1,1] neg_lo:[0,0,1] neg_hi:[0,0,1]
    v_pk_fma_f32 v[94:95], v[94:95], s[36:37], v[2:3] op_sel:[0,0,1] op_sel_hi:[1,1,1] neg_lo:[0,0,1] neg_hi:[0,0,1]
    v_exp_f32 v80, v80
    v_exp_f32 v81, v81
    v_exp_f32 v82, v82
    v_exp_f32 v83, v83
    v_exp_f32 v84, v84
    v_exp_f32 v85, v85
    v_exp_f32 v86, v86
    v_exp_f32 v87, v87
    v_pk_add_f32 v[18:19], v[18:19], v[80:81]
    v_pk_add_f32 v[18:19], v[18:19], v[82:83]
    v_pk_add_f32 v[18:19], v[18:19], v[84:85]
    v_pk_add_f32 v[18:19], v[18:19], v[86:87]
    v_cvt_pk_bf16_f32 v80, v80, v81
    v_cvt_pk_bf16_f32 v81, v82, v83
    v_cvt_pk_bf16_f32 v82, v84, v85
    v_cvt_pk_bf16_f32 v83, v86, v87
    v_pk_fma_f32 v[96:97], v[96:97], s[36:37], v[4:5] op_sel:[0,0,0] op_sel_hi:[1,1,0] neg_lo:[0,0,1] neg_hi:[0,0,1]
    v_pk_fma_f32 v[98:99], v[98:99], s[36:37], v[4:5] op_sel:[0,0,0] op_sel_hi:[1,1,0] neg_lo:[0,0,1] neg_hi:[0,0,1]
    v_pk_fma_f32 v[100:101], v[100:101], s[36:37], v[4:5] op_sel:[0,0,0] op_sel_hi:[1,1,0] neg_lo:[0,0,1] neg_hi:[0,0,1]
    v_pk_fma_f32 v[102:103], v[102:103], s[36:37], v[4:5] op_sel:[0,0,0] op_sel_hi:[1,1,0] neg_lo:[0,0,1] neg_hi:[0,0,1]
    v_exp_f32 v88, v88
    v_exp_f32 v89, v89
    v_exp_f32 v90, v90
    v_exp_f32 v91, v91
    v_exp_f32 v92, v92
    v_exp_f32 v93, v93
    v_exp_f32 v94, v94
    v_exp_f32 v95, v95
    v_pk_add_f32 v[14:15], v[14:15], v[88:89]
    v_pk_add_f32 v[14:15], v[14:15], v[90:91]
    v_pk_add_f32 v[14:15], v[14:15], v[92:93]
    v_pk_add_f32 v[14:15], v[14:15], v[94:95]
    v_cvt_pk_bf16_f32 v88, v88, v89
    v_cvt_pk_bf16_f32 v89, v90, v91
    v_cvt_pk_bf16_f32 v90, v92, v93
    v_cvt_pk_bf16_f32 v91, v94, v95
    v_pk_fma_f32 v[104:105], v[104:105], s[36:37], v[6:7] op_sel:[0,0,0] op_sel_hi:[1,1,0] neg_lo:[0,0,1] neg_hi:[0,0,1]
    v_pk_fma_f32 v[106:107], v[106:107], s[36:37], v[6:7] op_sel:[0,0,0] op_sel_hi:[1,1,0] neg_lo:[0,0,1] neg_hi:[0,0,1]
    v_pk_fma_f32 v[108:109], v[108:109], s[36:37], v[6:7] op_sel:[0,0,0] op_sel_hi:[1,1,0] neg_lo:[0,0,1] neg_hi:[0,0,1]
    v_pk_fma_f32 v[110:111], v[110:111], s[36:37], v[6:7] op_sel:[0,0,0] op_sel_hi:[1,1,0] neg_lo:[0,0,1] neg_hi:[0,0,1]
    v_exp_f32 v96, v96
    v_exp_f32 v97, v97
    v_exp_f32 v98, v98
    v_exp_f32 v99, v99
    v_exp_f32 v100, v100
    v_exp_f32 v101, v101
    v_exp_f32 v102, v102
    v_exp_f32 v103, v103
    v_pk_add_f32 v[16:17], v[16:17], v[96:97]
    v_pk_add_f32 v[16:17], v[16:17], v[98:99]
    v_pk_add_f32 v[16:17], v[16:17], v[100:101]
    v_pk_add_f32 v[16:17], v[16:17], v[102:103]
    v_cvt_pk_bf16_f32 v96, v96, v97
    v_cvt_pk_bf16_f32 v97, v98, v99
    v_cvt_pk_bf16_f32 v98, v100, v101
    v_cvt_pk_bf16_f32 v99, v102, v103
    v_exp_f32 v104, v104
    v_exp_f32 v105, v105
    v_exp_f32 v106, v106
    v_exp_f32 v107, v107
    v_exp_f32 v108, v108
    v_exp_f32 v109, v109
    v_exp_f32 v110, v110
    v_exp_f32 v111, v111
    v_pk_add_f32 v[18:19], v[18:19], v[104:105]
    v_pk_add_f32 v[18:19], v[18:19], v[106:107]
    v_pk_add_f32 v[18:19], v[18:19], v[108:109]
    v_pk_add_f32 v[18:19], v[18:19], v[110:111]
    v_cvt_pk_bf16_f32 v104, v104, v105
    v_cvt_pk_bf16_f32 v105, v106, v107
    v_cvt_pk_bf16_f32 v106, v108, v109
    v_cvt_pk_bf16_f32 v107, v110, v111
    v_mfma_f32_16x16x32_bf16 v[160:163], v[24:27], v[64:67], v[160:163]
    v_mfma_f32_16x16x32_bf16 v[164:167], v[24:27], v[72:75], v[164:167]
    v_mfma_f32_16x16x32_bf16 v[168:171], v[24:27], v[80:83], v[168:171]
    s_add_u32 s85, s85, 1
    s_cmp_ge_u32 s86, s85
    s_cbranch_scc0 .Lck_37_s
.Lck_37:
    ds_read_b64_tr_b16 v[24:25], v56 offset:8192
    v_mfma_f32_16x16x32_bf16 v[172:175], v[28:31], v[64:67], v[172:175]
    ds_read_b64_tr_b16 v[26:27], v56 offset:12288
    v_mfma_f32_16x16x32_bf16 v[176:179], v[28:31], v[72:75], v[176:179]
    v_mfma_f32_16x16x32_bf16 v[180:183], v[28:31], v[80:83], v[180:183]
    ds_read_b64_tr_b16 v[28:29], v57 offset:8192
    ds_read_b64_tr_b16 v[30:31], v57 offset:12288
    v_mfma_f32_16x16x32_bf16 v[184:187], v[32:35], v[64:67], v[184:187]
    v_mfma_f32_16x16x32_bf16 v[188:191], v[32:35], v[72:75], v[188:191]
    v_mfma_f32_16x16x32_bf16 v[192:195], v[32:35], v[80:83], v[192:195]
    ds_read_b64_tr_b16 v[32:33], v58 offset:8192
    ds_read_b64_tr_b16 v[34:35], v58 offset:12288
    v_mfma_f32_16x16x32_bf16 v[196:199], v[36:39], v[64:67], v[196:199]
    v_mfma_f32_16x16x32_bf16 v[200:203], v[36:39], v[72:75], v[200:203]
    v_mfma_f32_16x16x32_bf16 v[204:207], v[36:39], v[80:83], v[204:207]
    ds_read_b64_tr_b16 v[36:37], v59 offset:8192
    ds_read_b64_tr_b16 v[38:39], v59 offset:12288
    v_mfma_f32_16x16x32_bf16 v[208:211], v[40:43], v[64:67], v[208:211]
    v_mfma_f32_16x16x32_bf16 v[212:215], v[40:43], v[72:75], v[212:215]
    v_mfma_f32_16x16x32_bf16 v[216:219], v[40:43], v[80:83], v[216:219]
    ds_read_b64_tr_b16 v[40:41], v60 offset:8192
    ds_read_b64_tr_b16 v[42:43], v60 offset:12288
    v_mfma_f32_16x16x32_bf16 v[220:223], v[44:47], v[64:67], v[220:223]
    v_mfma_f32_16x16x32_bf16 v[224:227], v[44:47], v[72:75], v[224:227]
    v_mfma_f32_16x16x32_bf16 v[228:231], v[44:47], v[80:83], v[228:231]
    ds_read_b64_tr_b16 v[44:45], v61 offset:8192
    ds_read_b64_tr_b16 v[46:47], v61 offset:12288
    v_mfma_f32_16x16x32_bf16 v[232:235], v[48:51], v[64:67], v[232:235]
    ds_read_b32 v0, v1
    v_mfma_f32_16x16x32_bf16 v[236:239], v[48:51], v[72:75], v[236:239]
    v_mfma_f32_16x16x32_bf16 v[240:243], v[48:51], v[80:83], v[240:243]
    ds_read_b64_tr_b16 v[48:49], v62 offset:8192
    ds_read_b64_tr_b16 v[50:51], v62 offset:12288
    v_mfma_f32_16x16x32_bf16 v[244:247], v[52:55], v[64:67], v[244:247]
    v_mfma_f32_16x16x32_bf16 v[248:251], v[52:55], v[72:75], v[248:251]
    v_mfma_f32_16x16x32_bf16 v[252:255], v[52:55], v[80:83], v[252:255]
    s_waitcnt lgkmcnt(5)
    v_mfma_f32_16x16x32_bf16 v[160:163], v[24:27], v[88:91], v[160:163]
    ds_read_b64_tr_b16 v[52:53], v63 offset:8192
    ds_read_b64_tr_b16 v[54:55], v63 offset:12288
    v_mfma_f32_16x16x32_bf16 v[164:167], v[24:27], v[96:99], v[164:167]
    v_mfma_f32_16x16x32_bf16 v[168:171], v[24:27], v[104:107], v[168:171]
    s_waitcnt lgkmcnt(4)
    v_min_u32_dpp v0, v0, v0 quad_perm:[1,0,3,2] row_mask:0xf bank_mask:0xf
    v_mfma_f32_16x16x32_bf16 v[172:175], v[28:31], v[88:91], v[172:175]
    v_mfma_f32_16x16x32_bf16 v[176:179], v[28:31], v[96:99], v[176:179]
    v_min_u32_dpp v0, v0, v0 quad_perm:[2,3,0,1] row_mask:0xf bank_mask:0xf
    v_mfma_f32_16x16x32_bf16 v[180:183], v[28:31], v[104:107], v[180:183]
    v_readfirstlane_b32 s86, v0
    v_mfma_f32_16x16x32_bf16 v[184:187], v[32:35], v[88:91], v[184:187]
    v_mfma_f32_16x16x32_bf16 v[188:191], v[32:35], v[96:99], v[188:191]
    v_mfma_f32_16x16x32_bf16 v[192:195], v[32:35], v[104:107], v[192:195]
    s_waitcnt lgkmcnt(0)
    s_barrier
    v_mfma_f32_16x16x32_bf16 v[196:199], v[36:39], v[88:91], v[196:199]
    s_add_u32 s85, s85, 1
    s_cmp_ge_u32 s86, s85
    s_cbranch_scc0 .Lck_38_s
.Lck_38:
    v_add_u32 v20, 0x8000, v20
    v_and_b32 v20, 0x1ffff, v20
    ds_read_b128 v[24:27], v20 offset:0
    v_mfma_f32_16x16x32_bf16 v[200:203], v[36:39], v[96:99], v[200:203]
    ds_read_b128 v[28:31], v20 offset:4096
    v_add_u32 v21, 0x8000, v21
    v_and_b32 v21, 0x1ffff, v21
    ds_read_b128 v[32:35], v21 offset:0
    v_mfma_f32_16x16x32_bf16 v[204:207], v[36:39], v[104:107], v[204:207]
    ds_read_b128 v[36:39], v21 offset:4096
    v_mfma_f32_16x16x32_bf16 v[208:211], v[40:43], v[88:91], v[208:211]
    v_mfma_f32_16x16x32_bf16 v[212:215], v[40:43], v[96:99], v[212:215]
    v_mfma_f32_16x16x32_bf16 v[216:219], v[40:43], v[104:107], v[216:219]
    v_add_u32 v22, 0x8000, v22
    v_and_b32 v22, 0x1ffff, v22
    ds_read_b128 v[40:43], v22 offset:0
    v_mfma_f32_16x16x32_bf16 v[220:223], v[44:47], v[88:91], v[220:223]
    v_mfma_f32_16x16x32_bf16 v[224:227], v[44:47], v[96:99], v[224:227]
    v_mfma_f32_16x16x32_bf16 v[228:231], v[44:47], v[104:107], v[228:231]
    ds_read_b128 v[44:47], v22 offset:4096
    v_mfma_f32_16x16x32_bf16 v[232:235], v[48:51], v[88:91], v[232:235]
    v_mfma_f32_16x16x32_bf16 v[236:239], v[48:51], v[96:99], v[236:239]
    v_mfma_f32_16x16x32_bf16 v[240:243], v[48:51], v[104:107], v[240:243]
    v_add_u32 v23, 0x8000, v23
    v_and_b32 v23, 0x1ffff, v23
    ds_read_b128 v[48:51], v23 offset:0
    v_mfma_f32_16x16x32_bf16 v[244:247], v[52:55], v[88:91], v[244:247]
    v_mfma_f32_16x16x32_bf16 v[248:251], v[52:55], v[96:99], v[248:251]
    v_mfma_f32_16x16x32_bf16 v[252:255], v[52:55], v[104:107], v[252:255]
    ds_read_b128 v[52:55], v23 offset:4096
    s_add_u32 s9, s9, 1
    s_cmp_lt_u32 s9, 7
    s_cbranch_scc1 .Lchunk_a
    s_waitcnt lgkmcnt(2)
    v_mfma_f32_16x16x32_bf16 v[64:67], v[24:27], v[112:115], 0
    ds_read_b32 v0, v1
    v_mfma_f32_16x16x32_bf16 v[72:75], v[24:27], v[128:131], 0
    v_mfma_f32_16x16x32_bf16 v[80:83], v[24:27], v[144:147], 0
    v_mfma_f32_16x16x32_bf16 v[68:71], v[28:31], v[112:115], 0
    v_mfma_f32_16x16x32_bf16 v[76:79], v[28:31], v[128:131], 0
    v_mfma_f32_16x16x32_bf16 v[84:87], v[28:31], v[144:147], 0
    v_mfma_f32_16x16x32_bf16 v[64:67], v[32:35], v[116:119], v[64:67]
    v_mfma_f32_16x16x32_bf16 v[72:75], v[32:35], v[132:135], v[72:75]
    v_mfma_f32_16x16x32_bf16 v[80:83], v[32:35], v[148:151], v[80:83]
    s_waitcnt lgkmcnt(0)
    v_min_u32_dpp v0, v0, v0 quad_perm:[1,0,3,2] row_mask:0xf bank_mask:0xf
    v_mfma_f32_16x16x32_bf16 v[68:71], v[36:39], v[116:119], v[68:71]
    v_mfma_f32_16x16x32_bf16 v[76:79], v[36:39], v[132:135], v[76:79]
    v_min_u32_dpp v0, v0, v0 quad_perm:[2,3,0,1] row_mask:0xf bank_mask:0xf
    v_mfma_f32_16x16x32_bf16 v[84:87], v[36:39], v[148:151], v[84:87]
    v_readfirstlane_b32 s86, v0
    v_mfma_f32_16x16x32_bf16 v[64:67], v[40:43], v[120:123], v[64:67]
    s_add_u32 s85, s85, 1
    s_nop 1
    s_cmp_ge_u32 s86, s85
    s_cbranch_scc0 .Lck_40_s
.Lck_40:
    ds_read_b128 v[24:27], v20 offset:8192
    v_mfma_f32_16x16x32_bf16 v[72:75], v[40:43], v[136:139], v[72:75]
    ds_read_b128 v[28:31], v20 offset:12288
    ds_read_b128 v[32:35], v21 offset:8192
    v_mfma_f32_16x16x32_bf16 v[80:83], v[40:43], v[152:155], v[80:83]
    ds_read_b128 v[36:39], v21 offset:12288
    ds_read_b32 v0, v1
    v_mfma_f32_16x16x32_bf16 v[68:71], v[44:47], v[120:123], v[68:71]
    ds_read_b128 v[40:43], v22 offset:8192
    v_mfma_f32_16x16x32_bf16 v[76:79], v[44:47], v[136:139], v[76:79]
    v_mfma_f32_16x16x32_bf16 v[84:87], v[44:47], v[152:155], v[84:87]
    ds_read_b128 v[44:47], v22 offset:12288
    v_mfma_f32_16x16x32_bf16 v[64:67], v[48:51], v[124:127], v[64:67]
    v_mfma_f32_16x16x32_bf16 v[72:75], v[48:51], v[140:143], v[72:75]
    v_mfma_f32_16x16x32_bf16 v[80:83], v[48:51], v[156:159], v[80:83]
    ds_read_b128 v[48:51], v23 offset:8192
    v_mfma_f32_16x16x32_bf16 v[68:71], v[52:55], v[124:127], v[68:71]
    v_mfma_f32_16x16x32_bf16 v[76:79], v[52:55], v[140:143], v[76:79]
    s_waitcnt lgkmcnt(3)
    v_min_u32_dpp v0, v0, v0 quad_perm:[1,0,3,2] row_mask:0xf bank_mask:0xf
    v_mfma_f32_16x16x32_bf16 v[84:87], v[52:55], v[156:159], v[84:87]
    ds_read_b128 v[52:55], v23 offset:12288
    v_mfma_f32_16x16x32_bf16 v[88:91], v[24:27], v[112:115], 0
    v_min_u32_dpp v0, v0, v0 quad_perm:[2,3,0,1] row_mask:0xf bank_mask:0xf
    v_max_f32 v7, v64, v65
    v_mfma_f32_16x16x32_bf16 v[96:99], v[24:27], v[128:131], 0
    v_readfirstlane_b32 s86, v0
    v_max_f32 v8, v72, v73
    v_mfma_f32_16x16x32_bf16 v[104:107], v[24:27], v[144:147], 0
    v_max_f32 v9, v80, v81
    v_mfma_f32_16x16x32_bf16 v[92:95], v[28:31], v[112:115], 0
    v_mfma_f32_16x16x32_bf16 v[100:103], v[28:31], v[128:131], 0
    v_max3_f32 v7, v7, v66, v67
    v_mfma_f32_16x16x32_bf16 v[108:111], v[28:31], v[144:147], 0
    v_mfma_f32_16x16x32_bf16 v[88:91], v[32:35], v[116:119], v[88:91]
    v_max3_f32 v8, v8, v74, v75
    v_mfma_f32_16x16x32_bf16 v[96:99], v[32:35], v[132:135], v[96:99]
    s_waitcnt lgkmcnt(0)
    v_mfma_f32_16x16x32_bf16 v[104:107], v[32:35], v[148:151], v[104:107]
    s_add_u32 s85, s85, 1
    s_cmp_ge_u32 s86, s85
    s_cbranch_scc0 .Lck_41_s
.Lck_41:
    v_add_u32 v56, 0x8000, v56
    v_and_b32 v56, 0x1ffff, v56
    ds_read_b64_tr_b16 v[24:25], v56 offset:0
    v_mfma_f32_16x16x32_bf16 v[92:95], v[36:39], v[116:119], v[92:95]
    ds_read_b64_tr_b16 v[26:27], v56 offset:4096
    v_max3_f32 v9, v9, v82, v83
    v_mfma_f32_16x16x32_bf16 v[100:103], v[36:39], v[132:135], v[100:103]
    v_add_u32 v57, 0x8000, v57
    v_and_b32 v57, 0x1ffff, v57
    ds_read_b64_tr_b16 v[28:29], v57 offset:0
    v_mfma_f32_16x16x32_bf16 v[108:111], v[36:39], v[148:151], v[108:111]
    ds_read_b64_tr_b16 v[30:31], v57 offset:4096
    v_max3_f32 v7, v7, v68, v69
    v_mfma_f32_16x16x32_bf16 v[88:91], v[40:43], v[120:123], v[88:91]
    v_add_u32 v58, 0x8000, v58
    v_and_b32 v58, 0x1ffff, v58
    ds_read_b64_tr_b16 v[32:33], v58 offset:0
    v_mfma_f32_16x16x32_bf16 v[96:99], v[40:43], v[136:139], v[96:99]
    ds_read_b64_tr_b16 v[34:35], v58 offset:4096
    v_max3_f32 v8, v8, v76, v77
    v_mfma_f32_16x16x32_bf16 v[104:107], v[40:43], v[152:155], v[104:107]
    v_add_u32 v59, 0x8000, v59
    v_and_b32 v59, 0x1ffff, v59
    ds_read_b64_tr_b16 v[36:37], v59 offset:0
    v_mfma_f32_16x16x32_bf16 v[92:95], v[44:47], v[120:123], v[92:95]
    ds_read_b64_tr_b16 v[38:39], v59 offset:4096
    v_max3_f32 v9, v9, v84, v85
    v_mfma_f32_16x16x32_bf16 v[100:103], v[44:47], v[136:139], v[100:103]
    v_add_u32 v60, 0x8000, v60
    v_and_b32 v60, 0x1ffff, v60
    ds_read_b64_tr_b16 v[40:41], v60 offset:0
    v_mfma_f32_16x16x32_bf16 v[108:111], v[44:47], v[152:155], v[108:111]
    ds_read_b64_tr_b16 v[42:43], v60 offset:4096
    v_max3_f32 v7, v7, v70, v71
    v_mfma_f32_16x16x32_bf16 v[88:91], v[48:51], v[124:127], v[88:91]
    v_add_u32 v61, 0x8000, v61
    v_and_b32 v61, 0x1ffff, v61
    ds_read_b64_tr_b16 v[44:45], v61 offset:0
    v_mfma_f32_16x16x32_bf16 v[96:99], v[48:51], v[140:143], v[96:99]
    ds_read_b64_tr_b16 v[46:47], v61 offset:4096
    v_max3_f32 v8, v8, v78, v79
    v_mfma_f32_16x16x32_bf16 v[104:107], v[48:51], v[156:159], v[104:107]
    ds_read_b32 v0, v1
    v_max3_f32 v9, v9, v86, v87
    v_mfma_f32_16x16x32_bf16 v[92:95], v[52:55], v[124:127], v[92:95]
    v_add_u32 v62, 0x8000, v62
    v_and_b32 v62, 0x1ffff, v62
    ds_read_b64_tr_b16 v[48:49], v62 offset:0
    v_mfma_f32_16x16x32_bf16 v[100:103], v[52:55], v[140:143], v[100:103]
    ds_read_b64_tr_b16 v[50:51], v62 offset:4096
    v_mfma_f32_16x16x32_bf16 v[108:111], v[52:55], v[156:159], v[108:111]
    v_max3_f32 v7, v7, v88, v89
    v_max3_f32 v8, v8, v96, v97
    v_max3_f32 v9, v9, v104, v105
    v_max3_f32 v7, v7, v90, v91
    v_max3_f32 v8, v8, v98, v99
    v_max3_f32 v9, v9, v106, v107
    v_max3_f32 v7, v7, v92, v93
    v_max3_f32 v8, v8, v100, v101
    v_max3_f32 v9, v9, v108, v109
    v_max3_f32 v7, v7, v94, v95
    v_max3_f32 v8, v8, v102, v103
    v_max3_f32 v9, v9, v110, v111
    v_fma_f32 v10, v7, s36, -v3
    v_fma_f32 v12, v8, s36, -v4
    v_fma_f32 v13, v9, s36, -v6
    v_max3_f32 v10, v10, v12, v13
    v_cmp_nge_f32 vcc, 0x41000000, v10
    s_nop 4
    s_cbranch_vccnz .Lrs_39_s
.Lrs_39:
    v_pk_fma_f32 v[64:65], v[64:65], s[36:37], v[2:3] op_sel:[0,0,1] op_sel_hi:[1,1,1] neg_lo:[0,0,1] neg_hi:[0,0,1]
    v_pk_fma_f32 v[66:67], v[66:67], s[36:37], v[2:3] op_sel:[0,0,1] op_sel_hi:[1,1,1] neg_lo:[0,0,1] neg_hi:[0,0,1]
    s_waitcnt lgkmcnt(2)
    v_min_u32_dpp v0, v0, v0 quad_perm:[1,0,3,2] row_mask:0xf bank_mask:0xf
    v_pk_fma_f32 v[68:69], v[68:69], s[36:37], v[2:3] op_sel:[0,0,1] op_sel_hi:[1,1,1] neg_lo:[0,0,1] neg_hi:[0,0,1]
    v_pk_fma_f32 v[70:71], v[70:71], s[36:37], v[2:3] op_sel:[0,0,1] op_sel_hi:[1,1,1] neg_lo:[0,0,1] neg_hi:[0,0,1]
    v_min_u32_dpp v0, v0, v0 quad_perm:[2,3,0,1] row_mask:0xf bank_mask:0xf
    v_pk_fma_f32 v[72:73], v[72:73], s[36:37], v[4:5] op_sel:[0,0,0] op_sel_hi:[1,1,0] neg_lo:[0,0,1] neg_hi:[0,0,1]
    v_readfirstlane_b32 s86, v0
    v_pk_fma_f32 v[74:75], v[74:75], s[36:37], v[4:5] op_sel:[0,0,0] op_sel_hi:[1,1,0] neg_lo:[0,0,1] neg_hi:[0,0,1]
    v_add_u32 v63, 0x8000, v63
    v_and_b32 v63, 0x1ffff, v63
    ds_read_b64_tr_b16 v[52:53], v63 offset:0
    v_pk_fma_f32 v[76:77], v[76:77], s[36:37], v[4:5] op_sel:[0,0,0] op_sel_hi:[1,1,0] neg_lo:[0,0,1] neg_hi:[0,0,1]
    v_pk_fma_f32 v[78:79], v[78:79], s[36:37], v[4:5] op_sel:[0,0,0] op_sel_hi:[1,1,0] neg_lo:[0,0,1] neg_hi:[0,0,1]
    ds_read_b64_tr_b16 v[54:55], v63 offset:4096
    v_exp_f32 v64, v64
    v_exp_f32 v65, v65
    v_exp_f32 v66, v66
    v_exp_f32 v67, v67
    v_exp_f32 v68, v68
    v_exp_f32 v69, v69
    v_exp_f32 v70, v70
    v_exp_f32 v71, v71
    v_pk_add_f32 v[14:15], v[14:15], v[64:65]
    v_pk_add_f32 v[14:15], v[14:15], v[66:67]
    v_pk_add_f32 v[14:15], v[14:15], v[68:69]
    v_pk_add_f32 v[14:15], v[14:15], v[70:71]
    v_cvt_pk_bf16_f32 v64, v64, v65
    v_cvt_pk_bf16_f32 v65, v66, v67
    v_cvt_pk_bf16_f32 v66, v68, v69
    v_cvt_pk_bf16_f32 v67, v70, v71
    v_pk_fma_f32 v[80:81], v[80:81], s[36:37], v[6:7] op_sel:[0,0,0] op_sel_hi:[1,1,0] neg_lo:[0,0,1] neg_hi:[0,0,1]
    v_pk_fma_f32 v[82:83], v[82:83], s[36:37], v[6:7] op_sel:[0,0,0] op_sel_hi:[1,1,0] neg_lo:[0,0,1] neg_hi:[0,0,1]
    v_pk_fma_f32 v[84:85], v[84:85], s[36:37], v[6:7] op_sel:[0,0,0] op_sel_hi:[1,1,0] neg_lo:[0,0,1] neg_hi:[0,0,1]
    v_pk_fma_f32 v[86:87], v[86:87], s[36:37], v[6:7] op_sel:[0,0,0] op_sel_hi:[1,1,0] neg_lo:[0,0,1] neg_hi:[0,0,1]
    v_exp_f32 v72, v72
    v_exp_f32 v73, v73
    s_waitcnt lgkmcnt(0)
    v_exp_f32 v74, v74
    v_exp_f32 v75, v75
    v_exp_f32 v76, v76
    v_exp_f32 v77, v77
    v_exp_f32 v78, v78
    v_exp_f32 v79, v79
    v_pk_add_f32 v[16:17], v[16:17], v[72:73]
    v_pk_add_f32 v[16:17], v[16:17], v[74:75]
    v_pk_add_f32 v[16:17], v[16:17], v[76:77]
    v_pk_add_f32 v[16:17], v[16:17], v[78:79]
    v_cvt_pk_bf16_f32 v72, v72, v73
    v_cvt_pk_bf16_f32 v73, v74, v75
    v_cvt_pk_bf16_f32 v74, v76, v77
    v_cvt_pk_bf16_f32 v75, v78, v79
    v_pk_fma_f32 v[88:89], v[88:89], s[36:37], v[2:3] op_sel:[0,0,1] op_sel_hi:[1,1,1] neg_lo:[0,0,1] neg_hi:[0,0,1]
    v_pk_fma_f32 v[90:91], v[90:91], s[36:37], v[2:3] op_sel:[0,0,1] op_sel_hi:[1,1,1] neg_lo:[0,0,1] neg_hi:[0,0,1]
    v_pk_fma_f32 v[92:93], v[92:93], s[36:37], v[2:3] op_sel:[0,0,1] op_sel_hi:[1,1,1] neg_lo:[0,0,1] neg_hi:[0,0,1]
    v_pk_fma_f32 v[94:95], v[94:95], s[36:37], v[2:3] op_sel:[0,0,1] op_sel_hi:[1,1,1] neg_lo:[0,0,1] neg_hi:[0,0,1]
    v_exp_f32 v80, v80
    v_exp_f32 v81, v81
    v_exp_f32 v82, v82
    v_exp_f32 v83, v83
    v_exp_f32 v84, v84
    v_exp_f32 v85, v85
    v_exp_f32 v86, v86
    v_exp_f32 v87, v87
    v_pk_add_f32 v[18:19], v[18:19], v[80:81]
    v_pk_add_f32 v[18:19], v[18:19], v[82:83]
    v_pk_add_f32 v[18:19], v[18:19], v[84:85]
    v_pk_add_f32 v[18:19], v[18:19], v[86:87]
    v_cvt_pk_bf16_f32 v80, v80, v81
    v_cvt_pk_bf16_f32 v81, v82, v83
    v_cvt_pk_bf16_f32 v82, v84, v85
    v_cvt_pk_bf16_f32 v83, v86, v87
    v_pk_fma_f32 v[96:97], v[96:97], s[36:37], v[4:5] op_sel:[0,0,0] op_sel_hi:[1,1,0] neg_lo:[0,0,1] neg_hi:[0,0,1]
    v_pk_fma_f32 v[98:99], v[98:99], s[36:37], v[4:5] op_sel:[0,0,0] op_sel_hi:[1,1,0] neg_lo:[0,0,1] neg_hi:[0,0,1]
    v_pk_fma_f32 v[100:101], v[100:101], s[36:37], v[4:5] op_sel:[0,0,0] op_sel_hi:[1,1,0] neg_lo:[0,0,1] neg_hi:[0,0,1]
    v_pk_fma_f32 v[102:103], v[102:103], s[36:37], v[4:5] op_sel:[0,0,0] op_sel_hi:[1,1,0] neg_lo:[0,0,1] neg_hi:[0,0,1]
    v_exp_f32 v88, v88
    v_exp_f32 v89, v89
    v_exp_f32 v90, v90
    v_exp_f32 v91, v91
    v_exp_f32 v92, v92
    v_exp_f32 v93, v93
    v_exp_f32 v94, v94
    v_exp_f32 v95, v95
    v_pk_add_f32 v[14:15], v[14:15], v[88:89]
    v_pk_add_f32 v[14:15], v[14:15], v[90:91]
    v_pk_add_f32 v[14:15], v[14:15], v[92:93]
    v_pk_add_f32 v[14:15], v[14:15], v[94:95]
    v_cvt_pk_bf16_f32 v88, v88, v89
    v_cvt_pk_bf16_f32 v89, v90, v91
    v_cvt_pk_bf16_f32 v90, v92, v93
    v_cvt_pk_bf16_f32 v91, v94, v95
    v_pk_fma_f32 v[104:105], v[104:105], s[36:37], v[6:7] op_sel:[0,0,0] op_sel_hi:[1,1,0] neg_lo:[0,0,1] neg_hi:[0,0,1]
    v_pk_fma_f32 v[106:107], v[106:107], s[36:37], v[6:7] op_sel:[0,0,0] op_sel_hi:[1,1,0] neg_lo:[0,0,1] neg_hi:[0,0,1]
    v_pk_fma_f32 v[108:109], v[108:109], s[36:37], v[6:7] op_sel:[0,0,0] op_sel_hi:[1,1,0] neg_lo:[0,0,1] neg_hi:[0,0,1]
    v_pk_fma_f32 v[110:111], v[110:111], s[36:37], v[6:7] op_sel:[0,0,0] op_sel_hi:[1,1,0] neg_lo:[0,0,1] neg_hi:[0,0,1]
    v_exp_f32 v96, v96
    v_exp_f32 v97, v97
    v_exp_f32 v98, v98
    v_exp_f32 v99, v99
    v_exp_f32 v100, v100
    v_exp_f32 v101, v101
    v_exp_f32 v102, v102
    v_exp_f32 v103, v103
    v_pk_add_f32 v[16:17], v[16:17], v[96:97]
    v_pk_add_f32 v[16:17], v[16:17], v[98:99]
    v_pk_add_f32 v[16:17], v[16:17], v[100:101]
    v_pk_add_f32 v[16:17], v[16:17], v[102:103]
    v_cvt_pk_bf16_f32 v96, v96, v97
    v_cvt_pk_bf16_f32 v97, v98, v99
    v_cvt_pk_bf16_f32 v98, v100, v101
    v_cvt_pk_bf16_f32 v99, v102, v103
    v_exp_f32 v104, v104
    v_exp_f32 v105, v105
    v_exp_f32 v106, v106
    v_exp_f32 v107, v107
    v_exp_f32 v108, v108
    v_exp_f32 v109, v109
    v_exp_f32 v110, v110
    v_exp_f32 v111, v111
    v_pk_add_f32 v[18:19], v[18:19], v[104:105]
    v_pk_add_f32 v[18:19], v[18:19], v[106:107]
    v_pk_add_f32 v[18:19], v[18:19], v[108:109]
    v_pk_add_f32 v[18:19], v[18:19], v[110:111]
    v_cvt_pk_bf16_f32 v104, v104, v105
    v_cvt_pk_bf16_f32 v105, v106, v107
    v_cvt_pk_bf16_f32 v106, v108, v109
    v_cvt_pk_bf16_f32 v107, v110, v111
    v_mfma_f32_16x16x32_bf16 v[160:163], v[24:27], v[64:67], v[160:163]
    v_mfma_f32_16x16x32_bf16 v[164:167], v[24:27], v[72:75], v[164:167]
    v_mfma_f32_16x16x32_bf16 v[168:171], v[24:27], v[80:83], v[168:171]
    s_add_u32 s85, s85, 1
    s_cmp_ge_u32 s86, s85
    s_cbranch_scc0 .Lck_42_s
.Lck_42:
    ds_read_b64_tr_b16 v[24:25], v56 offset:8192
    v_mfma_f32_16x16x32_bf16 v[172:175], v[28:31], v[64:67], v[172:175]
    ds_read_b64_tr_b16 v[26:27], v56 offset:12288
    v_mfma_f32_16x16x32_bf16 v[176:179], v[28:31], v[72:75], v[176:179]
    v_mfma_f32_16x16x32_bf16 v[180:183], v[28:31], v[80:83], v[180:183]
    ds_read_b64_tr_b16 v[28:29], v57 offset:8192
    ds_read_b64_tr_b16 v[30:31], v57 offset:12288
    v_mfma_f32_16x16x32_bf16 v[184:187], v[32:35], v[64:67], v[184:187]
    v_mfma_f32_16x16x32_bf16 v[188:191], v[32:35], v[72:75], v[188:191]
    v_mfma_f32_16x16x32_bf16 v[192:195], v[32:35], v[80:83], v[192:195]
    ds_read_b64_tr_b16 v[32:33], v58 offset:8192
    ds_read_b64_tr_b16 v[34:35], v58 offset:12288
    v_mfma_f32_16x16x32_bf16 v[196:199], v[36:39], v[64:67], v[196:199]
    v_mfma_f32_16x16x32_bf16 v[200:203], v[36:39], v[72:75], v[200:203]
    v_mfma_f32_16x16x32_bf16 v[204:207], v[36:39], v[80:83], v[204:207]
    ds_read_b64_tr_b16 v[36:37], v59 offset:8192
    ds_read_b64_tr_b16 v[38:39], v59 offset:12288
    v_mfma_f32_16x16x32_bf16 v[208:211], v[40:43], v[64:67], v[208:211]
    v_mfma_f32_16x16x32_bf16 v[212:215], v[40:43], v[72:75], v[212:215]
    v_mfma_f32_16x16x32_bf16 v[216:219], v[40:43], v[80:83], v[216:219]
    ds_read_b64_tr_b16 v[40:41], v60 offset:8192
    ds_read_b64_tr_b16 v[42:43], v60 offset:12288
    v_mfma_f32_16x16x32_bf16 v[220:223], v[44:47], v[64:67], v[220:223]
    v_mfma_f32_16x16x32_bf16 v[224:227], v[44:47], v[72:75], v[224:227]
    v_mfma_f32_16x16x32_bf16 v[228:231], v[44:47], v[80:83], v[228:231]
    ds_read_b64_tr_b16 v[44:45], v61 offset:8192
    ds_read_b64_tr_b16 v[46:47], v61 offset:12288
    v_mfma_f32_16x16x32_bf16 v[232:235], v[48:51], v[64:67], v[232:235]
    v_mfma_f32_16x16x32_bf16 v[236:239], v[48:51], v[72:75], v[236:239]
    v_mfma_f32_16x16x32_bf16 v[240:243], v[48:51], v[80:83], v[240:243]
    ds_read_b64_tr_b16 v[48:49], v62 offset:8192
    ds_read_b64_tr_b16 v[50:51], v62 offset:12288
    v_mfma_f32_16x16x32_bf16 v[244:247], v[52:55], v[64:67], v[244:247]
    v_mfma_f32_16x16x32_bf16 v[248:251], v[52:55], v[72:75], v[248:251]
    v_mfma_f32_16x16x32_bf16 v[252:255], v[52:55], v[80:83], v[252:255]
    ds_read_b64_tr_b16 v[52:53], v63 offset:8192
    s_waitcnt lgkmcnt(5)
    v_mfma_f32_16x16x32_bf16 v[160:163], v[24:27], v[88:91], v[160:163]
    ds_read_b64_tr_b16 v[54:55], v63 offset:12288
    v_mfma_f32_16x16x32_bf16 v[164:167], v[24:27], v[96:99], v[164:167]
    v_mfma_f32_16x16x32_bf16 v[168:171], v[24:27], v[104:107], v[168:171]
    v_mfma_f32_16x16x32_bf16 v[172:175], v[28:31], v[88:91], v[172:175]
    v_mfma_f32_16x16x32_bf16 v[176:179], v[28:31], v[96:99], v[176:179]
    v_mfma_f32_16x16x32_bf16 v[180:183], v[28:31], v[104:107], v[180:183]
    v_mfma_f32_16x16x32_bf16 v[184:187], v[32:35], v[88:91], v[184:187]
    v_mfma_f32_16x16x32_bf16 v[188:191], v[32:35], v[96:99], v[188:191]
    v_mfma_f32_16x16x32_bf16 v[192:195], v[32:35], v[104:107], v[192:195]
    s_waitcnt lgkmcnt(0)
    s_barrier
    v_mfma_f32_16x16x32_bf16 v[196:199], v[36:39], v[88:91], v[196:199]
    v_mfma_f32_16x16x32_bf16 v[200:203], v[36:39], v[96:99], v[200:203]
    v_mfma_f32_16x16x32_bf16 v[204:207], v[36:39], v[104:107], v[204:207]
    v_mfma_f32_16x16x32_bf16 v[208:211], v[40:43], v[88:91], v[208:211]
    v_mfma_f32_16x16x32_bf16 v[212:215], v[40:43], v[96:99], v[212:215]
    v_mfma_f32_16x16x32_bf16 v[216:219], v[40:43], v[104:107], v[216:219]
    v_mfma_f32_16x16x32_bf16 v[220:223], v[44:47], v[88:91], v[220:223]
    v_mfma_f32_16x16x32_bf16 v[224:227], v[44:47], v[96:99], v[224:227]
    v_mfma_f32_16x16x32_bf16 v[228:231], v[44:47], v[104:107], v[228:231]
    v_mfma_f32_16x16x32_bf16 v[232:235], v[48:51], v[88:91], v[232:235]
    v_mfma_f32_16x16x32_bf16 v[236:239], v[48:51], v[96:99], v[236:239]
    v_mfma_f32_16x16x32_bf16 v[240:243], v[48:51], v[104:107], v[240:243]
    v_mfma_f32_16x16x32_bf16 v[244:247], v[52:55], v[88:91], v[244:247]
    v_mfma_f32_16x16x32_bf16 v[248:251], v[52:55], v[96:99], v[248:251]
    v_mfma_f32_16x16x32_bf16 v[252:255], v[52:55], v[104:107], v[252:255]
    v_add_f32 v14, v14, v15
    v_add_f32 v16, v16, v17
    v_add_f32 v18, v18, v19
    v_mov_b32 v10, v14
    v_mov_b32 v12, v16
    v_mov_b32 v13, v18
    v_permlane32_swap_b32 v10, v14
    v_permlane32_swap_b32 v12, v16
    v_permlane32_swap_b32 v13, v18
    v_add_f32 v14, v10, v14
    v_add_f32 v16, v12, v16
    v_add_f32 v18, v13, v18
    v_mov_b32 v10, v14
    v_mov_b32 v12, v16
    v_mov_b32 v13, v18
    v_permlane16_swap_b32 v10, v14
    v_permlane16_swap_b32 v12, v16
    v_permlane16_swap_b32 v13, v18
    v_add_f32 v14, v10, v14
    v_add_f32 v16, v12, v16
    v_add_f32 v18, v13, v18
    v_rcp_f32 v14, v14
    v_rcp_f32 v16, v16
    v_rcp_f32 v18, v18
    s_and_b32 s3, s4, 1
    s_lshl_b32 s3, s3, 14
    s_cmp_ge_u32 s4, 2
    s_cselect_b32 s11, 0, 32768
    s_add_u32 s3, s3, 98304
    s_add_u32 s3, s3, s11
    v_add_u32 v20, s3, v2
    v_add_u32 v8, 98304, v2
    v_pk_mul_f32 v[160:161], v[160:161], v[14:15] op_sel:[0,0] op_sel_hi:[1,0]
    v_pk_mul_f32 v[162:163], v[162:163], v[14:15] op_sel:[0,0] op_sel_hi:[1,0]
    v_pk_mul_f32 v[172:173], v[172:173], v[14:15] op_sel:[0,0] op_sel_hi:[1,0]
    v_pk_mul_f32 v[174:175], v[174:175], v[14:15] op_sel:[0,0] op_sel_hi:[1,0]
    v_cvt_pk_bf16_f32 v112, v160, v161
    v_cvt_pk_bf16_f32 v113, v162, v163
    v_cvt_pk_bf16_f32 v114, v172, v173
    v_cvt_pk_bf16_f32 v115, v174, v175
    ds_write_b128 v20, v[112:115] offset:0
    v_pk_mul_f32 v[164:165], v[164:165], v[16:17] op_sel:[0,0] op_sel_hi:[1,0]
    v_pk_mul_f32 v[166:167], v[166:167], v[16:17] op_sel:[0,0] op_sel_hi:[1,0]
    v_pk_mul_f32 v[176:177], v[176:177], v[16:17] op_sel:[0,0] op_sel_hi:[1,0]
    v_pk_mul_f32 v[178:179], v[178:179], v[16:17] op_sel:[0,0] op_sel_hi:[1,0]
    v_cvt_pk_bf16_f32 v128, v164, v165
    v_cvt_pk_bf16_f32 v129, v166, v167
    v_cvt_pk_bf16_f32 v130, v176, v177
    v_cvt_pk_bf16_f32 v131, v178, v179
    ds_write_b128 v20, v[128:131] offset:4096
    v_pk_mul_f32 v[168:169], v[168:169], v[18:19] op_sel:[0,0] op_sel_hi:[1,0]
    v_pk_mul_f32 v[170:171], v[170:171], v[18:19] op_sel:[0,0] op_sel_hi:[1,0]
    v_pk_mul_f32 v[180:181], v[180:181], v[18:19] op_sel:[0,0] op_sel_hi:[1,0]
    v_pk_mul_f32 v[182:183], v[182:183], v[18:19] op_sel:[0,0] op_sel_hi:[1,0]
    v_cvt_pk_bf16_f32 v144, v168, v169
    v_cvt_pk_bf16_f32 v145, v170, v171
    v_cvt_pk_bf16_f32 v146, v180, v181
    v_cvt_pk_bf16_f32 v147, v182, v183
    ds_write_b128 v20, v[144:147] offset:10240
    v_pk_mul_f32 v[184:185], v[184:185], v[14:15] op_sel:[0,0] op_sel_hi:[1,0]
    v_pk_mul_f32 v[186:187], v[186:187], v[14:15] op_sel:[0,0] op_sel_hi:[1,0]
    v_pk_mul_f32 v[196:197], v[196:197], v[14:15] op_sel:[0,0] op_sel_hi:[1,0]
    v_pk_mul_f32 v[198:199], v[198:199], v[14:15] op_sel:[0,0] op_sel_hi:[1,0]
    v_cvt_pk_bf16_f32 v116, v184, v185
    v_cvt_pk_bf16_f32 v117, v186, v187
    v_cvt_pk_bf16_f32 v118, v196, v197
    v_cvt_pk_bf16_f32 v119, v198, v199
    ds_write_b128 v20, v[116:119] offset:1024
    v_pk_mul_f32 v[188:189], v[188:189], v[16:17] op_sel:[0,0] op_sel_hi:[1,0]
    v_pk_mul_f32 v[190:191], v[190:191], v[16:17] op_sel:[0,0] op_sel_hi:[1,0]
    v_pk_mul_f32 v[200:201], v[200:201], v[16:17] op_sel:[0,0] op_sel_hi:[1,0]
    v_pk_mul_f32 v[202:203], v[202:203], v[16:17] op_sel:[0,0] op_sel_hi:[1,0]
    v_cvt_pk_bf16_f32 v132, v188, v189
    v_cvt_pk_bf16_f32 v133, v190, v191
    v_cvt_pk_bf16_f32 v134, v200, v201
    v_cvt_pk_bf16_f32 v135, v202, v203
    ds_write_b128 v20, v[132:135] offset:5120
    v_pk_mul_f32 v[192:193], v[192:193], v[18:19] op_sel:[0,0] op_sel_hi:[1,0]
    v_pk_mul_f32 v[194:195], v[194:195], v[18:19] op_sel:[0,0] op_sel_hi:[1,0]
    v_pk_mul_f32 v[204:205], v[204:205], v[18:19] op_sel:[0,0] op_sel_hi:[1,0]
    v_pk_mul_f32 v[206:207], v[206:207], v[18:19] op_sel:[0,0] op_sel_hi:[1,0]
    v_cvt_pk_bf16_f32 v148, v192, v193
    v_cvt_pk_bf16_f32 v149, v194, v195
    v_cvt_pk_bf16_f32 v150, v204, v205
    v_cvt_pk_bf16_f32 v151, v206, v207
    ds_write_b128 v20, v[148:151] offset:11264
    v_pk_mul_f32 v[208:209], v[208:209], v[14:15] op_sel:[0,0] op_sel_hi:[1,0]
    v_pk_mul_f32 v[210:211], v[210:211], v[14:15] op_sel:[0,0] op_sel_hi:[1,0]
    v_pk_mul_f32 v[220:221], v[220:221], v[14:15] op_sel:[0,0] op_sel_hi:[1,0]
    v_pk_mul_f32 v[222:223], v[222:223], v[14:15] op_sel:[0,0] op_sel_hi:[1,0]
    v_cvt_pk_bf16_f32 v120, v208, v209
    v_cvt_pk_bf16_f32 v121, v210, v211
    v_cvt_pk_bf16_f32 v122, v220, v221
    v_cvt_pk_bf16_f32 v123, v222, v223
    ds_write_b128 v20, v[120:123] offset:2048
    v_pk_mul_f32 v[212:213], v[212:213], v[16:17] op_sel:[0,0] op_sel_hi:[1,0]
    v_pk_mul_f32 v[214:215], v[214:215], v[16:17] op_sel:[0,0] op_sel_hi:[1,0]
    v_pk_mul_f32 v[224:225], v[224:225], v[16:17] op_sel:[0,0] op_sel_hi:[1,0]
    v_pk_mul_f32 v[226:227], v[226:227], v[16:17] op_sel:[0,0] op_sel_hi:[1,0]
    v_cvt_pk_bf16_f32 v136, v212, v213
    v_cvt_pk_bf16_f32 v137, v214, v215
    v_cvt_pk_bf16_f32 v138, v224, v225
    v_cvt_pk_bf16_f32 v139, v226, v227
    ds_write_b128 v20, v[136:139] offset:8192
    v_pk_mul_f32 v[216:217], v[216:217], v[18:19] op_sel:[0,0] op_sel_hi:[1,0]
    v_pk_mul_f32 v[218:219], v[218:219], v[18:19] op_sel:[0,0] op_sel_hi:[1,0]
    v_pk_mul_f32 v[228:229], v[228:229], v[18:19] op_sel:[0,0] op_sel_hi:[1,0]
    v_pk_mul_f32 v[230:231], v[230:231], v[18:19] op_sel:[0,0] op_sel_hi:[1,0]
    v_cvt_pk_bf16_f32 v152, v216, v217
    v_cvt_pk_bf16_f32 v153, v218, v219
    v_cvt_pk_bf16_f32 v154, v228, v229
    v_cvt_pk_bf16_f32 v155, v230, v231
    ds_write_b128 v20, v[152:155] offset:12288
    v_pk_mul_f32 v[232:233], v[232:233], v[14:15] op_sel:[0,0] op_sel_hi:[1,0]
    v_pk_mul_f32 v[234:235], v[234:235], v[14:15] op_sel:[0,0] op_sel_hi:[1,0]
    v_pk_mul_f32 v[244:245], v[244:245], v[14:15] op_sel:[0,0] op_sel_hi:[1,0]
    v_pk_mul_f32 v[246:247], v[246:247], v[14:15] op_sel:[0,0] op_sel_hi:[1,0]
    v_cvt_pk_bf16_f32 v124, v232, v233
    v_cvt_pk_bf16_f32 v125, v234, v235
    v_cvt_pk_bf16_f32 v126, v244, v245
    v_cvt_pk_bf16_f32 v127, v246, v247
    ds_write_b128 v20, v[124:127] offset:3072
    v_pk_mul_f32 v[236:237], v[236:237], v[16:17] op_sel:[0,0] op_sel_hi:[1,0]
    v_pk_mul_f32 v[238:239], v[238:239], v[16:17] op_sel:[0,0] op_sel_hi:[1,0]
    v_pk_mul_f32 v[248:249], v[248:249], v[16:17] op_sel:[0,0] op_sel_hi:[1,0]
    v_pk_mul_f32 v[250:251], v[250:251], v[16:17] op_sel:[0,0] op_sel_hi:[1,0]
    v_cvt_pk_bf16_f32 v140, v236, v237
    v_cvt_pk_bf16_f32 v141, v238, v239
    v_cvt_pk_bf16_f32 v142, v248, v249
    v_cvt_pk_bf16_f32 v143, v250, v251
    ds_write_b128 v20, v[140:143] offset:9216
    v_pk_mul_f32 v[240:241], v[240:241], v[18:19] op_sel:[0,0] op_sel_hi:[1,0]
    v_pk_mul_f32 v[242:243], v[242:243], v[18:19] op_sel:[0,0] op_sel_hi:[1,0]
    v_pk_mul_f32 v[252:253], v[252:253], v[18:19] op_sel:[0,0] op_sel_hi:[1,0]
    v_pk_mul_f32 v[254:255], v[254:255], v[18:19] op_sel:[0,0] op_sel_hi:[1,0]
    v_cvt_pk_bf16_f32 v156, v240, v241
    v_cvt_pk_bf16_f32 v157, v242, v243
    v_cvt_pk_bf16_f32 v158, v252, v253
    v_cvt_pk_bf16_f32 v159, v254, v255
    ds_write_b128 v20, v[156:159] offset:13312
    v_mov_b32 v24, v5
    v_xor_b32 v25, 32, v5
    v_xor_b32 v26, 64, v5
    v_xor_b32 v27, 96, v5
    v_xor_b32 v28, 128, v5
    v_xor_b32 v29, 160, v5
    v_xor_b32 v30, 192, v5
    v_xor_b32 v31, 224, v5
    v_xor_b32 v32, 0x10000, v24
    v_xor_b32 v33, 0x10000, v25
    v_xor_b32 v34, 0x10000, v26
    v_xor_b32 v35, 0x10000, v27
    v_xor_b32 v36, 0x10000, v28
    v_xor_b32 v37, 0x10000, v29
    v_xor_b32 v38, 0x10000, v30
    v_xor_b32 v39, 0x10000, v31
    s_and_b32 s74, s6, s7
    s_lshl_b32 s11, s5, s7
    s_add_u32 s11, s11, s74
    s_lshl_b32 s3, s6, 3
    s_add_u32 s3, s3, s11
    s_mul_i32 s3, s3, 49152
    s_mul_i32 s11, s4, 12288
    s_add_u32 s16, s3, s11
    s_add_u32 s17, s16, 4096
    s_add_u32 s18, s16, 8192
    s_waitcnt lgkmcnt(0)
    s_barrier
    s_add_u32 s85, s85, 1
    s_cmp_ge_u32 s86, s85
    s_cbranch_scc0 .Lck_43_s
.Lck_43:
    ds_read_b128 v[112:115], v8 offset:32768
    ds_read_b64_tr_b16 v[64:65], v24 offset:0
    ds_read_b64_tr_b16 v[66:67], v24 offset:16384
    ds_read_b64_tr_b16 v[68:69], v25 offset:0
    ds_read_b64_tr_b16 v[70:71], v25 offset:16384
    ds_read_b128 v[116:119], v8 offset:36864
    ds_read_b128 v[120:123], v8 offset:43008
    ds_read_b64_tr_b16 v[72:73], v26 offset:0
    ds_read_b64_tr_b16 v[74:75], v26 offset:16384
    ds_read_b64_tr_b16 v[76:77], v27 offset:0
    ds_read_b64_tr_b16 v[78:79], v27 offset:16384
    ds_read_b64_tr_b16 v[80:81], v28 offset:0
    ds_read_b64_tr_b16 v[82:83], v28 offset:16384
    ds_read_b64_tr_b16 v[84:85], v29 offset:0
    ds_read_b64_tr_b16 v[86:87], v29 offset:16384
    s_waitcnt lgkmcnt(12)
    v_mfma_f32_16x16x32_bf16 v[160:163], v[64:67], v[112:115], 0
    ds_read_b32 v0, v1
    s_waitcnt lgkmcnt(11)
    v_mfma_f32_16x16x32_bf16 v[172:175], v[68:71], v[112:115], 0
    ds_read_b64_tr_b16 v[88:89], v30 offset:0
    s_waitcnt lgkmcnt(11)
    v_mfma_f32_16x16x32_bf16 v[164:167], v[64:67], v[116:119], 0
    ds_read_b64_tr_b16 v[90:91], v30 offset:16384
    ds_read_b64_tr_b16 v[92:93], v31 offset:0
    v_mfma_f32_16x16x32_bf16 v[176:179], v[68:71], v[116:119], 0
    ds_read_b64_tr_b16 v[94:95], v31 offset:16384
    s_waitcnt lgkmcnt(13)
    v_mfma_f32_16x16x32_bf16 v[168:171], v[64:67], v[120:123], 0
    v_mfma_f32_16x16x32_bf16 v[180:183], v[68:71], v[120:123], 0
    s_waitcnt lgkmcnt(11)
    v_mfma_f32_16x16x32_bf16 v[184:187], v[72:75], v[112:115], 0
    v_mfma_f32_16x16x32_bf16 v[188:191], v[72:75], v[116:119], 0
    v_mfma_f32_16x16x32_bf16 v[192:195], v[72:75], v[120:123], 0
    s_waitcnt lgkmcnt(4)
    v_min_u32_dpp v0, v0, v0 quad_perm:[1,0,3,2] row_mask:0xf bank_mask:0xf
    v_mfma_f32_16x16x32_bf16 v[196:199], v[76:79], v[112:115], 0
    v_mfma_f32_16x16x32_bf16 v[200:203], v[76:79], v[116:119], 0
    v_min_u32_dpp v0, v0, v0 quad_perm:[2,3,0,1] row_mask:0xf bank_mask:0xf
    v_mfma_f32_16x16x32_bf16 v[204:207], v[76:79], v[120:123], 0
    s_waitcnt lgkmcnt(0)
    v_readfirstlane_b32 s86, v0
    s_barrier
    v_mfma_f32_16x16x32_bf16 v[208:211], v[80:83], v[112:115], 0
    s_add_u32 s85, s85, 1
    s_nop 0
    s_cmp_ge_u32 s86, s85
    s_cbranch_scc0 .Lck_44_s
.Lck_44:
    ds_read_b128 v[124:127], v8 offset:33792
    v_mfma_f32_16x16x32_bf16 v[212:215], v[80:83], v[116:119], 0
    ds_read_b64_tr_b16 v[96:97], v24 offset:32768
    ds_read_b64_tr_b16 v[98:99], v24 offset:49152
    v_mfma_f32_16x16x32_bf16 v[216:219], v[80:83], v[120:123], 0
    ds_read_b64_tr_b16 v[100:101], v25 offset:32768
    ds_read_b64_tr_b16 v[102:103], v25 offset:49152
    v_mfma_f32_16x16x32_bf16 v[220:223], v[84:87], v[112:115], 0
    ds_read_b128 v[128:131], v8 offset:37888
    ds_read_b128 v[132:135], v8 offset:44032
    v_mfma_f32_16x16x32_bf16 v[224:227], v[84:87], v[116:119], 0
    ds_read_b64_tr_b16 v[104:105], v26 offset:32768
    ds_read_b64_tr_b16 v[106:107], v26 offset:49152
    v_mfma_f32_16x16x32_bf16 v[228:231], v[84:87], v[120:123], 0
    ds_read_b64_tr_b16 v[108:109], v27 offset:32768
    ds_read_b64_tr_b16 v[110:111], v27 offset:49152
    v_mfma_f32_16x16x32_bf16 v[232:235], v[88:91], v[112:115], 0
    ds_read_b64_tr_b16 v[64:65], v28 offset:32768
    ds_read_b64_tr_b16 v[66:67], v28 offset:49152
    v_mfma_f32_16x16x32_bf16 v[244:247], v[92:95], v[112:115], 0
    ds_read_b64_tr_b16 v[68:69], v29 offset:32768
    ds_read_b64_tr_b16 v[70:71], v29 offset:49152
    v_mfma_f32_16x16x32_bf16 v[236:239], v[88:91], v[116:119], 0
    v_mfma_f32_16x16x32_bf16 v[248:251], v[92:95], v[116:119], 0
    v_mfma_f32_16x16x32_bf16 v[240:243], v[88:91], v[120:123], 0
    v_mfma_f32_16x16x32_bf16 v[252:255], v[92:95], v[120:123], 0
    s_waitcnt lgkmcnt(8)
    v_mfma_f32_16x16x32_bf16 v[160:163], v[96:99], v[124:127], v[160:163]
    ds_read_b32 v0, v1
    ds_read_b64_tr_b16 v[72:73], v30 offset:32768
    v_mfma_f32_16x16x32_bf16 v[172:175], v[100:103], v[124:127], v[172:175]
    ds_read_b64_tr_b16 v[74:75], v30 offset:49152
    ds_read_b64_tr_b16 v[76:77], v31 offset:32768
    v_mfma_f32_16x16x32_bf16 v[164:167], v[96:99], v[128:131], v[164:167]
    ds_read_b64_tr_b16 v[78:79], v31 offset:49152
    v_mfma_f32_16x16x32_bf16 v[176:179], v[100:103], v[128:131], v[176:179]
    v_mfma_f32_16x16x32_bf16 v[168:171], v[96:99], v[132:135], v[168:171]
    v_mfma_f32_16x16x32_bf16 v[180:183], v[100:103], v[132:135], v[180:183]
    s_waitcnt lgkmcnt(5)
    v_mfma_f32_16x16x32_bf16 v[184:187], v[104:107], v[124:127], v[184:187]
    v_mfma_f32_16x16x32_bf16 v[188:191], v[104:107], v[128:131], v[188:191]
    v_mfma_f32_16x16x32_bf16 v[192:195], v[104:107], v[132:135], v[192:195]
    s_waitcnt lgkmcnt(3)
    v_min_u32_dpp v0, v0, v0 quad_perm:[1,0,3,2] row_mask:0xf bank_mask:0xf
    v_mfma_f32_16x16x32_bf16 v[196:199], v[108:111], v[124:127], v[196:199]
    v_mfma_f32_16x16x32_bf16 v[200:203], v[108:111], v[128:131], v[200:203]
    s_waitcnt lgkmcnt(0)
    v_min_u32_dpp v0, v0, v0 quad_perm:[2,3,0,1] row_mask:0xf bank_mask:0xf
    s_barrier
    v_mfma_f32_16x16x32_bf16 v[204:207], v[108:111], v[132:135], v[204:207]
    v_readfirstlane_b32 s86, v0
    v_mfma_f32_16x16x32_bf16 v[208:211], v[64:67], v[124:127], v[208:211]
    s_add_u32 s85, s85, 1
    s_nop 1
    s_cmp_ge_u32 s86, s85
    s_cbranch_scc0 .Lck_45_s
.Lck_45:
    ds_read_b128 v[112:115], v8 offset:34816
    v_mfma_f32_16x16x32_bf16 v[212:215], v[64:67], v[128:131], v[212:215]
    ds_read_b64_tr_b16 v[80:81], v32 offset:0
    ds_read_b64_tr_b16 v[82:83], v32 offset:16384
    v_mfma_f32_16x16x32_bf16 v[216:219], v[64:67], v[132:135], v[216:219]
    ds_read_b64_tr_b16 v[84:85], v33 offset:0
    ds_read_b64_tr_b16 v[86:87], v33 offset:16384
    v_mfma_f32_16x16x32_bf16 v[220:223], v[68:71], v[124:127], v[220:223]
    ds_read_b128 v[116:119], v8 offset:40960
    ds_read_b128 v[120:123], v8 offset:45056
    v_mfma_f32_16x16x32_bf16 v[224:227], v[68:71], v[128:131], v[224:227]
    ds_read_b64_tr_b16 v[88:89], v34 offset:0
    ds_read_b64_tr_b16 v[90:91], v34 offset:16384
    v_mfma_f32_16x16x32_bf16 v[228:231], v[68:71], v[132:135], v[228:231]
    ds_read_b64_tr_b16 v[92:93], v35 offset:0
    ds_read_b64_tr_b16 v[94:95], v35 offset:16384
    v_mfma_f32_16x16x32_bf16 v[232:235], v[72:75], v[124:127], v[232:235]
    ds_read_b64_tr_b16 v[96:97], v36 offset:0
    ds_read_b64_tr_b16 v[98:99], v36 offset:16384
    v_mfma_f32_16x16x32_bf16 v[244:247], v[76:79], v[124:127], v[244:247]
    ds_read_b64_tr_b16 v[100:101], v37 offset:0
    ds_read_b64_tr_b16 v[102:103], v37 offset:16384
    v_mfma_f32_16x16x32_bf16 v[236:239], v[72:75], v[128:131], v[236:239]
    v_mfma_f32_16x16x32_bf16 v[248:251], v[76:79], v[128:131], v[248:251]
    v_mfma_f32_16x16x32_bf16 v[240:243], v[72:75], v[132:135], v[240:243]
    v_mfma_f32_16x16x32_bf16 v[252:255], v[76:79], v[132:135], v[252:255]
    s_waitcnt lgkmcnt(8)
    v_mfma_f32_16x16x32_bf16 v[160:163], v[80:83], v[112:115], v[160:163]
    ds_read_b32 v0, v1
    ds_read_b64_tr_b16 v[104:105], v38 offset:0
    v_mfma_f32_16x16x32_bf16 v[172:175], v[84:87], v[112:115], v[172:175]
    ds_read_b64_tr_b16 v[106:107], v38 offset:16384
    ds_read_b64_tr_b16 v[108:109], v39 offset:0
    v_mfma_f32_16x16x32_bf16 v[164:167], v[80:83], v[116:119], v[164:167]
    ds_read_b64_tr_b16 v[110:111], v39 offset:16384
    v_mfma_f32_16x16x32_bf16 v[176:179], v[84:87], v[116:119], v[176:179]
    v_mfma_f32_16x16x32_bf16 v[168:171], v[80:83], v[120:123], v[168:171]
    v_mfma_f32_16x16x32_bf16 v[180:183], v[84:87], v[120:123], v[180:183]
    s_waitcnt lgkmcnt(5)
    v_mfma_f32_16x16x32_bf16 v[184:187], v[88:91], v[112:115], v[184:187]
    v_mfma_f32_16x16x32_bf16 v[188:191], v[88:91], v[116:119], v[188:191]
    v_mfma_f32_16x16x32_bf16 v[192:195], v[88:91], v[120:123], v[192:195]
    s_waitcnt lgkmcnt(3)
    v_min_u32_dpp v0, v0, v0 quad_perm:[1,0,3,2] row_mask:0xf bank_mask:0xf
    v_mfma_f32_16x16x32_bf16 v[196:199], v[92:95], v[112:115], v[196:199]
    v_mfma_f32_16x16x32_bf16 v[200:203], v[92:95], v[116:119], v[200:203]
    s_waitcnt lgkmcnt(0)
    v_min_u32_dpp v0, v0, v0 quad_perm:[2,3,0,1] row_mask:0xf bank_mask:0xf
    s_barrier
    v_mfma_f32_16x16x32_bf16 v[204:207], v[92:95], v[120:123], v[204:207]
    v_readfirstlane_b32 s86, v0
    v_mfma_f32_16x16x32_bf16 v[208:211], v[96:99], v[112:115], v[208:211]
    s_add_u32 s85, s85, 1
    s_nop 1
    s_cmp_ge_u32 s86, s85
    s_cbranch_scc0 .Lck_46_s
.Lck_46:
    ds_read_b128 v[124:127], v8 offset:35840
    v_mfma_f32_16x16x32_bf16 v[212:215], v[96:99], v[116:119], v[212:215]
    ds_read_b64_tr_b16 v[64:65], v24 offset:0
    ds_read_b64_tr_b16 v[66:67], v24 offset:16384
    v_mfma_f32_16x16x32_bf16 v[216:219], v[96:99], v[120:123], v[216:219]
    ds_read_b64_tr_b16 v[68:69], v25 offset:0
    ds_read_b64_tr_b16 v[70:71], v25 offset:16384
    v_mfma_f32_16x16x32_bf16 v[220:223], v[100:103], v[112:115], v[220:223]
    ds_read_b128 v[128:131], v8 offset:41984
    ds_read_b128 v[132:135], v8 offset:46080
    v_mfma_f32_16x16x32_bf16 v[224:227], v[100:103], v[116:119], v[224:227]
    ds_read_b64_tr_b16 v[72:73], v26 offset:0
    ds_read_b64_tr_b16 v[74:75], v26 offset:16384
    v_mfma_f32_16x16x32_bf16 v[228:231], v[100:103], v[120:123], v[228:231]
    ds_read_b64_tr_b16 v[76:77], v27 offset:0
    ds_read_b64_tr_b16 v[78:79], v27 offset:16384
    v_mfma_f32_16x16x32_bf16 v[232:235], v[104:107], v[112:115], v[232:235]
    ds_read_b64_tr_b16 v[80:81], v28 offset:0
    ds_read_b64_tr_b16 v[82:83], v28 offset:16384
    v_mfma_f32_16x16x32_bf16 v[244:247], v[108:111], v[112:115], v[244:247]
    ds_read_b64_tr_b16 v[84:85], v29 offset:0
    ds_read_b64_tr_b16 v[86:87], v29 offset:16384
    v_mfma_f32_16x16x32_bf16 v[236:239], v[104:107], v[116:119], v[236:239]
    v_mfma_f32_16x16x32_bf16 v[248:251], v[108:111], v[116:119], v[248:251]
    v_mfma_f32_16x16x32_bf16 v[240:243], v[104:107], v[120:123], v[240:243]
    v_mfma_f32_16x16x32_bf16 v[252:255], v[108:111], v[120:123], v[252:255]
    s_waitcnt lgkmcnt(8)
    v_mfma_f32_16x16x32_bf16 v[160:163], v[64:67], v[124:127], v[160:163]
    ds_read_b32 v0, v1
    ds_read_b64_tr_b16 v[88:89], v30 offset:0
    v_mfma_f32_16x16x32_bf16 v[172:175], v[68:71], v[124:127], v[172:175]
    ds_read_b64_tr_b16 v[90:91], v30 offset:16384
    ds_read_b64_tr_b16 v[92:93], v31 offset:0
    v_mfma_f32_16x16x32_bf16 v[164:167], v[64:67], v[128:131], v[164:167]
    ds_read_b64_tr_b16 v[94:95], v31 offset:16384
    v_mfma_f32_16x16x32_bf16 v[176:179], v[68:71], v[128:131], v[176:179]
    v_mfma_f32_16x16x32_bf16 v[168:171], v[64:67], v[132:135], v[168:171]
    v_mfma_f32_16x16x32_bf16 v[180:183], v[68:71], v[132:135], v[180:183]
    s_waitcnt lgkmcnt(5)
    v_mfma_f32_16x16x32_bf16 v[184:187], v[72:75], v[124:127], v[184:187]
    v_mfma_f32_16x16x32_bf16 v[188:191], v[72:75], v[128:131], v[188:191]
    v_mfma_f32_16x16x32_bf16 v[192:195], v[72:75], v[132:135], v[192:195]
    s_waitcnt lgkmcnt(3)
    v_min_u32_dpp v0, v0, v0 quad_perm:[1,0,3,2] row_mask:0xf bank_mask:0xf
    v_mfma_f32_16x16x32_bf16 v[196:199], v[76:79], v[124:127], v[196:199]
    v_mfma_f32_16x16x32_bf16 v[200:203], v[76:79], v[128:131], v[200:203]
    s_waitcnt lgkmcnt(0)
    v_min_u32_dpp v0, v0, v0 quad_perm:[2,3,0,1] row_mask:0xf bank_mask:0xf
    s_barrier
    v_mfma_f32_16x16x32_bf16 v[204:207], v[76:79], v[132:135], v[204:207]
    v_readfirstlane_b32 s86, v0
    v_mfma_f32_16x16x32_bf16 v[208:211], v[80:83], v[124:127], v[208:211]
    s_add_u32 s85, s85, 1
    s_nop 1
    s_cmp_ge_u32 s86, s85
    s_cbranch_scc0 .Lck_47_s
.Lck_47:
    ds_read_b128 v[112:115], v8 offset:49152
    v_mfma_f32_16x16x32_bf16 v[212:215], v[80:83], v[128:131], v[212:215]
    ds_read_b64_tr_b16 v[96:97], v24 offset:32768
    ds_read_b64_tr_b16 v[98:99], v24 offset:49152
    v_mfma_f32_16x16x32_bf16 v[216:219], v[80:83], v[132:135], v[216:219]
    ds_read_b64_tr_b16 v[100:101], v25 offset:32768
    ds_read_b64_tr_b16 v[102:103], v25 offset:49152
    v_mfma_f32_16x16x32_bf16 v[220:223], v[84:87], v[124:127], v[220:223]
    ds_read_b128 v[116:119], v8 offset:53248
    ds_read_b128 v[120:123], v8 offset:59392
    v_mfma_f32_16x16x32_bf16 v[224:227], v[84:87], v[128:131], v[224:227]
    ds_read_b64_tr_b16 v[104:105], v26 offset:32768
    ds_read_b64_tr_b16 v[106:107], v26 offset:49152
    v_mfma_f32_16x16x32_bf16 v[228:231], v[84:87], v[132:135], v[228:231]
    ds_read_b64_tr_b16 v[108:109], v27 offset:32768
    ds_read_b64_tr_b16 v[110:111], v27 offset:49152
    v_mfma_f32_16x16x32_bf16 v[232:235], v[88:91], v[124:127], v[232:235]
    ds_read_b64_tr_b16 v[64:65], v28 offset:32768
    ds_read_b64_tr_b16 v[66:67], v28 offset:49152
    v_mfma_f32_16x16x32_bf16 v[244:247], v[92:95], v[124:127], v[244:247]
    ds_read_b64_tr_b16 v[68:69], v29 offset:32768
    ds_read_b64_tr_b16 v[70:71], v29 offset:49152
    v_mfma_f32_16x16x32_bf16 v[236:239], v[88:91], v[128:131], v[236:239]
    v_mfma_f32_16x16x32_bf16 v[248:251], v[92:95], v[128:131], v[248:251]
    v_mfma_f32_16x16x32_bf16 v[240:243], v[88:91], v[132:135], v[240:243]
    v_mfma_f32_16x16x32_bf16 v[252:255], v[92:95], v[132:135], v[252:255]
    s_waitcnt lgkmcnt(8)
    v_mfma_f32_16x16x32_bf16 v[160:163], v[96:99], v[112:115], v[160:163]
    ds_read_b32 v0, v1
    ds_read_b64_tr_b16 v[72:73], v30 offset:32768
    v_mfma_f32_16x16x32_bf16 v[172:175], v[100:103], v[112:115], v[172:175]
    ds_read_b64_tr_b16 v[74:75], v30 offset:49152
    ds_read_b64_tr_b16 v[76:77], v31 offset:32768
    v_mfma_f32_16x16x32_bf16 v[164:167], v[96:99], v[116:119], v[164:167]
    ds_read_b64_tr_b16 v[78:79], v31 offset:49152
    v_mfma_f32_16x16x32_bf16 v[176:179], v[100:103], v[116:119], v[176:179]
    v_mfma_f32_16x16x32_bf16 v[168:171], v[96:99], v[120:123], v[168:171]
    v_mfma_f32_16x16x32_bf16 v[180:183], v[100:103], v[120:123], v[180:183]
    s_waitcnt lgkmcnt(5)
    v_mfma_f32_16x16x32_bf16 v[184:187], v[104:107], v[112:115], v[184:187]
    v_mfma_f32_16x16x32_bf16 v[188:191], v[104:107], v[116:119], v[188:191]
    v_mfma_f32_16x16x32_bf16 v[192:195], v[104:107], v[120:123], v[192:195]
    s_waitcnt lgkmcnt(3)
    v_min_u32_dpp v0, v0, v0 quad_perm:[1,0,3,2] row_mask:0xf bank_mask:0xf
    v_mfma_f32_16x16x32_bf16 v[196:199], v[108:111], v[112:115], v[196:199]
    v_mfma_f32_16x16x32_bf16 v[200:203], v[108:111], v[116:119], v[200:203]
    s_waitcnt lgkmcnt(0)
    v_min_u32_dpp v0, v0, v0 quad_perm:[2,3,0,1] row_mask:0xf bank_mask:0xf
    s_barrier
    v_mfma_f32_16x16x32_bf16 v[204:207], v[108:111], v[120:123], v[204:207]
    v_readfirstlane_b32 s86, v0
    v_mfma_f32_16x16x32_bf16 v[208:211], v[64:67], v[112:115], v[208:211]
    s_add_u32 s85, s85, 1
    s_nop 1
    s_cmp_ge_u32 s86, s85
    s_cbranch_scc0 .Lck_48_s
.Lck_48:
    ds_read_b128 v[124:127], v8 offset:50176
    v_mfma_f32_16x16x32_bf16 v[212:215], v[64:67], v[116:119], v[212:215]
    ds_read_b64_tr_b16 v[80:81], v32 offset:0
    ds_read_b64_tr_b16 v[82:83], v32 offset:16384
    v_mfma_f32_16x16x32_bf16 v[216:219], v[64:67], v[120:123], v[216:219]
    ds_read_b64_tr_b16 v[84:85], v33 offset:0
    ds_read_b64_tr_b16 v[86:87], v33 offset:16384
    v_mfma_f32_16x16x32_bf16 v[220:223], v[68:71], v[112:115], v[220:223]
    ds_read_b128 v[128:131], v8 offset:54272
    ds_read_b128 v[132:135], v8 offset:60416
    v_mfma_f32_16x16x32_bf16 v[224:227], v[68:71], v[116:119], v[224:227]
    ds_read_b64_tr_b16 v[88:89], v34 offset:0
    ds_read_b64_tr_b16 v[90:91], v34 offset:16384
    v_mfma_f32_16x16x32_bf16 v[228:231], v[68:71], v[120:123], v[228:231]
    ds_read_b64_tr_b16 v[92:93], v35 offset:0
    ds_read_b64_tr_b16 v[94:95], v35 offset:16384
    v_mfma_f32_16x16x32_bf16 v[232:235], v[72:75], v[112:115], v[232:235]
    ds_read_b64_tr_b16 v[96:97], v36 offset:0
    ds_read_b64_tr_b16 v[98:99], v36 offset:16384
    v_mfma_f32_16x16x32_bf16 v[244:247], v[76:79], v[112:115], v[244:247]
    ds_read_b64_tr_b16 v[100:101], v37 offset:0
    ds_read_b64_tr_b16 v[102:103], v37 offset:16384
    v_mfma_f32_16x16x32_bf16 v[236:239], v[72:75], v[116:119], v[236:239]
    v_mfma_f32_16x16x32_bf16 v[248:251], v[76:79], v[116:119], v[248:251]
    v_mfma_f32_16x16x32_bf16 v[240:243], v[72:75], v[120:123], v[240:243]
    v_mfma_f32_16x16x32_bf16 v[252:255], v[76:79], v[120:123], v[252:255]
    s_waitcnt lgkmcnt(8)
    v_mfma_f32_16x16x32_bf16 v[160:163], v[80:83], v[124:127], v[160:163]
    ds_read_b32 v0, v1
    ds_read_b64_tr_b16 v[104:105], v38 offset:0
    v_mfma_f32_16x16x32_bf16 v[172:175], v[84:87], v[124:127], v[172:175]
    ds_read_b64_tr_b16 v[106:107], v38 offset:16384
    ds_read_b64_tr_b16 v[108:109], v39 offset:0
    v_mfma_f32_16x16x32_bf16 v[164:167], v[80:83], v[128:131], v[164:167]
    ds_read_b64_tr_b16 v[110:111], v39 offset:16384
    v_mfma_f32_16x16x32_bf16 v[176:179], v[84:87], v[128:131], v[176:179]
    v_mfma_f32_16x16x32_bf16 v[168:171], v[80:83], v[132:135], v[168:171]
    v_mfma_f32_16x16x32_bf16 v[180:183], v[84:87], v[132:135], v[180:183]
    s_waitcnt lgkmcnt(5)
    v_mfma_f32_16x16x32_bf16 v[184:187], v[88:91], v[124:127], v[184:187]
    v_mfma_f32_16x16x32_bf16 v[188:191], v[88:91], v[128:131], v[188:191]
    v_mfma_f32_16x16x32_bf16 v[192:195], v[88:91], v[132:135], v[192:195]
    s_waitcnt lgkmcnt(3)
    v_min_u32_dpp v0, v0, v0 quad_perm:[1,0,3,2] row_mask:0xf bank_mask:0xf
    v_mfma_f32_16x16x32_bf16 v[196:199], v[92:95], v[124:127], v[196:199]
    v_mfma_f32_16x16x32_bf16 v[200:203], v[92:95], v[128:131], v[200:203]
    s_waitcnt lgkmcnt(0)
    v_min_u32_dpp v0, v0, v0 quad_perm:[2,3,0,1] row_mask:0xf bank_mask:0xf
    s_barrier
    v_mfma_f32_16x16x32_bf16 v[204:207], v[92:95], v[132:135], v[204:207]
    v_readfirstlane_b32 s86, v0
    v_mfma_f32_16x16x32_bf16 v[208:211], v[96:99], v[124:127], v[208:211]
    s_add_u32 s85, s85, 1
    s_nop 1
    s_cmp_ge_u32 s86, s85
    s_cbranch_scc0 .Lck_49_s
.Lck_49:
    ds_read_b128 v[112:115], v8 offset:51200
    v_mfma_f32_16x16x32_bf16 v[212:215], v[96:99], v[128:131], v[212:215]
    ds_read_b64_tr_b16 v[64:65], v24 offset:0
    ds_read_b64_tr_b16 v[66:67], v24 offset:16384
    v_mfma_f32_16x16x32_bf16 v[216:219], v[96:99], v[132:135], v[216:219]
    ds_read_b64_tr_b16 v[68:69], v25 offset:0
    ds_read_b64_tr_b16 v[70:71], v25 offset:16384
    v_mfma_f32_16x16x32_bf16 v[220:223], v[100:103], v[124:127], v[220:223]
    ds_read_b128 v[116:119], v8 offset:57344
    ds_read_b128 v[120:123], v8 offset:61440
    v_mfma_f32_16x16x32_bf16 v[224:227], v[100:103], v[128:131], v[224:227]
    ds_read_b64_tr_b16 v[72:73], v26 offset:0
    ds_read_b64_tr_b16 v[74:75], v26 offset:16384
    v_mfma_f32_16x16x32_bf16 v[228:231], v[100:103], v[132:135], v[228:231]
    ds_read_b64_tr_b16 v[76:77], v27 offset:0
    ds_read_b64_tr_b16 v[78:79], v27 offset:16384
    v_mfma_f32_16x16x32_bf16 v[232:235], v[104:107], v[124:127], v[232:235]
    ds_read_b64_tr_b16 v[80:81], v28 offset:0
    ds_read_b64_tr_b16 v[82:83], v28 offset:16384
    v_mfma_f32_16x16x32_bf16 v[244:247], v[108:111], v[124:127], v[244:247]
    ds_read_b64_tr_b16 v[84:85], v29 offset:0
    ds_read_b64_tr_b16 v[86:87], v29 offset:16384
    v_mfma_f32_16x16x32_bf16 v[236:239], v[104:107], v[128:131], v[236:239]
    v_mfma_f32_16x16x32_bf16 v[248:251], v[108:111], v[128:131], v[248:251]
    v_mfma_f32_16x16x32_bf16 v[240:243], v[104:107], v[132:135], v[240:243]
    v_mfma_f32_16x16x32_bf16 v[252:255], v[108:111], v[132:135], v[252:255]
    s_waitcnt lgkmcnt(8)
    v_mfma_f32_16x16x32_bf16 v[160:163], v[64:67], v[112:115], v[160:163]
    ds_read_b32 v0, v1
    ds_read_b64_tr_b16 v[88:89], v30 offset:0
    v_mfma_f32_16x16x32_bf16 v[172:175], v[68:71], v[112:115], v[172:175]
    ds_read_b64_tr_b16 v[90:91], v30 offset:16384
    ds_read_b64_tr_b16 v[92:93], v31 offset:0
    v_mfma_f32_16x16x32_bf16 v[164:167], v[64:67], v[116:119], v[164:167]
    ds_read_b64_tr_b16 v[94:95], v31 offset:16384
    v_mfma_f32_16x16x32_bf16 v[176:179], v[68:71], v[116:119], v[176:179]
    v_mfma_f32_16x16x32_bf16 v[168:171], v[64:67], v[120:123], v[168:171]
    v_mfma_f32_16x16x32_bf16 v[180:183], v[68:71], v[120:123], v[180:183]
    s_waitcnt lgkmcnt(5)
    v_mfma_f32_16x16x32_bf16 v[184:187], v[72:75], v[112:115], v[184:187]
    v_mfma_f32_16x16x32_bf16 v[188:191], v[72:75], v[116:119], v[188:191]
    v_mfma_f32_16x16x32_bf16 v[192:195], v[72:75], v[120:123], v[192:195]
    s_waitcnt lgkmcnt(3)
    v_min_u32_dpp v0, v0, v0 quad_perm:[1,0,3,2] row_mask:0xf bank_mask:0xf
    v_mfma_f32_16x16x32_bf16 v[196:199], v[76:79], v[112:115], v[196:199]
    v_mfma_f32_16x16x32_bf16 v[200:203], v[76:79], v[116:119], v[200:203]
    s_waitcnt lgkmcnt(0)
    v_min_u32_dpp v0, v0, v0 quad_perm:[2,3,0,1] row_mask:0xf bank_mask:0xf
    s_barrier
    v_mfma_f32_16x16x32_bf16 v[204:207], v[76:79], v[120:123], v[204:207]
    v_readfirstlane_b32 s86, v0
    v_mfma_f32_16x16x32_bf16 v[208:211], v[80:83], v[112:115], v[208:211]
    s_add_u32 s85, s85, 1
    s_nop 1
    s_cmp_ge_u32 s86, s85
    s_cbranch_scc0 .Lck_50_s
.Lck_50:
    ds_read_b128 v[124:127], v8 offset:52224
    v_mfma_f32_16x16x32_bf16 v[212:215], v[80:83], v[116:119], v[212:215]
    ds_read_b64_tr_b16 v[96:97], v24 offset:32768
    ds_read_b64_tr_b16 v[98:99], v24 offset:49152
    v_mfma_f32_16x16x32_bf16 v[216:219], v[80:83], v[120:123], v[216:219]
    ds_read_b64_tr_b16 v[100:101], v25 offset:32768
    ds_read_b64_tr_b16 v[102:103], v25 offset:49152
    v_mfma_f32_16x16x32_bf16 v[220:223], v[84:87], v[112:115], v[220:223]
    ds_read_b128 v[128:131], v8 offset:58368
    ds_read_b128 v[132:135], v8 offset:62464
    v_mfma_f32_16x16x32_bf16 v[224:227], v[84:87], v[116:119], v[224:227]
    ds_read_b64_tr_b16 v[104:105], v26 offset:32768
    ds_read_b64_tr_b16 v[106:107], v26 offset:49152
    v_mfma_f32_16x16x32_bf16 v[228:231], v[84:87], v[120:123], v[228:231]
    ds_read_b64_tr_b16 v[108:109], v27 offset:32768
    ds_read_b64_tr_b16 v[110:111], v27 offset:49152
    v_mfma_f32_16x16x32_bf16 v[232:235], v[88:91], v[112:115], v[232:235]
    ds_read_b64_tr_b16 v[64:65], v28 offset:32768
    ds_read_b64_tr_b16 v[66:67], v28 offset:49152
    v_mfma_f32_16x16x32_bf16 v[244:247], v[92:95], v[112:115], v[244:247]
    ds_read_b64_tr_b16 v[68:69], v29 offset:32768
    ds_read_b64_tr_b16 v[70:71], v29 offset:49152
    v_mfma_f32_16x16x32_bf16 v[236:239], v[88:91], v[116:119], v[236:239]
    v_mfma_f32_16x16x32_bf16 v[248:251], v[92:95], v[116:119], v[248:251]
    v_mfma_f32_16x16x32_bf16 v[240:243], v[88:91], v[120:123], v[240:243]
    v_mfma_f32_16x16x32_bf16 v[252:255], v[92:95], v[120:123], v[252:255]
    s_waitcnt lgkmcnt(8)
    v_mfma_f32_16x16x32_bf16 v[160:163], v[96:99], v[124:127], v[160:163]
    ds_read_b32 v0, v1
    ds_read_b64_tr_b16 v[72:73], v30 offset:32768
    v_mfma_f32_16x16x32_bf16 v[172:175], v[100:103], v[124:127], v[172:175]
    ds_read_b64_tr_b16 v[74:75], v30 offset:49152
    ds_read_b64_tr_b16 v[76:77], v31 offset:32768
    v_mfma_f32_16x16x32_bf16 v[164:167], v[96:99], v[128:131], v[164:167]
    ds_read_b64_tr_b16 v[78:79], v31 offset:49152
    v_mfma_f32_16x16x32_bf16 v[176:179], v[100:103], v[128:131], v[176:179]
    v_mfma_f32_16x16x32_bf16 v[168:171], v[96:99], v[132:135], v[168:171]
    v_mfma_f32_16x16x32_bf16 v[180:183], v[100:103], v[132:135], v[180:183]
    s_waitcnt lgkmcnt(5)
    v_mfma_f32_16x16x32_bf16 v[184:187], v[104:107], v[124:127], v[184:187]
    v_mfma_f32_16x16x32_bf16 v[188:191], v[104:107], v[128:131], v[188:191]
    v_mfma_f32_16x16x32_bf16 v[192:195], v[104:107], v[132:135], v[192:195]
    s_waitcnt lgkmcnt(3)
    v_min_u32_dpp v0, v0, v0 quad_perm:[1,0,3,2] row_mask:0xf bank_mask:0xf
    v_mfma_f32_16x16x32_bf16 v[196:199], v[108:111], v[124:127], v[196:199]
    v_mfma_f32_16x16x32_bf16 v[200:203], v[108:111], v[128:131], v[200:203]
    s_waitcnt lgkmcnt(0)
    v_min_u32_dpp v0, v0, v0 quad_perm:[2,3,0,1] row_mask:0xf bank_mask:0xf
    s_barrier
    v_mfma_f32_16x16x32_bf16 v[204:207], v[108:111], v[132:135], v[204:207]
    v_readfirstlane_b32 s86, v0
    v_mfma_f32_16x16x32_bf16 v[208:211], v[64:67], v[124:127], v[208:211]
    s_add_u32 s85, s85, 1
    s_nop 1
    s_cmp_ge_u32 s86, s85
    s_cbranch_scc0 .Lck_51_s
.Lck_51:
    ds_read_b128 v[112:115], v8 offset:0
    v_mfma_f32_16x16x32_bf16 v[212:215], v[64:67], v[128:131], v[212:215]
    ds_read_b64_tr_b16 v[80:81], v32 offset:0
    ds_read_b64_tr_b16 v[82:83], v32 offset:16384
    v_mfma_f32_16x16x32_bf16 v[216:219], v[64:67], v[132:135], v[216:219]
    ds_read_b64_tr_b16 v[84:85], v33 offset:0
    ds_read_b64_tr_b16 v[86:87], v33 offset:16384
    v_mfma_f32_16x16x32_bf16 v[220:223], v[68:71], v[124:127], v[220:223]
    ds_read_b128 v[116:119], v8 offset:4096
    ds_read_b128 v[120:123], v8 offset:10240
    v_mfma_f32_16x16x32_bf16 v[224:227], v[68:71], v[128:131], v[224:227]
    ds_read_b64_tr_b16 v[88:89], v34 offset:0
    ds_read_b64_tr_b16 v[90:91], v34 offset:16384
    v_mfma_f32_16x16x32_bf16 v[228:231], v[68:71], v[132:135], v[228:231]
    ds_read_b64_tr_b16 v[92:93], v35 offset:0
    ds_read_b64_tr_b16 v[94:95], v35 offset:16384
    v_mfma_f32_16x16x32_bf16 v[232:235], v[72:75], v[124:127], v[232:235]
    ds_read_b64_tr_b16 v[96:97], v36 offset:0
    ds_read_b64_tr_b16 v[98:99], v36 offset:16384
    v_mfma_f32_16x16x32_bf16 v[244:247], v[76:79], v[124:127], v[244:247]
    ds_read_b64_tr_b16 v[100:101], v37 offset:0
    ds_read_b64_tr_b16 v[102:103], v37 offset:16384
    v_mfma_f32_16x16x32_bf16 v[236:239], v[72:75], v[128:131], v[236:239]
    v_mfma_f32_16x16x32_bf16 v[248:251], v[76:79], v[128:131], v[248:251]
    v_mfma_f32_16x16x32_bf16 v[240:243], v[72:75], v[132:135], v[240:243]
    v_mfma_f32_16x16x32_bf16 v[252:255], v[76:79], v[132:135], v[252:255]
    s_waitcnt lgkmcnt(8)
    v_mfma_f32_16x16x32_bf16 v[160:163], v[80:83], v[112:115], v[160:163]
    ds_read_b32 v0, v1
    ds_read_b64_tr_b16 v[104:105], v38 offset:0
    v_mfma_f32_16x16x32_bf16 v[172:175], v[84:87], v[112:115], v[172:175]
    ds_read_b64_tr_b16 v[106:107], v38 offset:16384
    ds_read_b64_tr_b16 v[108:109], v39 offset:0
    v_mfma_f32_16x16x32_bf16 v[164:167], v[80:83], v[116:119], v[164:167]
    ds_read_b64_tr_b16 v[110:111], v39 offset:16384
    v_mfma_f32_16x16x32_bf16 v[176:179], v[84:87], v[116:119], v[176:179]
    v_mfma_f32_16x16x32_bf16 v[168:171], v[80:83], v[120:123], v[168:171]
    v_mfma_f32_16x16x32_bf16 v[180:183], v[84:87], v[120:123], v[180:183]
    s_waitcnt lgkmcnt(5)
    v_mfma_f32_16x16x32_bf16 v[184:187], v[88:91], v[112:115], v[184:187]
    v_mfma_f32_16x16x32_bf16 v[188:191], v[88:91], v[116:119], v[188:191]
    v_mfma_f32_16x16x32_bf16 v[192:195], v[88:91], v[120:123], v[192:195]
    s_waitcnt lgkmcnt(3)
    v_min_u32_dpp v0, v0, v0 quad_perm:[1,0,3,2] row_mask:0xf bank_mask:0xf
    v_mfma_f32_16x16x32_bf16 v[196:199], v[92:95], v[112:115], v[196:199]
    v_mfma_f32_16x16x32_bf16 v[200:203], v[92:95], v[116:119], v[200:203]
    s_waitcnt lgkmcnt(0)
    v_min_u32_dpp v0, v0, v0 quad_perm:[2,3,0,1] row_mask:0xf bank_mask:0xf
    s_barrier
    v_mfma_f32_16x16x32_bf16 v[204:207], v[92:95], v[120:123], v[204:207]
    v_readfirstlane_b32 s86, v0
    v_mfma_f32_16x16x32_bf16 v[208:211], v[96:99], v[112:115], v[208:211]
    s_add_u32 s85, s85, 1
    s_nop 1
    s_cmp_ge_u32 s86, s85
    s_cbranch_scc0 .Lck_52_s
.Lck_52:
    ds_read_b128 v[124:127], v8 offset:1024
    v_mfma_f32_16x16x32_bf16 v[212:215], v[96:99], v[116:119], v[212:215]
    ds_read_b64_tr_b16 v[64:65], v24 offset:0
    ds_read_b64_tr_b16 v[66:67], v24 offset:16384
    v_mfma_f32_16x16x32_bf16 v[216:219], v[96:99], v[120:123], v[216:219]
    ds_read_b64_tr_b16 v[68:69], v25 offset:0
    ds_read_b64_tr_b16 v[70:71], v25 offset:16384
    v_mfma_f32_16x16x32_bf16 v[220:223], v[100:103], v[112:115], v[220:223]
    ds_read_b128 v[128:131], v8 offset:5120
    ds_read_b128 v[132:135], v8 offset:11264
    v_mfma_f32_16x16x32_bf16 v[224:227], v[100:103], v[116:119], v[224:227]
    ds_read_b64_tr_b16 v[72:73], v26 offset:0
    ds_read_b64_tr_b16 v[74:75], v26 offset:16384
    v_mfma_f32_16x16x32_bf16 v[228:231], v[100:103], v[120:123], v[228:231]
    ds_read_b64_tr_b16 v[76:77], v27 offset:0
    ds_read_b64_tr_b16 v[78:79], v27 offset:16384
    v_mfma_f32_16x16x32_bf16 v[232:235], v[104:107], v[112:115], v[232:235]
    ds_read_b64_tr_b16 v[80:81], v28 offset:0
    ds_read_b64_tr_b16 v[82:83], v28 offset:16384
    v_mfma_f32_16x16x32_bf16 v[244:247], v[108:111], v[112:115], v[244:247]
    ds_read_b64_tr_b16 v[84:85], v29 offset:0
    ds_read_b64_tr_b16 v[86:87], v29 offset:16384
    v_mfma_f32_16x16x32_bf16 v[236:239], v[104:107], v[116:119], v[236:239]
    v_mfma_f32_16x16x32_bf16 v[248:251], v[108:111], v[116:119], v[248:251]
    v_mfma_f32_16x16x32_bf16 v[240:243], v[104:107], v[120:123], v[240:243]
    v_mfma_f32_16x16x32_bf16 v[252:255], v[108:111], v[120:123], v[252:255]
    s_waitcnt lgkmcnt(8)
    v_mfma_f32_16x16x32_bf16 v[160:163], v[64:67], v[124:127], v[160:163]
    ds_read_b32 v0, v1
    ds_read_b64_tr_b16 v[88:89], v30 offset:0
    v_mfma_f32_16x16x32_bf16 v[172:175], v[68:71], v[124:127], v[172:175]
    ds_read_b64_tr_b16 v[90:91], v30 offset:16384
    ds_read_b64_tr_b16 v[92:93], v31 offset:0
    v_mfma_f32_16x16x32_bf16 v[164:167], v[64:67], v[128:131], v[164:167]
    ds_read_b64_tr_b16 v[94:95], v31 offset:16384
    v_mfma_f32_16x16x32_bf16 v[176:179], v[68:71], v[128:131], v[176:179]
    v_mfma_f32_16x16x32_bf16 v[168:171], v[64:67], v[132:135], v[168:171]
    v_mfma_f32_16x16x32_bf16 v[180:183], v[68:71], v[132:135], v[180:183]
    s_waitcnt lgkmcnt(5)
    v_mfma_f32_16x16x32_bf16 v[184:187], v[72:75], v[124:127], v[184:187]
    v_mfma_f32_16x16x32_bf16 v[188:191], v[72:75], v[128:131], v[188:191]
    v_mfma_f32_16x16x32_bf16 v[192:195], v[72:75], v[132:135], v[192:195]
    s_waitcnt lgkmcnt(3)
    v_min_u32_dpp v0, v0, v0 quad_perm:[1,0,3,2] row_mask:0xf bank_mask:0xf
    v_mfma_f32_16x16x32_bf16 v[196:199], v[76:79], v[124:127], v[196:199]
    v_mfma_f32_16x16x32_bf16 v[200:203], v[76:79], v[128:131], v[200:203]
    s_waitcnt lgkmcnt(0)
    v_min_u32_dpp v0, v0, v0 quad_perm:[2,3,0,1] row_mask:0xf bank_mask:0xf
    s_barrier
    v_mfma_f32_16x16x32_bf16 v[204:207], v[76:79], v[132:135], v[204:207]
    v_readfirstlane_b32 s86, v0
    v_mfma_f32_16x16x32_bf16 v[208:211], v[80:83], v[124:127], v[208:211]
    s_add_u32 s85, s85, 1
    s_nop 1
    s_cmp_ge_u32 s86, s85
    s_cbranch_scc0 .Lck_53_s
.Lck_53:
    ds_read_b128 v[112:115], v8 offset:2048
    v_mfma_f32_16x16x32_bf16 v[212:215], v[80:83], v[128:131], v[212:215]
    ds_read_b64_tr_b16 v[96:97], v24 offset:32768
    ds_read_b64_tr_b16 v[98:99], v24 offset:49152
    v_mfma_f32_16x16x32_bf16 v[216:219], v[80:83], v[132:135], v[216:219]
    ds_read_b64_tr_b16 v[100:101], v25 offset:32768
    ds_read_b64_tr_b16 v[102:103], v25 offset:49152
    v_mfma_f32_16x16x32_bf16 v[220:223], v[84:87], v[124:127], v[220:223]
    ds_read_b128 v[116:119], v8 offset:8192
    ds_read_b128 v[120:123], v8 offset:12288
    v_mfma_f32_16x16x32_bf16 v[224:227], v[84:87], v[128:131], v[224:227]
    ds_read_b64_tr_b16 v[104:105], v26 offset:32768
    ds_read_b64_tr_b16 v[106:107], v26 offset:49152
    v_mfma_f32_16x16x32_bf16 v[228:231], v[84:87], v[132:135], v[228:231]
    ds_read_b64_tr_b16 v[108:109], v27 offset:32768
    ds_read_b64_tr_b16 v[110:111], v27 offset:49152
    v_mfma_f32_16x16x32_bf16 v[232:235], v[88:91], v[124:127], v[232:235]
    ds_read_b64_tr_b16 v[64:65], v28 offset:32768
    ds_read_b64_tr_b16 v[66:67], v28 offset:49152
    v_mfma_f32_16x16x32_bf16 v[244:247], v[92:95], v[124:127], v[244:247]
    ds_read_b64_tr_b16 v[68:69], v29 offset:32768
    ds_read_b64_tr_b16 v[70:71], v29 offset:49152
    v_mfma_f32_16x16x32_bf16 v[236:239], v[88:91], v[128:131], v[236:239]
    v_mfma_f32_16x16x32_bf16 v[248:251], v[92:95], v[128:131], v[248:251]
    v_mfma_f32_16x16x32_bf16 v[240:243], v[88:91], v[132:135], v[240:243]
    v_mfma_f32_16x16x32_bf16 v[252:255], v[92:95], v[132:135], v[252:255]
    s_waitcnt lgkmcnt(8)
    v_mfma_f32_16x16x32_bf16 v[160:163], v[96:99], v[112:115], v[160:163]
    ds_read_b32 v0, v1
    ds_read_b64_tr_b16 v[72:73], v30 offset:32768
    v_mfma_f32_16x16x32_bf16 v[172:175], v[100:103], v[112:115], v[172:175]
    ds_read_b64_tr_b16 v[74:75], v30 offset:49152
    ds_read_b64_tr_b16 v[76:77], v31 offset:32768
    v_mfma_f32_16x16x32_bf16 v[164:167], v[96:99], v[116:119], v[164:167]
    ds_read_b64_tr_b16 v[78:79], v31 offset:49152
    v_mfma_f32_16x16x32_bf16 v[176:179], v[100:103], v[116:119], v[176:179]
    v_mfma_f32_16x16x32_bf16 v[168:171], v[96:99], v[120:123], v[168:171]
    v_mfma_f32_16x16x32_bf16 v[180:183], v[100:103], v[120:123], v[180:183]
    s_waitcnt lgkmcnt(5)
    v_mfma_f32_16x16x32_bf16 v[184:187], v[104:107], v[112:115], v[184:187]
    v_mfma_f32_16x16x32_bf16 v[188:191], v[104:107], v[116:119], v[188:191]
    v_mfma_f32_16x16x32_bf16 v[192:195], v[104:107], v[120:123], v[192:195]
    s_waitcnt lgkmcnt(3)
    v_min_u32_dpp v0, v0, v0 quad_perm:[1,0,3,2] row_mask:0xf bank_mask:0xf
    v_mfma_f32_16x16x32_bf16 v[196:199], v[108:111], v[112:115], v[196:199]
    v_mfma_f32_16x16x32_bf16 v[200:203], v[108:111], v[116:119], v[200:203]
    s_waitcnt lgkmcnt(0)
    v_min_u32_dpp v0, v0, v0 quad_perm:[2,3,0,1] row_mask:0xf bank_mask:0xf
    s_barrier
    v_mfma_f32_16x16x32_bf16 v[204:207], v[108:111], v[120:123], v[204:207]
    v_readfirstlane_b32 s86, v0
    v_mfma_f32_16x16x32_bf16 v[208:211], v[64:67], v[112:115], v[208:211]
    s_add_u32 s85, s85, 1
    s_nop 1
    s_cmp_ge_u32 s86, s85
    s_cbranch_scc0 .Lck_54_s
.Lck_54:
    ds_read_b128 v[124:127], v8 offset:3072
    v_mfma_f32_16x16x32_bf16 v[212:215], v[64:67], v[116:119], v[212:215]
    ds_read_b64_tr_b16 v[80:81], v32 offset:0
    ds_read_b64_tr_b16 v[82:83], v32 offset:16384
    v_mfma_f32_16x16x32_bf16 v[216:219], v[64:67], v[120:123], v[216:219]
    ds_read_b64_tr_b16 v[84:85], v33 offset:0
    ds_read_b64_tr_b16 v[86:87], v33 offset:16384
    v_mfma_f32_16x16x32_bf16 v[220:223], v[68:71], v[112:115], v[220:223]
    ds_read_b128 v[128:131], v8 offset:9216
    ds_read_b128 v[132:135], v8 offset:13312
    v_mfma_f32_16x16x32_bf16 v[224:227], v[68:71], v[116:119], v[224:227]
    ds_read_b64_tr_b16 v[88:89], v34 offset:0
    ds_read_b64_tr_b16 v[90:91], v34 offset:16384
    v_mfma_f32_16x16x32_bf16 v[228:231], v[68:71], v[120:123], v[228:231]
    ds_read_b64_tr_b16 v[92:93], v35 offset:0
    ds_read_b64_tr_b16 v[94:95], v35 offset:16384
    v_mfma_f32_16x16x32_bf16 v[232:235], v[72:75], v[112:115], v[232:235]
    ds_read_b64_tr_b16 v[96:97], v36 offset:0
    ds_read_b64_tr_b16 v[98:99], v36 offset:16384
    v_mfma_f32_16x16x32_bf16 v[244:247], v[76:79], v[112:115], v[244:247]
    ds_read_b64_tr_b16 v[100:101], v37 offset:0
    ds_read_b64_tr_b16 v[102:103], v37 offset:16384
    v_mfma_f32_16x16x32_bf16 v[236:239], v[72:75], v[116:119], v[236:239]
    v_mfma_f32_16x16x32_bf16 v[248:251], v[76:79], v[116:119], v[248:251]
    v_mfma_f32_16x16x32_bf16 v[240:243], v[72:75], v[120:123], v[240:243]
    v_mfma_f32_16x16x32_bf16 v[252:255], v[76:79], v[120:123], v[252:255]
    s_waitcnt lgkmcnt(8)
    v_mfma_f32_16x16x32_bf16 v[160:163], v[80:83], v[124:127], v[160:163]
    ds_read_b32 v0, v1
    ds_read_b64_tr_b16 v[104:105], v38 offset:0
    v_mfma_f32_16x16x32_bf16 v[172:175], v[84:87], v[124:127], v[172:175]
    ds_read_b64_tr_b16 v[106:107], v38 offset:16384
    ds_read_b64_tr_b16 v[108:109], v39 offset:0
    v_mfma_f32_16x16x32_bf16 v[164:167], v[80:83], v[128:131], v[164:167]
    ds_read_b64_tr_b16 v[110:111], v39 offset:16384
    v_mfma_f32_16x16x32_bf16 v[176:179], v[84:87], v[128:131], v[176:179]
    v_mfma_f32_16x16x32_bf16 v[168:171], v[80:83], v[132:135], v[168:171]
    v_mfma_f32_16x16x32_bf16 v[180:183], v[84:87], v[132:135], v[180:183]
    s_waitcnt lgkmcnt(5)
    v_mfma_f32_16x16x32_bf16 v[184:187], v[88:91], v[124:127], v[184:187]
    v_mfma_f32_16x16x32_bf16 v[188:191], v[88:91], v[128:131], v[188:191]
    v_mfma_f32_16x16x32_bf16 v[192:195], v[88:91], v[132:135], v[192:195]
    s_waitcnt lgkmcnt(3)
    v_min_u32_dpp v0, v0, v0 quad_perm:[1,0,3,2] row_mask:0xf bank_mask:0xf
    v_mfma_f32_16x16x32_bf16 v[196:199], v[92:95], v[124:127], v[196:199]
    v_mfma_f32_16x16x32_bf16 v[200:203], v[92:95], v[128:131], v[200:203]
    s_waitcnt lgkmcnt(0)
    v_min_u32_dpp v0, v0, v0 quad_perm:[2,3,0,1] row_mask:0xf bank_mask:0xf
    s_barrier
    v_mfma_f32_16x16x32_bf16 v[204:207], v[92:95], v[132:135], v[204:207]
    v_readfirstlane_b32 s86, v0
    v_mfma_f32_16x16x32_bf16 v[208:211], v[96:99], v[124:127], v[208:211]
    s_add_u32 s85, s85, 1
    s_nop 1
    s_cmp_ge_u32 s86, s85
    s_cbranch_scc0 .Lck_55_s
.Lck_55:
    ds_read_b128 v[112:115], v8 offset:16384
    v_mfma_f32_16x16x32_bf16 v[212:215], v[96:99], v[128:131], v[212:215]
    ds_read_b64_tr_b16 v[64:65], v24 offset:0
    ds_read_b64_tr_b16 v[66:67], v24 offset:16384
    v_mfma_f32_16x16x32_bf16 v[216:219], v[96:99], v[132:135], v[216:219]
    ds_read_b64_tr_b16 v[68:69], v25 offset:0
    ds_read_b64_tr_b16 v[70:71], v25 offset:16384
    v_mfma_f32_16x16x32_bf16 v[220:223], v[100:103], v[124:127], v[220:223]
    ds_read_b128 v[116:119], v8 offset:20480
    ds_read_b128 v[120:123], v8 offset:26624
    v_mfma_f32_16x16x32_bf16 v[224:227], v[100:103], v[128:131], v[224:227]
    ds_read_b64_tr_b16 v[72:73], v26 offset:0
    ds_read_b64_tr_b16 v[74:75], v26 offset:16384
    v_mfma_f32_16x16x32_bf16 v[228:231], v[100:103], v[132:135], v[228:231]
    ds_read_b64_tr_b16 v[76:77], v27 offset:0
    ds_read_b64_tr_b16 v[78:79], v27 offset:16384
    v_mfma_f32_16x16x32_bf16 v[232:235], v[104:107], v[124:127], v[232:235]
    ds_read_b64_tr_b16 v[80:81], v28 offset:0
    ds_read_b64_tr_b16 v[82:83], v28 offset:16384
    v_mfma_f32_16x16x32_bf16 v[244:247], v[108:111], v[124:127], v[244:247]
    ds_read_b64_tr_b16 v[84:85], v29 offset:0
    ds_read_b64_tr_b16 v[86:87], v29 offset:16384
    v_mfma_f32_16x16x32_bf16 v[236:239], v[104:107], v[128:131], v[236:239]
    v_mfma_f32_16x16x32_bf16 v[248:251], v[108:111], v[128:131], v[248:251]
    v_mfma_f32_16x16x32_bf16 v[240:243], v[104:107], v[132:135], v[240:243]
    v_mfma_f32_16x16x32_bf16 v[252:255], v[108:111], v[132:135], v[252:255]
    s_waitcnt lgkmcnt(8)
    v_mfma_f32_16x16x32_bf16 v[160:163], v[64:67], v[112:115], v[160:163]
    ds_read_b32 v0, v1
    ds_read_b64_tr_b16 v[88:89], v30 offset:0
    v_mfma_f32_16x16x32_bf16 v[172:175], v[68:71], v[112:115], v[172:175]
    ds_read_b64_tr_b16 v[90:91], v30 offset:16384
    ds_read_b64_tr_b16 v[92:93], v31 offset:0
    v_mfma_f32_16x16x32_bf16 v[164:167], v[64:67], v[116:119], v[164:167]
    ds_read_b64_tr_b16 v[94:95], v31 offset:16384
    v_mfma_f32_16x16x32_bf16 v[176:179], v[68:71], v[116:119], v[176:179]
    v_mfma_f32_16x16x32_bf16 v[168:171], v[64:67], v[120:123], v[168:171]
    v_mfma_f32_16x16x32_bf16 v[180:183], v[68:71], v[120:123], v[180:183]
    s_waitcnt lgkmcnt(5)
    v_mfma_f32_16x16x32_bf16 v[184:187], v[72:75], v[112:115], v[184:187]
    v_mfma_f32_16x16x32_bf16 v[188:191], v[72:75], v[116:119], v[188:191]
    v_mfma_f32_16x16x32_bf16 v[192:195], v[72:75], v[120:123], v[192:195]
    s_waitcnt lgkmcnt(3)
    v_min_u32_dpp v0, v0, v0 quad_perm:[1,0,3,2] row_mask:0xf bank_mask:0xf
    v_mfma_f32_16x16x32_bf16 v[196:199], v[76:79], v[112:115], v[196:199]
    v_mfma_f32_16x16x32_bf16 v[200:203], v[76:79], v[116:119], v[200:203]
    s_waitcnt lgkmcnt(0)
    v_min_u32_dpp v0, v0, v0 quad_perm:[2,3,0,1] row_mask:0xf bank_mask:0xf
    s_barrier
    v_mfma_f32_16x16x32_bf16 v[204:207], v[76:79], v[120:123], v[204:207]
    v_readfirstlane_b32 s86, v0
    v_mfma_f32_16x16x32_bf16 v[208:211], v[80:83], v[112:115], v[208:211]
    s_add_u32 s85, s85, 1
    s_nop 1
    s_cmp_ge_u32 s86, s85
    s_cbranch_scc0 .Lck_56_s
.Lck_56:
    ds_read_b128 v[124:127], v8 offset:17408
    v_mfma_f32_16x16x32_bf16 v[212:215], v[80:83], v[116:119], v[212:215]
    ds_read_b64_tr_b16 v[96:97], v24 offset:32768
    ds_read_b64_tr_b16 v[98:99], v24 offset:49152
    v_mfma_f32_16x16x32_bf16 v[216:219], v[80:83], v[120:123], v[216:219]
    ds_read_b64_tr_b16 v[100:101], v25 offset:32768
    ds_read_b64_tr_b16 v[102:103], v25 offset:49152
    v_mfma_f32_16x16x32_bf16 v[220:223], v[84:87], v[112:115], v[220:223]
    ds_read_b128 v[128:131], v8 offset:21504
    ds_read_b128 v[132:135], v8 offset:27648
    v_mfma_f32_16x16x32_bf16 v[224:227], v[84:87], v[116:119], v[224:227]
    ds_read_b64_tr_b16 v[104:105], v26 offset:32768
    ds_read_b64_tr_b16 v[106:107], v26 offset:49152
    v_mfma_f32_16x16x32_bf16 v[228:231], v[84:87], v[120:123], v[228:231]
    ds_read_b64_tr_b16 v[108:109], v27 offset:32768
    ds_read_b64_tr_b16 v[110:111], v27 offset:49152
    v_mfma_f32_16x16x32_bf16 v[232:235], v[88:91], v[112:115], v[232:235]
    ds_read_b64_tr_b16 v[64:65], v28 offset:32768
    ds_read_b64_tr_b16 v[66:67], v28 offset:49152
    v_mfma_f32_16x16x32_bf16 v[244:247], v[92:95], v[112:115], v[244:247]
    ds_read_b64_tr_b16 v[68:69], v29 offset:32768
    ds_read_b64_tr_b16 v[70:71], v29 offset:49152
    v_mfma_f32_16x16x32_bf16 v[236:239], v[88:91], v[116:119], v[236:239]
    v_mfma_f32_16x16x32_bf16 v[248:251], v[92:95], v[116:119], v[248:251]
    v_mfma_f32_16x16x32_bf16 v[240:243], v[88:91], v[120:123], v[240:243]
    v_mfma_f32_16x16x32_bf16 v[252:255], v[92:95], v[120:123], v[252:255]
    s_waitcnt lgkmcnt(8)
    v_mfma_f32_16x16x32_bf16 v[160:163], v[96:99], v[124:127], v[160:163]
    ds_read_b32 v0, v1
    ds_read_b64_tr_b16 v[72:73], v30 offset:32768
    v_mfma_f32_16x16x32_bf16 v[172:175], v[100:103], v[124:127], v[172:175]
    ds_read_b64_tr_b16 v[74:75], v30 offset:49152
    ds_read_b64_tr_b16 v[76:77], v31 offset:32768
    v_mfma_f32_16x16x32_bf16 v[164:167], v[96:99], v[128:131], v[164:167]
    ds_read_b64_tr_b16 v[78:79], v31 offset:49152
    v_mfma_f32_16x16x32_bf16 v[176:179], v[100:103], v[128:131], v[176:179]
    v_mfma_f32_16x16x32_bf16 v[168:171], v[96:99], v[132:135], v[168:171]
    v_mfma_f32_16x16x32_bf16 v[180:183], v[100:103], v[132:135], v[180:183]
    s_waitcnt lgkmcnt(5)
    v_mfma_f32_16x16x32_bf16 v[184:187], v[104:107], v[124:127], v[184:187]
    v_mfma_f32_16x16x32_bf16 v[188:191], v[104:107], v[128:131], v[188:191]
    v_mfma_f32_16x16x32_bf16 v[192:195], v[104:107], v[132:135], v[192:195]
    s_waitcnt lgkmcnt(3)
    v_min_u32_dpp v0, v0, v0 quad_perm:[1,0,3,2] row_mask:0xf bank_mask:0xf
    v_mfma_f32_16x16x32_bf16 v[196:199], v[108:111], v[124:127], v[196:199]
    v_mfma_f32_16x16x32_bf16 v[200:203], v[108:111], v[128:131], v[200:203]
    s_waitcnt lgkmcnt(0)
    v_min_u32_dpp v0, v0, v0 quad_perm:[2,3,0,1] row_mask:0xf bank_mask:0xf
    v_mfma_f32_16x16x32_bf16 v[204:207], v[108:111], v[132:135], v[204:207]
    v_readfirstlane_b32 s86, v0
    v_mfma_f32_16x16x32_bf16 v[208:211], v[64:67], v[124:127], v[208:211]
    s_add_u32 s85, s85, 1
    s_nop 1
    s_cmp_ge_u32 s86, s85
    s_cbranch_scc0 .Lck_57_s
.Lck_57:
    ds_read_b128 v[112:115], v8 offset:18432
    v_mfma_f32_16x16x32_bf16 v[212:215], v[64:67], v[128:131], v[212:215]
    ds_read_b64_tr_b16 v[80:81], v32 offset:0
    ds_read_b64_tr_b16 v[82:83], v32 offset:16384
    v_mfma_f32_16x16x32_bf16 v[216:219], v[64:67], v[132:135], v[216:219]
    ds_read_b64_tr_b16 v[84:85], v33 offset:0
    ds_read_b64_tr_b16 v[86:87], v33 offset:16384
    v_mfma_f32_16x16x32_bf16 v[220:223], v[68:71], v[124:127], v[220:223]
    ds_read_b128 v[116:119], v8 offset:24576
    ds_read_b128 v[120:123], v8 offset:28672
    v_mfma_f32_16x16x32_bf16 v[224:227], v[68:71], v[128:131], v[224:227]
    ds_read_b64_tr_b16 v[88:89], v34 offset:0
    ds_read_b64_tr_b16 v[90:91], v34 offset:16384
    v_mfma_f32_16x16x32_bf16 v[228:231], v[68:71], v[132:135], v[228:231]
    ds_read_b64_tr_b16 v[92:93], v35 offset:0
    ds_read_b64_tr_b16 v[94:95], v35 offset:16384
    v_mfma_f32_16x16x32_bf16 v[232:235], v[72:75], v[124:127], v[232:235]
    ds_read_b64_tr_b16 v[96:97], v36 offset:0
    ds_read_b64_tr_b16 v[98:99], v36 offset:16384
    v_mfma_f32_16x16x32_bf16 v[244:247], v[76:79], v[124:127], v[244:247]
    ds_read_b64_tr_b16 v[100:101], v37 offset:0
    ds_read_b64_tr_b16 v[102:103], v37 offset:16384
    v_mfma_f32_16x16x32_bf16 v[236:239], v[72:75], v[128:131], v[236:239]
    v_mfma_f32_16x16x32_bf16 v[248:251], v[76:79], v[128:131], v[248:251]
    v_mfma_f32_16x16x32_bf16 v[240:243], v[72:75], v[132:135], v[240:243]
    v_mfma_f32_16x16x32_bf16 v[252:255], v[76:79], v[132:135], v[252:255]
    s_waitcnt lgkmcnt(8)
    v_mfma_f32_16x16x32_bf16 v[160:163], v[80:83], v[112:115], v[160:163]
    ds_read_b32 v0, v1
    ds_read_b64_tr_b16 v[104:105], v38 offset:0
    v_mfma_f32_16x16x32_bf16 v[172:175], v[84:87], v[112:115], v[172:175]
    ds_read_b64_tr_b16 v[106:107], v38 offset:16384
    ds_read_b64_tr_b16 v[108:109], v39 offset:0
    v_mfma_f32_16x16x32_bf16 v[164:167], v[80:83], v[116:119], v[164:167]
    ds_read_b64_tr_b16 v[110:111], v39 offset:16384
    v_mfma_f32_16x16x32_bf16 v[176:179], v[84:87], v[116:119], v[176:179]
    v_mfma_f32_16x16x32_bf16 v[168:171], v[80:83], v[120:123], v[168:171]
    v_mfma_f32_16x16x32_bf16 v[180:183], v[84:87], v[120:123], v[180:183]
    s_waitcnt lgkmcnt(5)
    v_mfma_f32_16x16x32_bf16 v[184:187], v[88:91], v[112:115], v[184:187]
    v_mfma_f32_16x16x32_bf16 v[188:191], v[88:91], v[116:119], v[188:191]
    v_mfma_f32_16x16x32_bf16 v[192:195], v[88:91], v[120:123], v[192:195]
    s_waitcnt lgkmcnt(3)
    v_min_u32_dpp v0, v0, v0 quad_perm:[1,0,3,2] row_mask:0xf bank_mask:0xf
    v_mfma_f32_16x16x32_bf16 v[196:199], v[92:95], v[112:115], v[196:199]
    v_mfma_f32_16x16x32_bf16 v[200:203], v[92:95], v[116:119], v[200:203]
    s_waitcnt lgkmcnt(0)
    v_min_u32_dpp v0, v0, v0 quad_perm:[2,3,0,1] row_mask:0xf bank_mask:0xf
    v_mfma_f32_16x16x32_bf16 v[204:207], v[92:95], v[120:123], v[204:207]
    v_readfirstlane_b32 s86, v0
    v_mfma_f32_16x16x32_bf16 v[208:211], v[96:99], v[112:115], v[208:211]
    s_add_u32 s85, s85, 1
    s_nop 1
    s_cmp_ge_u32 s86, s85
    s_cbranch_scc0 .Lck_58_s
.Lck_58:
    ds_read_b128 v[124:127], v8 offset:19456
    v_mfma_f32_16x16x32_bf16 v[212:215], v[96:99], v[116:119], v[212:215]
    ds_read_b64_tr_b16 v[64:65], v24 offset:0
    ds_read_b64_tr_b16 v[66:67], v24 offset:16384
    v_mfma_f32_16x16x32_bf16 v[216:219], v[96:99], v[120:123], v[216:219]
    ds_read_b64_tr_b16 v[68:69], v25 offset:0
    ds_read_b64_tr_b16 v[70:71], v25 offset:16384
    v_mfma_f32_16x16x32_bf16 v[220:223], v[100:103], v[112:115], v[220:223]
    ds_read_b128 v[128:131], v8 offset:25600
    ds_read_b128 v[132:135], v8 offset:29696
    v_mfma_f32_16x16x32_bf16 v[224:227], v[100:103], v[116:119], v[224:227]
    ds_read_b64_tr_b16 v[72:73], v26 offset:0
    ds_read_b64_tr_b16 v[74:75], v26 offset:16384
    v_mfma_f32_16x16x32_bf16 v[228:231], v[100:103], v[120:123], v[228:231]
    ds_read_b64_tr_b16 v[76:77], v27 offset:0
    ds_read_b64_tr_b16 v[78:79], v27 offset:16384
    v_mfma_f32_16x16x32_bf16 v[232:235], v[104:107], v[112:115], v[232:235]
    ds_read_b64_tr_b16 v[80:81], v28 offset:0
    ds_read_b64_tr_b16 v[82:83], v28 offset:16384
    v_mfma_f32_16x16x32_bf16 v[244:247], v[108:111], v[112:115], v[244:247]
    ds_read_b64_tr_b16 v[84:85], v29 offset:0
    ds_read_b64_tr_b16 v[86:87], v29 offset:16384
    v_mfma_f32_16x16x32_bf16 v[236:239], v[104:107], v[116:119], v[236:239]
    v_mfma_f32_16x16x32_bf16 v[248:251], v[108:111], v[116:119], v[248:251]
    v_mfma_f32_16x16x32_bf16 v[240:243], v[104:107], v[120:123], v[240:243]
    v_mfma_f32_16x16x32_bf16 v[252:255], v[108:111], v[120:123], v[252:255]
    s_waitcnt lgkmcnt(8)
    v_mfma_f32_16x16x32_bf16 v[160:163], v[64:67], v[124:127], v[160:163]
    ds_read_b64_tr_b16 v[88:89], v30 offset:0
    ds_read_b64_tr_b16 v[90:91], v30 offset:16384
    v_mfma_f32_16x16x32_bf16 v[172:175], v[68:71], v[124:127], v[172:175]
    ds_read_b64_tr_b16 v[92:93], v31 offset:0
    ds_read_b64_tr_b16 v[94:95], v31 offset:16384
    v_mfma_f32_16x16x32_bf16 v[164:167], v[64:67], v[128:131], v[164:167]
    v_mfma_f32_16x16x32_bf16 v[176:179], v[68:71], v[128:131], v[176:179]
    v_mfma_f32_16x16x32_bf16 v[168:171], v[64:67], v[132:135], v[168:171]
    v_mfma_f32_16x16x32_bf16 v[180:183], v[68:71], v[132:135], v[180:183]
    s_waitcnt lgkmcnt(4)
    v_mfma_f32_16x16x32_bf16 v[184:187], v[72:75], v[124:127], v[184:187]
    v_mfma_f32_16x16x32_bf16 v[188:191], v[72:75], v[128:131], v[188:191]
    v_mfma_f32_16x16x32_bf16 v[192:195], v[72:75], v[132:135], v[192:195]
    v_mfma_f32_16x16x32_bf16 v[196:199], v[76:79], v[124:127], v[196:199]
    s_waitcnt lgkmcnt(0)
    v_mfma_f32_16x16x32_bf16 v[200:203], v[76:79], v[128:131], v[200:203]
    v_mfma_f32_16x16x32_bf16 v[204:207], v[76:79], v[132:135], v[204:207]
    v_mfma_f32_16x16x32_bf16 v[208:211], v[80:83], v[124:127], v[208:211]
    v_mfma_f32_16x16x32_bf16 v[212:215], v[80:83], v[128:131], v[212:215]
    v_mfma_f32_16x16x32_bf16 v[216:219], v[80:83], v[132:135], v[216:219]
    v_mfma_f32_16x16x32_bf16 v[220:223], v[84:87], v[124:127], v[220:223]
    v_mfma_f32_16x16x32_bf16 v[224:227], v[84:87], v[128:131], v[224:227]
    v_mfma_f32_16x16x32_bf16 v[228:231], v[84:87], v[132:135], v[228:231]
    v_mfma_f32_16x16x32_bf16 v[232:235], v[88:91], v[124:127], v[232:235]
    v_mfma_f32_16x16x32_bf16 v[244:247], v[92:95], v[124:127], v[244:247]
    v_mfma_f32_16x16x32_bf16 v[236:239], v[88:91], v[128:131], v[236:239]
    v_mfma_f32_16x16x32_bf16 v[248:251], v[92:95], v[128:131], v[248:251]
    v_mfma_f32_16x16x32_bf16 v[240:243], v[88:91], v[132:135], v[240:243]
    v_mfma_f32_16x16x32_bf16 v[252:255], v[92:95], v[132:135], v[252:255]
    v_cvt_pk_bf16_f32 v160, v160, v161
    v_cvt_pk_bf16_f32 v161, v162, v163
    v_cvt_pk_bf16_f32 v162, v172, v173
    v_cvt_pk_bf16_f32 v163, v174, v175
    buffer_store_dwordx4 v[160:163], v2, s[32:35], s16 offen offset:0 sc1
    v_cvt_pk_bf16_f32 v164, v164, v165
    v_cvt_pk_bf16_f32 v165, v166, v167
    v_cvt_pk_bf16_f32 v166, v176, v177
    v_cvt_pk_bf16_f32 v167, v178, v179
    buffer_store_dwordx4 v[164:167], v2, s[32:35], s17 offen offset:0 sc1
    v_cvt_pk_bf16_f32 v168, v168, v169
    v_cvt_pk_bf16_f32 v169, v170, v171
    v_cvt_pk_bf16_f32 v170, v180, v181
    v_cvt_pk_bf16_f32 v171, v182, v183
    buffer_store_dwordx4 v[168:171], v2, s[32:35], s18 offen offset:0 sc1
    v_cvt_pk_bf16_f32 v184, v184, v185
    v_cvt_pk_bf16_f32 v185, v186, v187
    v_cvt_pk_bf16_f32 v186, v196, v197
    v_cvt_pk_bf16_f32 v187, v198, v199
    buffer_store_dwordx4 v[184:187], v2, s[32:35], s16 offen offset:1024 sc1
    v_cvt_pk_bf16_f32 v188, v188, v189
    v_cvt_pk_bf16_f32 v189, v190, v191
    v_cvt_pk_bf16_f32 v190, v200, v201
    v_cvt_pk_bf16_f32 v191, v202, v203
    buffer_store_dwordx4 v[188:191], v2, s[32:35], s17 offen offset:1024 sc1
    v_cvt_pk_bf16_f32 v192, v192, v193
    v_cvt_pk_bf16_f32 v193, v194, v195
    v_cvt_pk_bf16_f32 v194, v204, v205
    v_cvt_pk_bf16_f32 v195, v206, v207
    buffer_store_dwordx4 v[192:195], v2, s[32:35], s18 offen offset:1024 sc1
    v_cvt_pk_bf16_f32 v208, v208, v209
    v_cvt_pk_bf16_f32 v209, v210, v211
    v_cvt_pk_bf16_f32 v210, v220, v221
    v_cvt_pk_bf16_f32 v211, v222, v223
    buffer_store_dwordx4 v[208:211], v2, s[32:35], s16 offen offset:2048 sc1
    v_cvt_pk_bf16_f32 v212, v212, v213
    v_cvt_pk_bf16_f32 v213, v214, v215
    v_cvt_pk_bf16_f32 v214, v224, v225
    v_cvt_pk_bf16_f32 v215, v226, v227
    buffer_store_dwordx4 v[212:215], v2, s[32:35], s17 offen offset:2048 sc1
    v_cvt_pk_bf16_f32 v216, v216, v217
    v_cvt_pk_bf16_f32 v217, v218, v219
    v_cvt_pk_bf16_f32 v218, v228, v229
    v_cvt_pk_bf16_f32 v219, v230, v231
    buffer_store_dwordx4 v[216:219], v2, s[32:35], s18 offen offset:2048 sc1
    v_cvt_pk_bf16_f32 v232, v232, v233
    v_cvt_pk_bf16_f32 v233, v234, v235
    v_cvt_pk_bf16_f32 v234, v244, v245
    v_cvt_pk_bf16_f32 v235, v246, v247
    buffer_store_dwordx4 v[232:235], v2, s[32:35], s16 offen offset:3072 sc1
    v_cvt_pk_bf16_f32 v236, v236, v237
    v_cvt_pk_bf16_f32 v237, v238, v239
    v_cvt_pk_bf16_f32 v238, v248, v249
    v_cvt_pk_bf16_f32 v239, v250, v251
    buffer_store_dwordx4 v[236:239], v2, s[32:35], s17 offen offset:3072 sc1
    v_cvt_pk_bf16_f32 v240, v240, v241
    v_cvt_pk_bf16_f32 v241, v242, v243
    v_cvt_pk_bf16_f32 v242, v252, v253
    v_cvt_pk_bf16_f32 v243, v254, v255
    buffer_store_dwordx4 v[240:243], v2, s[32:35], s18 offen offset:3072 sc1
.Lreduce:
    s_mov_b32 s32, s64
    s_mov_b32 s33, s65
    s_mov_b32 s34, 0x1200000
    s_mov_b32 s35, 0x20000
    s_mov_b32 s12, s60
    s_mov_b32 s13, s61
    s_mov_b32 s14, 0x180000
    s_mov_b32 s15, 0x20000
    v_and_b32 v3, 0xf0, v2
    v_lshlrev_b32 v3, 7, v3
    v_lshrrev_b32 v4, 8, v2
    v_lshl_add_u32 v3, v4, 4, v3
    s_mov_b32 s88, s7
    s_and_b32 s74, s6, s7
    s_lshl_b32 s89, s5, s7
    s_add_u32 s89, s89, s74
    s_cmp_lg_u32 s4, 4
    s_cbranch_scc1 .Lrd_join
    v_mov_b32 v38, 0
.Lrd_all:
    global_load_dword v39, v38, s[62:63] sc1
    s_waitcnt vmcnt(0)
    v_readfirstlane_b32 s83, v39
    s_nop 3
    s_cmp_ge_u32 s83, 256
    s_cbranch_scc1 .Lrd_join
    s_cmp_eq_u32 s82, 0
    s_cbranch_scc1 .Lrd_join
    s_sub_u32 s82, s82, 1
    s_sleep 32
    s_branch .Lrd_all
.Lrd_join:
    s_waitcnt vmcnt(0)
    s_barrier
    s_cmp_lg_u32 s4, 4
    s_cbranch_scc1 .Lrd_pass
    v_mov_b32 v37, 1
    s_lshl_b32 s3, s7, 4
    s_lshr_b32 s11, s6, s7
    s_add_u32 s3, s3, s11
    s_lshl_b32 s3, s3, 11
    s_add_u32 s3, s3, 0x1200000
    s_and_b32 s74, s6, s7
    s_lshl_b32 s11, s5, s7
    s_add_u32 s11, s11, s74
    s_lshl_b32 s11, s11, 2
    s_add_u32 s3, s3, s11
    v_lshl_add_u32 v36, v2, 3, s3
    s_mov_b64 exec, 0x1
    global_store_dword v36, v37, s[64:65] sc1
    s_mov_b64 exec, -1
.Lrd_pass:
    s_lshr_b32 s90, 6, s88
    s_mul_i32 s68, s89, s90
    s_add_u32 s68, s68, s4
    s_andn2_b32 s10, s6, s88
    s_cmp_ge_u32 s68, 48
    s_addc_u32 s10, s10, 0
    s_cmp_ge_u32 s68, 48
    s_cselect_b32 s3, 48, 0
    s_sub_u32 s68, s68, s3
    s_lshr_b32 s3, s68, 2
    s_mul_i32 s69, s3, 43691
    s_lshr_b32 s69, s69, 17
    s_mul_i32 s72, s69, 3
    s_sub_u32 s72, s3, s72
    s_mul_i32 s73, s10, 48
    s_lshl_b32 s72, s72, 4
    s_add_u32 s73, s73, s72
    s_lshl_b32 s73, s73, 11
    s_lshl_b32 s69, s69, 8
    s_add_u32 s73, s73, s69
    s_and_b32 s3, s68, 3
    s_lshl_b32 s3, s3, 6
    s_add_u32 s73, s73, s3
    s_lshl_b32 s3, s88, 10
    s_add_u32 s73, s73, s3
    s_lshl_b32 s3, s10, s88
    s_lshl_b32 s11, s88, 4
    s_add_u32 s3, s3, s11
    s_mul_i32 s66, s3, 393216
    s_lshl_b32 s11, s68, 10
    s_add_u32 s66, s66, s11
    s_cmp_lg_u32 s4, 4
    s_cbranch_scc1 .Lrd_sync
    s_lshl_b32 s3, s88, 4
    s_lshr_b32 s11, s6, s88
    s_add_u32 s3, s3, s11
    s_lshl_b32 s3, s3, 11
    s_add_u32 s3, s3, 0x1200000
    s_and_b32 s11, s89, 0
    s_lshl_b32 s11, s11, 7
    s_add_u32 s3, s3, s11
    v_lshrrev_b32 v36, 2, v2
    s_lshl_b32 s11, s88, 5
    s_or_b32 s11, s11, 28
    v_and_b32 v36, s11, v36
    v_add_u32 v36, s3, v36
.Lrd_poll:
    global_load_dword v37, v36, s[64:65] sc1
    s_waitcnt vmcnt(0)
    v_cmp_ne_u32 vcc, 1, v37
    s_nop 4
    s_cbranch_vccz .Lrd_sync
    s_bcnt1_i32_b64 s3, vcc
    s_cmp_le_u32 s3, 24
    s_cbranch_scc1 .Lrd_soon
    s_sleep 24
.Lrd_soon:
    s_cmp_eq_u32 s82, 0
    s_cbranch_scc1 .Lrd_sync
    s_sub_u32 s82, s82, 1
    s_sleep 4
    s_branch .Lrd_poll
.Lrd_sync:
    s_barrier
    s_cmp_ge_u32 s4, s90
    s_cbranch_scc1 .Lrd_next
    buffer_load_dwordx4 v[64:67], v2, s[32:35], s66 offen sc1
    s_add_u32 s66, s66, 49152
    buffer_load_dwordx4 v[68:71], v2, s[32:35], s66 offen sc1
    s_add_u32 s66, s66, 49152
    buffer_load_dwordx4 v[72:75], v2, s[32:35], s66 offen sc1
    s_add_u32 s66, s66, 49152
    buffer_load_dwordx4 v[76:79], v2, s[32:35], s66 offen sc1
    s_add_u32 s66, s66, 49152
    buffer_load_dwordx4 v[80:83], v2, s[32:35], s66 offen sc1
    s_add_u32 s66, s66, 49152
    buffer_load_dwordx4 v[84:87], v2, s[32:35], s66 offen sc1
    s_add_u32 s66, s66, 49152
    buffer_load_dwordx4 v[88:91], v2, s[32:35], s66 offen sc1
    s_add_u32 s66, s66, 49152
    buffer_load_dwordx4 v[92:95], v2, s[32:35], s66 offen sc1
    s_add_u32 s66, s66, 49152
    v_mov_b32 v40, 0
    v_mov_b32 v41, 0
    v_mov_b32 v42, 0
    v_mov_b32 v43, 0
    v_mov_b32 v44, 0
    v_mov_b32 v45, 0
    v_mov_b32 v46, 0
    v_mov_b32 v47, 0
    s_cmp_eq_u32 s88, 0
    s_cbranch_scc1 .Lrd_eight
    buffer_load_dwordx4 v[96:99], v2, s[32:35], s66 offen sc1
    s_add_u32 s66, s66, 49152
    buffer_load_dwordx4 v[100:103], v2, s[32:35], s66 offen sc1
    s_add_u32 s66, s66, 49152
    buffer_load_dwordx4 v[104:107], v2, s[32:35], s66 offen sc1
    s_add_u32 s66, s66, 49152
    buffer_load_dwordx4 v[108:111], v2, s[32:35], s66 offen sc1
    s_add_u32 s66, s66, 49152
    buffer_load_dwordx4 v[112:115], v2, s[32:35], s66 offen sc1
    s_add_u32 s66, s66, 49152
    buffer_load_dwordx4 v[116:119], v2, s[32:35], s66 offen sc1
    s_add_u32 s66, s66, 49152
    buffer_load_dwordx4 v[120:123], v2, s[32:35], s66 offen sc1
    s_add_u32 s66, s66, 49152
    buffer_load_dwordx4 v[124:127], v2, s[32:35], s66 offen sc1
    s_add_u32 s66, s66, 49152
    s_waitcnt vmcnt(15)
    v_lshlrev_b32 v38, 16, v64
    v_and_b32 v39, 0xffff0000, v64
    v_pk_add_f32 v[40:41], v[40:41], v[38:39]
    v_lshlrev_b32 v38, 16, v65
    v_and_b32 v39, 0xffff0000, v65
    v_pk_add_f32 v[42:43], v[42:43], v[38:39]
    v_lshlrev_b32 v38, 16, v66
    v_and_b32 v39, 0xffff0000, v66
    v_pk_add_f32 v[44:45], v[44:45], v[38:39]
    v_lshlrev_b32 v38, 16, v67
    v_and_b32 v39, 0xffff0000, v67
    v_pk_add_f32 v[46:47], v[46:47], v[38:39]
    s_waitcnt vmcnt(14)
    v_lshlrev_b32 v38, 16, v68
    v_and_b32 v39, 0xffff0000, v68
    v_pk_add_f32 v[40:41], v[40:41], v[38:39]
    v_lshlrev_b32 v38, 16, v69
    v_and_b32 v39, 0xffff0000, v69
    v_pk_add_f32 v[42:43], v[42:43], v[38:39]
    v_lshlrev_b32 v38, 16, v70
    v_and_b32 v39, 0xffff0000, v70
    v_pk_add_f32 v[44:45], v[44:45], v[38:39]
    v_lshlrev_b32 v38, 16, v71
    v_and_b32 v39, 0xffff0000, v71
    v_pk_add_f32 v[46:47], v[46:47], v[38:39]
    s_waitcnt vmcnt(13)
    v_lshlrev_b32 v38, 16, v72
    v_and_b32 v39, 0xffff0000, v72
    v_pk_add_f32 v[40:41], v[40:41], v[38:39]
    v_lshlrev_b32 v38, 16, v73
    v_and_b32 v39, 0xffff0000, v73
    v_pk_add_f32 v[42:43], v[42:43], v[38:39]
    v_lshlrev_b32 v38, 16, v74
    v_and_b32 v39, 0xffff0000, v74
    v_pk_add_f32 v[44:45], v[44:45], v[38:39]
    v_lshlrev_b32 v38, 16, v75
    v_and_b32 v39, 0xffff0000, v75
    v_pk_add_f32 v[46:47], v[46:47], v[38:39]
    s_waitcnt vmcnt(12)
    v_lshlrev_b32 v38, 16, v76
    v_and_b32 v39, 0xffff0000, v76
    v_pk_add_f32 v[40:41], v[40:41], v[38:39]
    v_lshlrev_b32 v38, 16, v77
    v_and_b32 v39, 0xffff0000, v77
    v_pk_add_f32 v[42:43], v[42:43], v[38:39]
    v_lshlrev_b32 v38, 16, v78
    v_and_b32 v39, 0xffff0000, v78
    v_pk_add_f32 v[44:45], v[44:45], v[38:39]
    v_lshlrev_b32 v38, 16, v79
    v_and_b32 v39, 0xffff0000, v79
    v_pk_add_f32 v[46:47], v[46:47], v[38:39]
    s_waitcnt vmcnt(11)
    v_lshlrev_b32 v38, 16, v80
    v_and_b32 v39, 0xffff0000, v80
    v_pk_add_f32 v[40:41], v[40:41], v[38:39]
    v_lshlrev_b32 v38, 16, v81
    v_and_b32 v39, 0xffff0000, v81
    v_pk_add_f32 v[42:43], v[42:43], v[38:39]
    v_lshlrev_b32 v38, 16, v82
    v_and_b32 v39, 0xffff0000, v82
    v_pk_add_f32 v[44:45], v[44:45], v[38:39]
    v_lshlrev_b32 v38, 16, v83
    v_and_b32 v39, 0xffff0000, v83
    v_pk_add_f32 v[46:47], v[46:47], v[38:39]
    s_waitcnt vmcnt(10)
    v_lshlrev_b32 v38, 16, v84
    v_and_b32 v39, 0xffff0000, v84
    v_pk_add_f32 v[40:41], v[40:41], v[38:39]
    v_lshlrev_b32 v38, 16, v85
    v_and_b32 v39, 0xffff0000, v85
    v_pk_add_f32 v[42:43], v[42:43], v[38:39]
    v_lshlrev_b32 v38, 16, v86
    v_and_b32 v39, 0xffff0000, v86
    v_pk_add_f32 v[44:45], v[44:45], v[38:39]
    v_lshlrev_b32 v38, 16, v87
    v_and_b32 v39, 0xffff0000, v87
    v_pk_add_f32 v[46:47], v[46:47], v[38:39]
    s_waitcnt vmcnt(9)
    v_lshlrev_b32 v38, 16, v88
    v_and_b32 v39, 0xffff0000, v88
    v_pk_add_f32 v[40:41], v[40:41], v[38:39]
    v_lshlrev_b32 v38, 16, v89
    v_and_b32 v39, 0xffff0000, v89
    v_pk_add_f32 v[42:43], v[42:43], v[38:39]
    v_lshlrev_b32 v38, 16, v90
    v_and_b32 v39, 0xffff0000, v90
    v_pk_add_f32 v[44:45], v[44:45], v[38:39]
    v_lshlrev_b32 v38, 16, v91
    v_and_b32 v39, 0xffff0000, v91
    v_pk_add_f32 v[46:47], v[46:47], v[38:39]
    s_waitcnt vmcnt(8)
    v_lshlrev_b32 v38, 16, v92
    v_and_b32 v39, 0xffff0000, v92
    v_pk_add_f32 v[40:41], v[40:41], v[38:39]
    v_lshlrev_b32 v38, 16, v93
    v_and_b32 v39, 0xffff0000, v93
    v_pk_add_f32 v[42:43], v[42:43], v[38:39]
    v_lshlrev_b32 v38, 16, v94
    v_and_b32 v39, 0xffff0000, v94
    v_pk_add_f32 v[44:45], v[44:45], v[38:39]
    v_lshlrev_b32 v38, 16, v95
    v_and_b32 v39, 0xffff0000, v95
    v_pk_add_f32 v[46:47], v[46:47], v[38:39]
    s_waitcnt vmcnt(7)
    v_lshlrev_b32 v38, 16, v96
    v_and_b32 v39, 0xffff0000, v96
    v_pk_add_f32 v[40:41], v[40:41], v[38:39]
    v_lshlrev_b32 v38, 16, v97
    v_and_b32 v39, 0xffff0000, v97
    v_pk_add_f32 v[42:43], v[42:43], v[38:39]
    v_lshlrev_b32 v38, 16, v98
    v_and_b32 v39, 0xffff0000, v98
    v_pk_add_f32 v[44:45], v[44:45], v[38:39]
    v_lshlrev_b32 v38, 16, v99
    v_and_b32 v39, 0xffff0000, v99
    v_pk_add_f32 v[46:47], v[46:47], v[38:39]
    s_waitcnt vmcnt(6)
    v_lshlrev_b32 v38, 16, v100
    v_and_b32 v39, 0xffff0000, v100
    v_pk_add_f32 v[40:41], v[40:41], v[38:39]
    v_lshlrev_b32 v38, 16, v101
    v_and_b32 v39, 0xffff0000, v101
    v_pk_add_f32 v[42:43], v[42:43], v[38:39]
    v_lshlrev_b32 v38, 16, v102
    v_and_b32 v39, 0xffff0000, v102
    v_pk_add_f32 v[44:45], v[44:45], v[38:39]
    v_lshlrev_b32 v38, 16, v103
    v_and_b32 v39, 0xffff0000, v103
    v_pk_add_f32 v[46:47], v[46:47], v[38:39]
    s_waitcnt vmcnt(5)
    v_lshlrev_b32 v38, 16, v104
    v_and_b32 v39, 0xffff0000, v104
    v_pk_add_f32 v[40:41], v[40:41], v[38:39]
    v_lshlrev_b32 v38, 16, v105
    v_and_b32 v39, 0xffff0000, v105
    v_pk_add_f32 v[42:43], v[42:43], v[38:39]
    v_lshlrev_b32 v38, 16, v106
    v_and_b32 v39, 0xffff0000, v106
    v_pk_add_f32 v[44:45], v[44:45], v[38:39]
    v_lshlrev_b32 v38, 16, v107
    v_and_b32 v39, 0xffff0000, v107
    v_pk_add_f32 v[46:47], v[46:47], v[38:39]
    s_waitcnt vmcnt(4)
    v_lshlrev_b32 v38, 16, v108
    v_and_b32 v39, 0xffff0000, v108
    v_pk_add_f32 v[40:41], v[40:41], v[38:39]
    v_lshlrev_b32 v38, 16, v109
    v_and_b32 v39, 0xffff0000, v109
    v_pk_add_f32 v[42:43], v[42:43], v[38:39]
    v_lshlrev_b32 v38, 16, v110
    v_and_b32 v39, 0xffff0000, v110
    v_pk_add_f32 v[44:45], v[44:45], v[38:39]
    v_lshlrev_b32 v38, 16, v111
    v_and_b32 v39, 0xffff0000, v111
    v_pk_add_f32 v[46:47], v[46:47], v[38:39]
    s_waitcnt vmcnt(3)
    v_lshlrev_b32 v38, 16, v112
    v_and_b32 v39, 0xffff0000, v112
    v_pk_add_f32 v[40:41], v[40:41], v[38:39]
    v_lshlrev_b32 v38, 16, v113
    v_and_b32 v39, 0xffff0000, v113
    v_pk_add_f32 v[42:43], v[42:43], v[38:39]
    v_lshlrev_b32 v38, 16, v114
    v_and_b32 v39, 0xffff0000, v114
    v_pk_add_f32 v[44:45], v[44:45], v[38:39]
    v_lshlrev_b32 v38, 16, v115
    v_and_b32 v39, 0xffff0000, v115
    v_pk_add_f32 v[46:47], v[46:47], v[38:39]
    s_waitcnt vmcnt(2)
    v_lshlrev_b32 v38, 16, v116
    v_and_b32 v39, 0xffff0000, v116
    v_pk_add_f32 v[40:41], v[40:41], v[38:39]
    v_lshlrev_b32 v38, 16, v117
    v_and_b32 v39, 0xffff0000, v117
    v_pk_add_f32 v[42:43], v[42:43], v[38:39]
    v_lshlrev_b32 v38, 16, v118
    v_and_b32 v39, 0xffff0000, v118
    v_pk_add_f32 v[44:45], v[44:45], v[38:39]
    v_lshlrev_b32 v38, 16, v119
    v_and_b32 v39, 0xffff0000, v119
    v_pk_add_f32 v[46:47], v[46:47], v[38:39]
    s_waitcnt vmcnt(1)
    v_lshlrev_b32 v38, 16, v120
    v_and_b32 v39, 0xffff0000, v120
    v_pk_add_f32 v[40:41], v[40:41], v[38:39]
    v_lshlrev_b32 v38, 16, v121
    v_and_b32 v39, 0xffff0000, v121
    v_pk_add_f32 v[42:43], v[42:43], v[38:39]
    v_lshlrev_b32 v38, 16, v122
    v_and_b32 v39, 0xffff0000, v122
    v_pk_add_f32 v[44:45], v[44:45], v[38:39]
    v_lshlrev_b32 v38, 16, v123
    v_and_b32 v39, 0xffff0000, v123
    v_pk_add_f32 v[46:47], v[46:47], v[38:39]
    s_waitcnt vmcnt(0)
    v_lshlrev_b32 v38, 16, v124
    v_and_b32 v39, 0xffff0000, v124
    v_pk_add_f32 v[40:41], v[40:41], v[38:39]
    v_lshlrev_b32 v38, 16, v125
    v_and_b32 v39, 0xffff0000, v125
    v_pk_add_f32 v[42:43], v[42:43], v[38:39]
    v_lshlrev_b32 v38, 16, v126
    v_and_b32 v39, 0xffff0000, v126
    v_pk_add_f32 v[44:45], v[44:45], v[38:39]
    v_lshlrev_b32 v38, 16, v127
    v_and_b32 v39, 0xffff0000, v127
    v_pk_add_f32 v[46:47], v[46:47], v[38:39]
    s_branch .Lrd_out
.Lrd_eight:
    s_waitcnt vmcnt(7)
    v_lshlrev_b32 v38, 16, v64
    v_and_b32 v39, 0xffff0000, v64
    v_pk_add_f32 v[40:41], v[40:41], v[38:39]
    v_lshlrev_b32 v38, 16, v65
    v_and_b32 v39, 0xffff0000, v65
    v_pk_add_f32 v[42:43], v[42:43], v[38:39]
    v_lshlrev_b32 v38, 16, v66
    v_and_b32 v39, 0xffff0000, v66
    v_pk_add_f32 v[44:45], v[44:45], v[38:39]
    v_lshlrev_b32 v38, 16, v67
    v_and_b32 v39, 0xffff0000, v67
    v_pk_add_f32 v[46:47], v[46:47], v[38:39]
    s_waitcnt vmcnt(6)
    v_lshlrev_b32 v38, 16, v68
    v_and_b32 v39, 0xffff0000, v68
    v_pk_add_f32 v[40:41], v[40:41], v[38:39]
    v_lshlrev_b32 v38, 16, v69
    v_and_b32 v39, 0xffff0000, v69
    v_pk_add_f32 v[42:43], v[42:43], v[38:39]
    v_lshlrev_b32 v38, 16, v70
    v_and_b32 v39, 0xffff0000, v70
    v_pk_add_f32 v[44:45], v[44:45], v[38:39]
    v_lshlrev_b32 v38, 16, v71
    v_and_b32 v39, 0xffff0000, v71
    v_pk_add_f32 v[46:47], v[46:47], v[38:39]
    s_waitcnt vmcnt(5)
    v_lshlrev_b32 v38, 16, v72
    v_and_b32 v39, 0xffff0000, v72
    v_pk_add_f32 v[40:41], v[40:41], v[38:39]
    v_lshlrev_b32 v38, 16, v73
    v_and_b32 v39, 0xffff0000, v73
    v_pk_add_f32 v[42:43], v[42:43], v[38:39]
    v_lshlrev_b32 v38, 16, v74
    v_and_b32 v39, 0xffff0000, v74
    v_pk_add_f32 v[44:45], v[44:45], v[38:39]
    v_lshlrev_b32 v38, 16, v75
    v_and_b32 v39, 0xffff0000, v75
    v_pk_add_f32 v[46:47], v[46:47], v[38:39]
    s_waitcnt vmcnt(4)
    v_lshlrev_b32 v38, 16, v76
    v_and_b32 v39, 0xffff0000, v76
    v_pk_add_f32 v[40:41], v[40:41], v[38:39]
    v_lshlrev_b32 v38, 16, v77
    v_and_b32 v39, 0xffff0000, v77
    v_pk_add_f32 v[42:43], v[42:43], v[38:39]
    v_lshlrev_b32 v38, 16, v78
    v_and_b32 v39, 0xffff0000, v78
    v_pk_add_f32 v[44:45], v[44:45], v[38:39]
    v_lshlrev_b32 v38, 16, v79
    v_and_b32 v39, 0xffff0000, v79
    v_pk_add_f32 v[46:47], v[46:47], v[38:39]
    s_waitcnt vmcnt(3)
    v_lshlrev_b32 v38, 16, v80
    v_and_b32 v39, 0xffff0000, v80
    v_pk_add_f32 v[40:41], v[40:41], v[38:39]
    v_lshlrev_b32 v38, 16, v81
    v_and_b32 v39, 0xffff0000, v81
    v_pk_add_f32 v[42:43], v[42:43], v[38:39]
    v_lshlrev_b32 v38, 16, v82
    v_and_b32 v39, 0xffff0000, v82
    v_pk_add_f32 v[44:45], v[44:45], v[38:39]
    v_lshlrev_b32 v38, 16, v83
    v_and_b32 v39, 0xffff0000, v83
    v_pk_add_f32 v[46:47], v[46:47], v[38:39]
    s_waitcnt vmcnt(2)
    v_lshlrev_b32 v38, 16, v84
    v_and_b32 v39, 0xffff0000, v84
    v_pk_add_f32 v[40:41], v[40:41], v[38:39]
    v_lshlrev_b32 v38, 16, v85
    v_and_b32 v39, 0xffff0000, v85
    v_pk_add_f32 v[42:43], v[42:43], v[38:39]
    v_lshlrev_b32 v38, 16, v86
    v_and_b32 v39, 0xffff0000, v86
    v_pk_add_f32 v[44:45], v[44:45], v[38:39]
    v_lshlrev_b32 v38, 16, v87
    v_and_b32 v39, 0xffff0000, v87
    v_pk_add_f32 v[46:47], v[46:47], v[38:39]
    s_waitcnt vmcnt(1)
    v_lshlrev_b32 v38, 16, v88
    v_and_b32 v39, 0xffff0000, v88
    v_pk_add_f32 v[40:41], v[40:41], v[38:39]
    v_lshlrev_b32 v38, 16, v89
    v_and_b32 v39, 0xffff0000, v89
    v_pk_add_f32 v[42:43], v[42:43], v[38:39]
    v_lshlrev_b32 v38, 16, v90
    v_and_b32 v39, 0xffff0000, v90
    v_pk_add_f32 v[44:45], v[44:45], v[38:39]
    v_lshlrev_b32 v38, 16, v91
    v_and_b32 v39, 0xffff0000, v91
    v_pk_add_f32 v[46:47], v[46:47], v[38:39]
    s_waitcnt vmcnt(0)
    v_lshlrev_b32 v38, 16, v92
    v_and_b32 v39, 0xffff0000, v92
    v_pk_add_f32 v[40:41], v[40:41], v[38:39]
    v_lshlrev_b32 v38, 16, v93
    v_and_b32 v39, 0xffff0000, v93
    v_pk_add_f32 v[42:43], v[42:43], v[38:39]
    v_lshlrev_b32 v38, 16, v94
    v_and_b32 v39, 0xffff0000, v94
    v_pk_add_f32 v[44:45], v[44:45], v[38:39]
    v_lshlrev_b32 v38, 16, v95
    v_and_b32 v39, 0xffff0000, v95
    v_pk_add_f32 v[46:47], v[46:47], v[38:39]
.Lrd_out:
    v_cvt_pk_bf16_f32 v48, v40, v41
    v_cvt_pk_bf16_f32 v49, v42, v43
    v_cvt_pk_bf16_f32 v50, v44, v45
    v_cvt_pk_bf16_f32 v51, v46, v47
    s_nop 0
    v_permlane32_swap_b32 v48, v50
    v_permlane32_swap_b32 v49, v51
    s_nop 0
    v_permlane16_swap_b32 v48, v50
    v_permlane16_swap_b32 v49, v51
    buffer_store_dwordx4 v[48:51], v3, s[12:15], s73 offen
.Lrd_next:
    s_cmp_lg_u32 s88, 0
    s_cbranch_scc1 .Lfin
    s_mov_b32 s88, 1
    s_and_b32 s3, s6, 1
    s_lshl_b32 s3, s3, 3
    s_add_u32 s89, s3, s5
    s_add_u32 s89, s89, 16
    s_branch .Lrd_pass
.Lfin:
.Lend:
    s_endpgm
.Lw_land:
    ds_read_b32 v0, v1
    s_waitcnt lgkmcnt(0)
    v_min_u32_dpp v0, v0, v0 quad_perm:[1,0,3,2] row_mask:0xf bank_mask:0xf
    s_nop 1
    v_min_u32_dpp v0, v0, v0 quad_perm:[2,3,0,1] row_mask:0xf bank_mask:0xf
    s_nop 0
    v_readfirstlane_b32 s86, v0
    s_nop 3
    s_cmp_ge_u32 s86, s85
    s_cbranch_scc1 .Lw_land_r
    s_cmp_eq_u32 s82, 0
    s_cbranch_scc1 .Lw_land_r
    s_sub_u32 s82, s82, 1
    s_sleep 1
    s_branch .Lw_land
.Lw_land_r:
    s_setpc_b64 s[70:71]
.Lck_11_s:
    s_call_b64 s[70:71], .Lw_land
    s_branch .Lck_11
.Lck_12_s:
    s_call_b64 s[70:71], .Lw_land
    s_branch .Lck_12
.Lck_13_s:
    s_call_b64 s[70:71], .Lw_land
    s_branch .Lck_13
.Lck_14_s:
    s_call_b64 s[70:71], .Lw_land
    s_branch .Lck_14
.Lck_15_s:
    s_call_b64 s[70:71], .Lw_land
    s_branch .Lck_15
.Lck_17_s:
    s_call_b64 s[70:71], .Lw_land
    s_branch .Lck_17
.Lck_18_s:
    s_call_b64 s[70:71], .Lw_land
    s_branch .Lck_18
.Lck_20_s:
    s_call_b64 s[70:71], .Lw_land
    s_branch .Lck_20
.Lck_21_s:
    s_call_b64 s[70:71], .Lw_land
    s_branch .Lck_21
.Lck_22_s:
    s_call_b64 s[70:71], .Lw_land
    s_branch .Lck_22
.Lck_23_s:
    s_call_b64 s[70:71], .Lw_land
    s_branch .Lck_23
.Lck_24_s:
    s_call_b64 s[70:71], .Lw_land
    s_branch .Lck_24
.Lck_25_s:
    s_call_b64 s[70:71], .Lw_land
    s_branch .Lck_25
.Lck_26_s:
    s_call_b64 s[70:71], .Lw_land
    s_branch .Lck_26
.Lck_27_s:
    s_call_b64 s[70:71], .Lw_land
    s_branch .Lck_27
.Lck_28_s:
    s_call_b64 s[70:71], .Lw_land
    s_branch .Lck_28
.Lck_29_s:
    s_call_b64 s[70:71], .Lw_land
    s_branch .Lck_29
.Lck_30_s:
    s_call_b64 s[70:71], .Lw_land
    s_branch .Lck_30
.Lck_31_s:
    s_call_b64 s[70:71], .Lw_land
    s_branch .Lck_31
.Lck_32_s:
    s_call_b64 s[70:71], .Lw_land
    s_branch .Lck_32
.Lck_33_s:
    s_call_b64 s[70:71], .Lw_land
    s_branch .Lck_33
.Lck_35_s:
    s_call_b64 s[70:71], .Lw_land
    s_branch .Lck_35
.Lck_36_s:
    s_call_b64 s[70:71], .Lw_land
    s_branch .Lck_36
.Lck_37_s:
    s_call_b64 s[70:71], .Lw_land
    s_branch .Lck_37
.Lck_38_s:
    s_call_b64 s[70:71], .Lw_land
    s_branch .Lck_38
.Lck_40_s:
    s_call_b64 s[70:71], .Lw_land
    s_branch .Lck_40
.Lck_41_s:
    s_call_b64 s[70:71], .Lw_land
    s_branch .Lck_41
.Lck_42_s:
    s_call_b64 s[70:71], .Lw_land
    s_branch .Lck_42
.Lck_43_s:
    s_call_b64 s[70:71], .Lw_land
    s_branch .Lck_43
.Lck_44_s:
    s_call_b64 s[70:71], .Lw_land
    s_branch .Lck_44
.Lck_45_s:
    s_call_b64 s[70:71], .Lw_land
    s_branch .Lck_45
.Lck_46_s:
    s_call_b64 s[70:71], .Lw_land
    s_branch .Lck_46
.Lck_47_s:
    s_call_b64 s[70:71], .Lw_land
    s_branch .Lck_47
.Lck_48_s:
    s_call_b64 s[70:71], .Lw_land
    s_branch .Lck_48
.Lck_49_s:
    s_call_b64 s[70:71], .Lw_land
    s_branch .Lck_49
.Lck_50_s:
    s_call_b64 s[70:71], .Lw_land
    s_branch .Lck_50
.Lck_51_s:
    s_call_b64 s[70:71], .Lw_land
    s_branch .Lck_51
.Lck_52_s:
    s_call_b64 s[70:71], .Lw_land
    s_branch .Lck_52
.Lck_53_s:
    s_call_b64 s[70:71], .Lw_land
    s_branch .Lck_53
.Lck_54_s:
    s_call_b64 s[70:71], .Lw_land
    s_branch .Lck_54
.Lck_55_s:
    s_call_b64 s[70:71], .Lw_land
    s_branch .Lck_55
.Lck_56_s:
    s_call_b64 s[70:71], .Lw_land
    s_branch .Lck_56
.Lck_57_s:
    s_call_b64 s[70:71], .Lw_land
    s_branch .Lck_57
.Lck_58_s:
    s_call_b64 s[70:71], .Lw_land
    s_branch .Lck_58
.Lrs_16_s:
    v_mov_b32 v10, v7
    v_mov_b32 v12, v8
    v_mov_b32 v13, v9
    v_permlane32_swap_b32 v10, v7
    v_permlane32_swap_b32 v12, v8
    v_permlane32_swap_b32 v13, v9
    v_max_f32 v7, v10, v7
    v_max_f32 v8, v12, v8
    v_max_f32 v9, v13, v9
    v_mov_b32 v10, v7
    v_mov_b32 v12, v8
    v_mov_b32 v13, v9
    v_permlane16_swap_b32 v10, v7
    v_permlane16_swap_b32 v12, v8
    v_permlane16_swap_b32 v13, v9
    v_max_f32 v7, v10, v7
    v_max_f32 v8, v12, v8
    v_max_f32 v9, v13, v9
    v_mul_f32 v7, s36, v7
    v_mul_f32 v8, s36, v8
    v_mul_f32 v9, s36, v9
    v_max_f32 v7, v7, v3
    v_max_f32 v8, v8, v4
    v_max_f32 v9, v9, v6
    v_sub_f32 v10, v3, v7
    v_sub_f32 v12, v4, v8
    v_sub_f32 v13, v6, v9
    v_exp_f32 v10, v10
    v_exp_f32 v12, v12
    v_exp_f32 v13, v13
    v_mov_b32 v3, v7
    v_mov_b32 v4, v8
    v_mov_b32 v6, v9
    v_pk_mul_f32 v[14:15], v[14:15], v[10:11] op_sel:[0,0] op_sel_hi:[1,0]
    v_pk_mul_f32 v[16:17], v[16:17], v[12:13] op_sel:[0,0] op_sel_hi:[1,0]
    v_pk_mul_f32 v[18:19], v[18:19], v[12:13] op_sel:[0,1] op_sel_hi:[1,1]
    v_pk_mul_f32 v[160:161], v[160:161], v[10:11] op_sel:[0,0] op_sel_hi:[1,0]
    v_pk_mul_f32 v[162:163], v[162:163], v[10:11] op_sel:[0,0] op_sel_hi:[1,0]
    v_pk_mul_f32 v[164:165], v[164:165], v[12:13] op_sel:[0,0] op_sel_hi:[1,0]
    v_pk_mul_f32 v[166:167], v[166:167], v[12:13] op_sel:[0,0] op_sel_hi:[1,0]
    v_pk_mul_f32 v[168:169], v[168:169], v[12:13] op_sel:[0,1] op_sel_hi:[1,1]
    v_pk_mul_f32 v[170:171], v[170:171], v[12:13] op_sel:[0,1] op_sel_hi:[1,1]
    v_pk_mul_f32 v[172:173], v[172:173], v[10:11] op_sel:[0,0] op_sel_hi:[1,0]
    v_pk_mul_f32 v[174:175], v[174:175], v[10:11] op_sel:[0,0] op_sel_hi:[1,0]
    v_pk_mul_f32 v[176:177], v[176:177], v[12:13] op_sel:[0,0] op_sel_hi:[1,0]
    v_pk_mul_f32 v[178:179], v[178:179], v[12:13] op_sel:[0,0] op_sel_hi:[1,0]
    v_pk_mul_f32 v[180:181], v[180:181], v[12:13] op_sel:[0,1] op_sel_hi:[1,1]
    v_pk_mul_f32 v[182:183], v[182:183], v[12:13] op_sel:[0,1] op_sel_hi:[1,1]
    v_pk_mul_f32 v[184:185], v[184:185], v[10:11] op_sel:[0,0] op_sel_hi:[1,0]
    v_pk_mul_f32 v[186:187], v[186:187], v[10:11] op_sel:[0,0] op_sel_hi:[1,0]
    v_pk_mul_f32 v[188:189], v[188:189], v[12:13] op_sel:[0,0] op_sel_hi:[1,0]
    v_pk_mul_f32 v[190:191], v[190:191], v[12:13] op_sel:[0,0] op_sel_hi:[1,0]
    v_pk_mul_f32 v[192:193], v[192:193], v[12:13] op_sel:[0,1] op_sel_hi:[1,1]
    v_pk_mul_f32 v[194:195], v[194:195], v[12:13] op_sel:[0,1] op_sel_hi:[1,1]
    v_pk_mul_f32 v[196:197], v[196:197], v[10:11] op_sel:[0,0] op_sel_hi:[1,0]
    v_pk_mul_f32 v[198:199], v[198:199], v[10:11] op_sel:[0,0] op_sel_hi:[1,0]
    v_pk_mul_f32 v[200:201], v[200:201], v[12:13] op_sel:[0,0] op_sel_hi:[1,0]
    v_pk_mul_f32 v[202:203], v[202:203], v[12:13] op_sel:[0,0] op_sel_hi:[1,0]
    v_pk_mul_f32 v[204:205], v[204:205], v[12:13] op_sel:[0,1] op_sel_hi:[1,1]
    v_pk_mul_f32 v[206:207], v[206:207], v[12:13] op_sel:[0,1] op_sel_hi:[1,1]
    v_pk_mul_f32 v[208:209], v[208:209], v[10:11] op_sel:[0,0] op_sel_hi:[1,0]
    v_pk_mul_f32 v[210:211], v[210:211], v[10:11] op_sel:[0,0] op_sel_hi:[1,0]
    v_pk_mul_f32 v[212:213], v[212:213], v[12:13] op_sel:[0,0] op_sel_hi:[1,0]
    v_pk_mul_f32 v[214:215], v[214:215], v[12:13] op_sel:[0,0] op_sel_hi:[1,0]
    v_pk_mul_f32 v[216:217], v[216:217], v[12:13] op_sel:[0,1] op_sel_hi:[1,1]
    v_pk_mul_f32 v[218:219], v[218:219], v[12:13] op_sel:[0,1] op_sel_hi:[1,1]
    v_pk_mul_f32 v[220:221], v[220:221], v[10:11] op_sel:[0,0] op_sel_hi:[1,0]
    v_pk_mul_f32 v[222:223], v[222:223], v[10:11] op_sel:[0,0] op_sel_hi:[1,0]
    v_pk_mul_f32 v[224:225], v[224:225], v[12:13] op_sel:[0,0] op_sel_hi:[1,0]
    v_pk_mul_f32 v[226:227], v[226:227], v[12:13] op_sel:[0,0] op_sel_hi:[1,0]
    v_pk_mul_f32 v[228:229], v[228:229], v[12:13] op_sel:[0,1] op_sel_hi:[1,1]
    v_pk_mul_f32 v[230:231], v[230:231], v[12:13] op_sel:[0,1] op_sel_hi:[1,1]
    v_pk_mul_f32 v[232:233], v[232:233], v[10:11] op_sel:[0,0] op_sel_hi:[1,0]
    v_pk_mul_f32 v[234:235], v[234:235], v[10:11] op_sel:[0,0] op_sel_hi:[1,0]
    v_pk_mul_f32 v[236:237], v[236:237], v[12:13] op_sel:[0,0] op_sel_hi:[1,0]
    v_pk_mul_f32 v[238:239], v[238:239], v[12:13] op_sel:[0,0] op_sel_hi:[1,0]
    v_pk_mul_f32 v[240:241], v[240:241], v[12:13] op_sel:[0,1] op_sel_hi:[1,1]
    v_pk_mul_f32 v[242:243], v[242:243], v[12:13] op_sel:[0,1] op_sel_hi:[1,1]
    v_pk_mul_f32 v[244:245], v[244:245], v[10:11] op_sel:[0,0] op_sel_hi:[1,0]
    v_pk_mul_f32 v[246:247], v[246:247], v[10:11] op_sel:[0,0] op_sel_hi:[1,0]
    v_pk_mul_f32 v[248:249], v[248:249], v[12:13] op_sel:[0,0] op_sel_hi:[1,0]
    v_pk_mul_f32 v[250:251], v[250:251], v[12:13] op_sel:[0,0] op_sel_hi:[1,0]
    v_pk_mul_f32 v[252:253], v[252:253], v[12:13] op_sel:[0,1] op_sel_hi:[1,1]
    v_pk_mul_f32 v[254:255], v[254:255], v[12:13] op_sel:[0,1] op_sel_hi:[1,1]
    s_branch .Lrs_16
.Lrs_19_s:
    v_mov_b32 v10, v7
    v_mov_b32 v12, v8
    v_mov_b32 v13, v9
    v_permlane32_swap_b32 v10, v7
    v_permlane32_swap_b32 v12, v8
    v_permlane32_swap_b32 v13, v9
    v_max_f32 v7, v10, v7
    v_max_f32 v8, v12, v8
    v_max_f32 v9, v13, v9
    v_mov_b32 v10, v7
    v_mov_b32 v12, v8
    v_mov_b32 v13, v9
    v_permlane16_swap_b32 v10, v7
    v_permlane16_swap_b32 v12, v8
    v_permlane16_swap_b32 v13, v9
    v_max_f32 v7, v10, v7
    v_max_f32 v8, v12, v8
    v_max_f32 v9, v13, v9
    v_mul_f32 v7, s36, v7
    v_mul_f32 v8, s36, v8
    v_mul_f32 v9, s36, v9
    v_max_f32 v7, v7, v3
    v_max_f32 v8, v8, v4
    v_max_f32 v9, v9, v6
    v_sub_f32 v10, v3, v7
    v_sub_f32 v12, v4, v8
    v_sub_f32 v13, v6, v9
    v_exp_f32 v10, v10
    v_exp_f32 v12, v12
    v_exp_f32 v13, v13
    v_mov_b32 v3, v7
    v_mov_b32 v4, v8
    v_mov_b32 v6, v9
    v_pk_mul_f32 v[14:15], v[14:15], v[10:11] op_sel:[0,0] op_sel_hi:[1,0]
    v_pk_mul_f32 v[16:17], v[16:17], v[12:13] op_sel:[0,0] op_sel_hi:[1,0]
    v_pk_mul_f32 v[18:19], v[18:19], v[12:13] op_sel:[0,1] op_sel_hi:[1,1]
    v_pk_mul_f32 v[160:161], v[160:161], v[10:11] op_sel:[0,0] op_sel_hi:[1,0]
    v_pk_mul_f32 v[162:163], v[162:163], v[10:11] op_sel:[0,0] op_sel_hi:[1,0]
    v_pk_mul_f32 v[164:165], v[164:165], v[12:13] op_sel:[0,0] op_sel_hi:[1,0]
    v_pk_mul_f32 v[166:167], v[166:167], v[12:13] op_sel:[0,0] op_sel_hi:[1,0]
    v_pk_mul_f32 v[168:169], v[168:169], v[12:13] op_sel:[0,1] op_sel_hi:[1,1]
    v_pk_mul_f32 v[170:171], v[170:171], v[12:13] op_sel:[0,1] op_sel_hi:[1,1]
    v_pk_mul_f32 v[172:173], v[172:173], v[10:11] op_sel:[0,0] op_sel_hi:[1,0]
    v_pk_mul_f32 v[174:175], v[174:175], v[10:11] op_sel:[0,0] op_sel_hi:[1,0]
    v_pk_mul_f32 v[176:177], v[176:177], v[12:13] op_sel:[0,0] op_sel_hi:[1,0]
    v_pk_mul_f32 v[178:179], v[178:179], v[12:13] op_sel:[0,0] op_sel_hi:[1,0]
    v_pk_mul_f32 v[180:181], v[180:181], v[12:13] op_sel:[0,1] op_sel_hi:[1,1]
    v_pk_mul_f32 v[182:183], v[182:183], v[12:13] op_sel:[0,1] op_sel_hi:[1,1]
    v_pk_mul_f32 v[184:185], v[184:185], v[10:11] op_sel:[0,0] op_sel_hi:[1,0]
    v_pk_mul_f32 v[186:187], v[186:187], v[10:11] op_sel:[0,0] op_sel_hi:[1,0]
    v_pk_mul_f32 v[188:189], v[188:189], v[12:13] op_sel:[0,0] op_sel_hi:[1,0]
    v_pk_mul_f32 v[190:191], v[190:191], v[12:13] op_sel:[0,0] op_sel_hi:[1,0]
    v_pk_mul_f32 v[192:193], v[192:193], v[12:13] op_sel:[0,1] op_sel_hi:[1,1]
    v_pk_mul_f32 v[194:195], v[194:195], v[12:13] op_sel:[0,1] op_sel_hi:[1,1]
    v_pk_mul_f32 v[196:197], v[196:197], v[10:11] op_sel:[0,0] op_sel_hi:[1,0]
    v_pk_mul_f32 v[198:199], v[198:199], v[10:11] op_sel:[0,0] op_sel_hi:[1,0]
    v_pk_mul_f32 v[200:201], v[200:201], v[12:13] op_sel:[0,0] op_sel_hi:[1,0]
    v_pk_mul_f32 v[202:203], v[202:203], v[12:13] op_sel:[0,0] op_sel_hi:[1,0]
    v_pk_mul_f32 v[204:205], v[204:205], v[12:13] op_sel:[0,1] op_sel_hi:[1,1]
    v_pk_mul_f32 v[206:207], v[206:207], v[12:13] op_sel:[0,1] op_sel_hi:[1,1]
    v_pk_mul_f32 v[208:209], v[208:209], v[10:11] op_sel:[0,0] op_sel_hi:[1,0]
    v_pk_mul_f32 v[210:211], v[210:211], v[10:11] op_sel:[0,0] op_sel_hi:[1,0]
    v_pk_mul_f32 v[212:213], v[212:213], v[12:13] op_sel:[0,0] op_sel_hi:[1,0]
    v_pk_mul_f32 v[214:215], v[214:215], v[12:13] op_sel:[0,0] op_sel_hi:[1,0]
    v_pk_mul_f32 v[216:217], v[216:217], v[12:13] op_sel:[0,1] op_sel_hi:[1,1]
    v_pk_mul_f32 v[218:219], v[218:219], v[12:13] op_sel:[0,1] op_sel_hi:[1,1]
    v_pk_mul_f32 v[220:221], v[220:221], v[10:11] op_sel:[0,0] op_sel_hi:[1,0]
    v_pk_mul_f32 v[222:223], v[222:223], v[10:11] op_sel:[0,0] op_sel_hi:[1,0]
    v_pk_mul_f32 v[224:225], v[224:225], v[12:13] op_sel:[0,0] op_sel_hi:[1,0]
    v_pk_mul_f32 v[226:227], v[226:227], v[12:13] op_sel:[0,0] op_sel_hi:[1,0]
    v_pk_mul_f32 v[228:229], v[228:229], v[12:13] op_sel:[0,1] op_sel_hi:[1,1]
    v_pk_mul_f32 v[230:231], v[230:231], v[12:13] op_sel:[0,1] op_sel_hi:[1,1]
    v_pk_mul_f32 v[232:233], v[232:233], v[10:11] op_sel:[0,0] op_sel_hi:[1,0]
    v_pk_mul_f32 v[234:235], v[234:235], v[10:11] op_sel:[0,0] op_sel_hi:[1,0]
    v_pk_mul_f32 v[236:237], v[236:237], v[12:13] op_sel:[0,0] op_sel_hi:[1,0]
    v_pk_mul_f32 v[238:239], v[238:239], v[12:13] op_sel:[0,0] op_sel_hi:[1,0]
    v_pk_mul_f32 v[240:241], v[240:241], v[12:13] op_sel:[0,1] op_sel_hi:[1,1]
    v_pk_mul_f32 v[242:243], v[242:243], v[12:13] op_sel:[0,1] op_sel_hi:[1,1]
    v_pk_mul_f32 v[244:245], v[244:245], v[10:11] op_sel:[0,0] op_sel_hi:[1,0]
    v_pk_mul_f32 v[246:247], v[246:247], v[10:11] op_sel:[0,0] op_sel_hi:[1,0]
    v_pk_mul_f32 v[248:249], v[248:249], v[12:13] op_sel:[0,0] op_sel_hi:[1,0]
    v_pk_mul_f32 v[250:251], v[250:251], v[12:13] op_sel:[0,0] op_sel_hi:[1,0]
    v_pk_mul_f32 v[252:253], v[252:253], v[12:13] op_sel:[0,1] op_sel_hi:[1,1]
    v_pk_mul_f32 v[254:255], v[254:255], v[12:13] op_sel:[0,1] op_sel_hi:[1,1]
    s_branch .Lrs_19
.Lrs_34_s:
    v_mov_b32 v10, v7
    v_mov_b32 v12, v8
    v_mov_b32 v13, v9
    v_permlane32_swap_b32 v10, v7
    v_permlane32_swap_b32 v12, v8
    v_permlane32_swap_b32 v13, v9
    v_max_f32 v7, v10, v7
    v_max_f32 v8, v12, v8
    v_max_f32 v9, v13, v9
    v_mov_b32 v10, v7
    v_mov_b32 v12, v8
    v_mov_b32 v13, v9
    v_permlane16_swap_b32 v10, v7
    v_permlane16_swap_b32 v12, v8
    v_permlane16_swap_b32 v13, v9
    v_max_f32 v7, v10, v7
    v_max_f32 v8, v12, v8
    v_max_f32 v9, v13, v9
    v_mul_f32 v7, s36, v7
    v_mul_f32 v8, s36, v8
    v_mul_f32 v9, s36, v9
    v_max_f32 v7, v7, v3
    v_max_f32 v8, v8, v4
    v_max_f32 v9, v9, v6
    v_sub_f32 v10, v3, v7
    v_sub_f32 v12, v4, v8
    v_sub_f32 v13, v6, v9
    v_exp_f32 v10, v10
    v_exp_f32 v12, v12
    v_exp_f32 v13, v13
    v_mov_b32 v3, v7
    v_mov_b32 v4, v8
    v_mov_b32 v6, v9
    v_pk_mul_f32 v[14:15], v[14:15], v[10:11] op_sel:[0,0] op_sel_hi:[1,0]
    v_pk_mul_f32 v[16:17], v[16:17], v[12:13] op_sel:[0,0] op_sel_hi:[1,0]
    v_pk_mul_f32 v[18:19], v[18:19], v[12:13] op_sel:[0,1] op_sel_hi:[1,1]
    v_pk_mul_f32 v[160:161], v[160:161], v[10:11] op_sel:[0,0] op_sel_hi:[1,0]
    v_pk_mul_f32 v[162:163], v[162:163], v[10:11] op_sel:[0,0] op_sel_hi:[1,0]
    v_pk_mul_f32 v[164:165], v[164:165], v[12:13] op_sel:[0,0] op_sel_hi:[1,0]
    v_pk_mul_f32 v[166:167], v[166:167], v[12:13] op_sel:[0,0] op_sel_hi:[1,0]
    v_pk_mul_f32 v[168:169], v[168:169], v[12:13] op_sel:[0,1] op_sel_hi:[1,1]
    v_pk_mul_f32 v[170:171], v[170:171], v[12:13] op_sel:[0,1] op_sel_hi:[1,1]
    v_pk_mul_f32 v[172:173], v[172:173], v[10:11] op_sel:[0,0] op_sel_hi:[1,0]
    v_pk_mul_f32 v[174:175], v[174:175], v[10:11] op_sel:[0,0] op_sel_hi:[1,0]
    v_pk_mul_f32 v[176:177], v[176:177], v[12:13] op_sel:[0,0] op_sel_hi:[1,0]
    v_pk_mul_f32 v[178:179], v[178:179], v[12:13] op_sel:[0,0] op_sel_hi:[1,0]
    v_pk_mul_f32 v[180:181], v[180:181], v[12:13] op_sel:[0,1] op_sel_hi:[1,1]
    v_pk_mul_f32 v[182:183], v[182:183], v[12:13] op_sel:[0,1] op_sel_hi:[1,1]
    v_pk_mul_f32 v[184:185], v[184:185], v[10:11] op_sel:[0,0] op_sel_hi:[1,0]
    v_pk_mul_f32 v[186:187], v[186:187], v[10:11] op_sel:[0,0] op_sel_hi:[1,0]
    v_pk_mul_f32 v[188:189], v[188:189], v[12:13] op_sel:[0,0] op_sel_hi:[1,0]
    v_pk_mul_f32 v[190:191], v[190:191], v[12:13] op_sel:[0,0] op_sel_hi:[1,0]
    v_pk_mul_f32 v[192:193], v[192:193], v[12:13] op_sel:[0,1] op_sel_hi:[1,1]
    v_pk_mul_f32 v[194:195], v[194:195], v[12:13] op_sel:[0,1] op_sel_hi:[1,1]
    v_pk_mul_f32 v[196:197], v[196:197], v[10:11] op_sel:[0,0] op_sel_hi:[1,0]
    v_pk_mul_f32 v[198:199], v[198:199], v[10:11] op_sel:[0,0] op_sel_hi:[1,0]
    v_pk_mul_f32 v[200:201], v[200:201], v[12:13] op_sel:[0,0] op_sel_hi:[1,0]
    v_pk_mul_f32 v[202:203], v[202:203], v[12:13] op_sel:[0,0] op_sel_hi:[1,0]
    v_pk_mul_f32 v[204:205], v[204:205], v[12:13] op_sel:[0,1] op_sel_hi:[1,1]
    v_pk_mul_f32 v[206:207], v[206:207], v[12:13] op_sel:[0,1] op_sel_hi:[1,1]
    v_pk_mul_f32 v[208:209], v[208:209], v[10:11] op_sel:[0,0] op_sel_hi:[1,0]
    v_pk_mul_f32 v[210:211], v[210:211], v[10:11] op_sel:[0,0] op_sel_hi:[1,0]
    v_pk_mul_f32 v[212:213], v[212:213], v[12:13] op_sel:[0,0] op_sel_hi:[1,0]
    v_pk_mul_f32 v[214:215], v[214:215], v[12:13] op_sel:[0,0] op_sel_hi:[1,0]
    v_pk_mul_f32 v[216:217], v[216:217], v[12:13] op_sel:[0,1] op_sel_hi:[1,1]
    v_pk_mul_f32 v[218:219], v[218:219], v[12:13] op_sel:[0,1] op_sel_hi:[1,1]
    v_pk_mul_f32 v[220:221], v[220:221], v[10:11] op_sel:[0,0] op_sel_hi:[1,0]
    v_pk_mul_f32 v[222:223], v[222:223], v[10:11] op_sel:[0,0] op_sel_hi:[1,0]
    v_pk_mul_f32 v[224:225], v[224:225], v[12:13] op_sel:[0,0] op_sel_hi:[1,0]
    v_pk_mul_f32 v[226:227], v[226:227], v[12:13] op_sel:[0,0] op_sel_hi:[1,0]
    v_pk_mul_f32 v[228:229], v[228:229], v[12:13] op_sel:[0,1] op_sel_hi:[1,1]
    v_pk_mul_f32 v[230:231], v[230:231], v[12:13] op_sel:[0,1] op_sel_hi:[1,1]
    v_pk_mul_f32 v[232:233], v[232:233], v[10:11] op_sel:[0,0] op_sel_hi:[1,0]
    v_pk_mul_f32 v[234:235], v[234:235], v[10:11] op_sel:[0,0] op_sel_hi:[1,0]
    v_pk_mul_f32 v[236:237], v[236:237], v[12:13] op_sel:[0,0] op_sel_hi:[1,0]
    v_pk_mul_f32 v[238:239], v[238:239], v[12:13] op_sel:[0,0] op_sel_hi:[1,0]
    v_pk_mul_f32 v[240:241], v[240:241], v[12:13] op_sel:[0,1] op_sel_hi:[1,1]
    v_pk_mul_f32 v[242:243], v[242:243], v[12:13] op_sel:[0,1] op_sel_hi:[1,1]
    v_pk_mul_f32 v[244:245], v[244:245], v[10:11] op_sel:[0,0] op_sel_hi:[1,0]
    v_pk_mul_f32 v[246:247], v[246:247], v[10:11] op_sel:[0,0] op_sel_hi:[1,0]
    v_pk_mul_f32 v[248:249], v[248:249], v[12:13] op_sel:[0,0] op_sel_hi:[1,0]
    v_pk_mul_f32 v[250:251], v[250:251], v[12:13] op_sel:[0,0] op_sel_hi:[1,0]
    v_pk_mul_f32 v[252:253], v[252:253], v[12:13] op_sel:[0,1] op_sel_hi:[1,1]
    v_pk_mul_f32 v[254:255], v[254:255], v[12:13] op_sel:[0,1] op_sel_hi:[1,1]
    s_branch .Lrs_34
.Lrs_39_s:
    v_mov_b32 v10, v7
    v_mov_b32 v12, v8
    v_mov_b32 v13, v9
    v_permlane32_swap_b32 v10, v7
    v_permlane32_swap_b32 v12, v8
    v_permlane32_swap_b32 v13, v9
    v_max_f32 v7, v10, v7
    v_max_f32 v8, v12, v8
    v_max_f32 v9, v13, v9
    v_mov_b32 v10, v7
    v_mov_b32 v12, v8
    v_mov_b32 v13, v9
    v_permlane16_swap_b32 v10, v7
    v_permlane16_swap_b32 v12, v8
    v_permlane16_swap_b32 v13, v9
    v_max_f32 v7, v10, v7
    v_max_f32 v8, v12, v8
    v_max_f32 v9, v13, v9
    v_mul_f32 v7, s36, v7
    v_mul_f32 v8, s36, v8
    v_mul_f32 v9, s36, v9
    v_max_f32 v7, v7, v3
    v_max_f32 v8, v8, v4
    v_max_f32 v9, v9, v6
    v_sub_f32 v10, v3, v7
    v_sub_f32 v12, v4, v8
    v_sub_f32 v13, v6, v9
    v_exp_f32 v10, v10
    v_exp_f32 v12, v12
    v_exp_f32 v13, v13
    v_mov_b32 v3, v7
    v_mov_b32 v4, v8
    v_mov_b32 v6, v9
    v_pk_mul_f32 v[14:15], v[14:15], v[10:11] op_sel:[0,0] op_sel_hi:[1,0]
    v_pk_mul_f32 v[16:17], v[16:17], v[12:13] op_sel:[0,0] op_sel_hi:[1,0]
    v_pk_mul_f32 v[18:19], v[18:19], v[12:13] op_sel:[0,1] op_sel_hi:[1,1]
    v_pk_mul_f32 v[160:161], v[160:161], v[10:11] op_sel:[0,0] op_sel_hi:[1,0]
    v_pk_mul_f32 v[162:163], v[162:163], v[10:11] op_sel:[0,0] op_sel_hi:[1,0]
    v_pk_mul_f32 v[164:165], v[164:165], v[12:13] op_sel:[0,0] op_sel_hi:[1,0]
    v_pk_mul_f32 v[166:167], v[166:167], v[12:13] op_sel:[0,0] op_sel_hi:[1,0]
    v_pk_mul_f32 v[168:169], v[168:169], v[12:13] op_sel:[0,1] op_sel_hi:[1,1]
    v_pk_mul_f32 v[170:171], v[170:171], v[12:13] op_sel:[0,1] op_sel_hi:[1,1]
    v_pk_mul_f32 v[172:173], v[172:173], v[10:11] op_sel:[0,0] op_sel_hi:[1,0]
    v_pk_mul_f32 v[174:175], v[174:175], v[10:11] op_sel:[0,0] op_sel_hi:[1,0]
    v_pk_mul_f32 v[176:177], v[176:177], v[12:13] op_sel:[0,0] op_sel_hi:[1,0]
    v_pk_mul_f32 v[178:179], v[178:179], v[12:13] op_sel:[0,0] op_sel_hi:[1,0]
    v_pk_mul_f32 v[180:181], v[180:181], v[12:13] op_sel:[0,1] op_sel_hi:[1,1]
    v_pk_mul_f32 v[182:183], v[182:183], v[12:13] op_sel:[0,1] op_sel_hi:[1,1]
    v_pk_mul_f32 v[184:185], v[184:185], v[10:11] op_sel:[0,0] op_sel_hi:[1,0]
    v_pk_mul_f32 v[186:187], v[186:187], v[10:11] op_sel:[0,0] op_sel_hi:[1,0]
    v_pk_mul_f32 v[188:189], v[188:189], v[12:13] op_sel:[0,0] op_sel_hi:[1,0]
    v_pk_mul_f32 v[190:191], v[190:191], v[12:13] op_sel:[0,0] op_sel_hi:[1,0]
    v_pk_mul_f32 v[192:193], v[192:193], v[12:13] op_sel:[0,1] op_sel_hi:[1,1]
    v_pk_mul_f32 v[194:195], v[194:195], v[12:13] op_sel:[0,1] op_sel_hi:[1,1]
    v_pk_mul_f32 v[196:197], v[196:197], v[10:11] op_sel:[0,0] op_sel_hi:[1,0]
    v_pk_mul_f32 v[198:199], v[198:199], v[10:11] op_sel:[0,0] op_sel_hi:[1,0]
    v_pk_mul_f32 v[200:201], v[200:201], v[12:13] op_sel:[0,0] op_sel_hi:[1,0]
    v_pk_mul_f32 v[202:203], v[202:203], v[12:13] op_sel:[0,0] op_sel_hi:[1,0]
    v_pk_mul_f32 v[204:205], v[204:205], v[12:13] op_sel:[0,1] op_sel_hi:[1,1]
    v_pk_mul_f32 v[206:207], v[206:207], v[12:13] op_sel:[0,1] op_sel_hi:[1,1]
    v_pk_mul_f32 v[208:209], v[208:209], v[10:11] op_sel:[0,0] op_sel_hi:[1,0]
    v_pk_mul_f32 v[210:211], v[210:211], v[10:11] op_sel:[0,0] op_sel_hi:[1,0]
    v_pk_mul_f32 v[212:213], v[212:213], v[12:13] op_sel:[0,0] op_sel_hi:[1,0]
    v_pk_mul_f32 v[214:215], v[214:215], v[12:13] op_sel:[0,0] op_sel_hi:[1,0]
    v_pk_mul_f32 v[216:217], v[216:217], v[12:13] op_sel:[0,1] op_sel_hi:[1,1]
    v_pk_mul_f32 v[218:219], v[218:219], v[12:13] op_sel:[0,1] op_sel_hi:[1,1]
    v_pk_mul_f32 v[220:221], v[220:221], v[10:11] op_sel:[0,0] op_sel_hi:[1,0]
    v_pk_mul_f32 v[222:223], v[222:223], v[10:11] op_sel:[0,0] op_sel_hi:[1,0]
    v_pk_mul_f32 v[224:225], v[224:225], v[12:13] op_sel:[0,0] op_sel_hi:[1,0]
    v_pk_mul_f32 v[226:227], v[226:227], v[12:13] op_sel:[0,0] op_sel_hi:[1,0]
    v_pk_mul_f32 v[228:229], v[228:229], v[12:13] op_sel:[0,1] op_sel_hi:[1,1]
    v_pk_mul_f32 v[230:231], v[230:231], v[12:13] op_sel:[0,1] op_sel_hi:[1,1]
    v_pk_mul_f32 v[232:233], v[232:233], v[10:11] op_sel:[0,0] op_sel_hi:[1,0]
    v_pk_mul_f32 v[234:235], v[234:235], v[10:11] op_sel:[0,0] op_sel_hi:[1,0]
    v_pk_mul_f32 v[236:237], v[236:237], v[12:13] op_sel:[0,0] op_sel_hi:[1,0]
    v_pk_mul_f32 v[238:239], v[238:239], v[12:13] op_sel:[0,0] op_sel_hi:[1,0]
    v_pk_mul_f32 v[240:241], v[240:241], v[12:13] op_sel:[0,1] op_sel_hi:[1,1]
    v_pk_mul_f32 v[242:243], v[242:243], v[12:13] op_sel:[0,1] op_sel_hi:[1,1]
    v_pk_mul_f32 v[244:245], v[244:245], v[10:11] op_sel:[0,0] op_sel_hi:[1,0]
    v_pk_mul_f32 v[246:247], v[246:247], v[10:11] op_sel:[0,0] op_sel_hi:[1,0]
    v_pk_mul_f32 v[248:249], v[248:249], v[12:13] op_sel:[0,0] op_sel_hi:[1,0]
    v_pk_mul_f32 v[250:251], v[250:251], v[12:13] op_sel:[0,0] op_sel_hi:[1,0]
    v_pk_mul_f32 v[252:253], v[252:253], v[12:13] op_sel:[0,1] op_sel_hi:[1,1]
    v_pk_mul_f32 v[254:255], v[254:255], v[12:13] op_sel:[0,1] op_sel_hi:[1,1]
    s_branch .Lrs_39
.Ltab:
    .long 0, 1, 2, 3, 4, 5, 6, 7, 8, 9, 10, 11, 12, 13, 14, 15, 16, 17, 18, 19, 20, 21, 22, 23, 24, 25, 26, 27, 28, 29, 30, 31, 32, 33, 34, 35, 36, 37, 38, 39, 40, 41, 42, 43, 44, 45, 46, 47, 48, 49, 50, 51, 52, 53, 54, 55, 56, 57, 58, 59, 60, 61, 62, 63, 64
.Lcode_end:
.section .rodata,"a"
.p2align 6
.amdhsa_kernel concat_heads__gqa_block_cached__mha_block_cached__near_ridge_kernel
  .amdhsa_next_free_vgpr 256
  .amdhsa_next_free_sgpr 102
  .amdhsa_accum_offset 256
  .amdhsa_group_segment_fixed_size 0
  .amdhsa_kernarg_size 104
  .amdhsa_user_sgpr_count 2
  .amdhsa_user_sgpr_kernarg_segment_ptr 1
  .amdhsa_system_sgpr_workgroup_id_x 1
.end_amdhsa_kernel
```
